```python
import torch

def _softmax(x, axis=-1):
    return torch.softmax(x, dim=axis)
def _gelu(x):
    return torch.nn.functional.gelu(x, approximate="tanh")
def _silu(x):
    return torch.nn.functional.silu(x)
def _sigmoid(x):
    return torch.sigmoid(x)
def _layernorm(x, axis=-1, eps=1e-5):
    m = x.mean(dim=axis, keepdim=True)
    v = x.var(dim=axis, keepdim=True, unbiased=False)
    return (x - m) / torch.sqrt(v + eps)
def _scatter_add(tgt, idx, src, axis=0):
    return tgt.clone().index_add_(axis, idx, src)
def _segment_sum(src, seg, n):
    out = torch.zeros((n,) + src.shape[1:], dtype=src.dtype)
    return out.index_add_(0, seg, src)
def _pad(x, pw):
    flat = tuple(v for pair in reversed(pw) for v in pair)
    return torch.nn.functional.pad(x, flat)

kernel_name = 'sequential_preLN__linear_kernel_hedgehog__glu_gated_reglu__prompt'

def setup_inputs():

    _w = (lambda a: (lambda t: t.to(torch.bfloat16) if t.is_floating_point() else t)(torch.as_tensor(a)))
    def _A_setup():
        B, S, D, H = 1, 2048, 640, 32
        Dh = D // H
        return {
            "x": _w((lambda *s: torch.randn(*s, dtype=torch.bfloat16) * 0.05)(B, S, D)),
            "wqkv": _w((lambda *s: torch.randn(*s, dtype=torch.bfloat16) * 0.2)(D, 3 * D)),
            "w_phi": _w((lambda *s: torch.randn(*s, dtype=torch.bfloat16) * 0.2)(H, Dh, Dh) * (Dh ** -0.5)),
            "wo": _w((lambda *s: torch.randn(*s, dtype=torch.bfloat16) * 0.05)(D, D)),
        }
    _A_in = _A_setup()

    def _B_setup():
        B, S, D, F = 1, 2048, 640, 1536
        return {
            "x": _w((lambda *s: torch.randn(*s, dtype=torch.bfloat16) * 0.05)(B, S, D)),
            "W_gate": _w((lambda *s: torch.randn(*s, dtype=torch.bfloat16) * 0.4)(D, F) * (2.0 / D) ** 0.5),
            "W_up": _w((lambda *s: torch.randn(*s, dtype=torch.bfloat16) * 0.4)(D, F) * (2.0 / D) ** 0.5),
            "W_down": _w((lambda *s: torch.randn(*s, dtype=torch.bfloat16) * 0.4)(F, D) * (1.0 / F) ** 0.5),
        }
    _B_in = _B_setup()

    return {
        "A_x": _A_in["x"],
        "A_wqkv": _A_in["wqkv"],
        "A_w_phi": _A_in["w_phi"],
        "A_wo": _A_in["wo"],
        "B_x": _B_in["x"],
        "B_W_gate": _B_in["W_gate"],
        "B_W_up": _B_in["W_up"],
        "B_W_down": _B_in["W_down"],
    }

def reference(A_x, A_wqkv, A_w_phi, A_wo, B_x, B_W_gate, B_W_up, B_W_down):
    def _A_ref(x, wqkv, w_phi, wo):
        B, S, D = x.shape
        H = 32; Dh = D // H
        qkv = (lambda x, *d: x.permute(*d))((x @ wqkv).reshape(B, S, 3, H, Dh), 2, 0, 3, 1, 4)
        q, k, v = qkv[0], qkv[1], qkv[2]
        pq = torch.einsum("bhsd,hdf->bhsf", q, w_phi)
        pk = torch.einsum("bhsd,hdf->bhsf", k, w_phi)
        phi_q = torch.concatenate([_softmax(pq, axis=-1), _softmax(-pq, axis=-1)], axis=-1)
        phi_k = torch.concatenate([_softmax(pk, axis=-1), _softmax(-pk, axis=-1)], axis=-1)
        kv = torch.einsum("bhsf,bhsd->bhfd", phi_k, v)
        z  = torch.einsum("bhsf->bhf", phi_k)
        num = torch.einsum("bhqf,bhfd->bhqd", phi_q, kv)
        den = torch.einsum("bhqf,bhf->bhq", phi_q, z)[..., None] + 1e-6
        o = num / den
        return (lambda x, *d: x.permute(*d))(o, 0, 2, 1, 3).reshape(B, S, D) @ wo

    def _B_ref(x, W_gate, W_up, W_down):
        gate = torch.einsum("bsd,df->bsf", x, W_gate)
        up = torch.einsum("bsd,df->bsf", x, W_up)
        gate = gate * (lambda x, dt: x.to(dt))(gate > 0, gate.dtype)
        h = gate * up
        return torch.einsum("bsf,fd->bsd", h, W_down)

    x = A_x
    h = x + _A_ref(_layernorm(x, axis=-1), A_wqkv, A_w_phi, A_wo)
    h2 = h + _B_ref(_layernorm(h, axis=-1), B_W_gate, B_W_up, B_W_down)
    return h2
```

```asm
; @launch grid=(256,1,1) block=(256,1,1) lds=163840
.amdgcn_target "amdgcn-amd-amdhsa--gfx950"
.text
.globl sequential_preLN__linear_kernel_hedgehog__glu_gated_reglu__prompt_kernel
.p2align 8
.type sequential_preLN__linear_kernel_hedgehog__glu_gated_reglu__prompt_kernel,@function
sequential_preLN__linear_kernel_hedgehog__glu_gated_reglu__prompt_kernel:
    s_load_dwordx16 s[80:95], s[0:1], 0
    s_load_dwordx4 s[96:99], s[0:1], 64
    s_load_dwordx2 s[100:101], s[0:1], 80
    s_cmp_ge_u32 s2, 256
    s_cbranch_scc1 L_end
    s_and_b32 s4, s2, 7
    s_lshr_b32 s5, s2, 3
    s_lshr_b32 s6, s4, 1
    s_lshl_b32 s12, s6, 2
    s_lshr_b32 s7, s5, 3
    s_add_u32 s12, s12, s7
    s_and_b32 s7, s4, 1
    s_lshl_b32 s13, s7, 3
    s_and_b32 s8, s5, 7
    s_add_u32 s13, s13, s8
    s_lshl_b32 s15, s6, 3
    s_lshr_b32 s8, s5, 2
    s_add_u32 s15, s15, s8
    s_lshl_b32 s16, s7, 2
    s_and_b32 s8, s5, 3
    s_add_u32 s16, s16, s8
    s_mov_b32 s20, s5
    s_mov_b32 s21, s7
    v_lshrrev_b32 v4, 6, v0
    v_and_b32 v1, 63, v0
    v_readfirstlane_b32 s14, v4
    v_lshlrev_b32 v12, 4, v1
    v_lshrrev_b32 v5, 4, v1
    v_and_b32 v6, 15, v1
    s_mul_i32 s4, s12, 40
    v_add_u32 v4, s4, v5
    s_lshl_b32 s6, s13, 4
    s_add_u32 s6, s6, s12
    v_lshlrev_b32 v10, 5, v6
    v_cmp_eq_u32 vcc, 0, v5
    v_mov_b32 v11, 0x7ffffff0
    s_nop 0
    v_cndmask_b32 v10, v11, v10, vcc
    v_min_u32 v8, 14, v6
    v_lshlrev_b32 v8, 4, v8
    v_cmp_le_u32 vcc, 5, v6
    v_add_u32 v9, 1200, v8
    s_nop 0
    v_cndmask_b32 v8, v8, v9, vcc
    v_cmp_le_u32 vcc, 10, v6
    v_add_u32 v9, 1200, v8
    s_nop 0
    v_cndmask_b32_e64 v8, v8, v9, vcc
    v_mul_u32_u24 v4, 3840, v4
    s_mul_i32 s5, s13, 80
    v_add3_u32 v4, v4, v8, s5
    s_lshl_b32 s6, s6, 9
    s_add_u32 s6, s6, 131072
    v_add_u32 v226, s6, v10
    v_mov_b32 v228, v4
    v_lshlrev_b32 v7, 2, v5
    v_xor_b32 v7, v7, v6
    v_lshlrev_b32 v7, 4, v7
    v_lshl_add_u32 v7, v5, 8, v7
    s_mul_i32 s4, s12, 10240
    s_mul_i32 s5, s13, 163840
    s_add_u32 s4, s4, s5
    s_add_u32 s4, s4, 17825792
    v_add_u32 v227, s4, v7
    s_sub_u32 s6, s14, 1
    s_max_i32 s6, s6, 0
    s_cmp_eq_u32 s14, 1
    s_cselect_b32 s6, 3, s6
    s_and_b32 s4, s20, 7
    s_lshl_b32 s4, s4, 4
    s_lshl_b32 s5, s12, 7
    s_add_u32 s4, s4, s5
    v_and_b32 v4, 15, v1
    v_add_u32 v4, s4, v4
    v_mul_u32_u24 v4, 1280, v4
    v_lshrrev_b32 v5, 4, v1
    s_lshl_b32 s5, s6, 2
    v_add_u32 v5, s5, v5
    v_cmp_gt_u32 vcc, 10, v5
    v_lshl_add_u32 v4, v5, 7, v4
    v_mov_b32 v7, 0x7ffffff0
    v_cndmask_b32 v229, v7, v4, vcc
    s_cmp_eq_u32 s14, 3
    s_cbranch_scc0 L_ct_1
    s_getpc_b64 s[30:31]
L_pc:
    s_mul_i32 s4, s20, 14
    v_add_u32 v4, s4, v1
    v_lshlrev_b32_e64 v4, 7, v4
    s_mov_b32 s4, L_end-L_pc
    v_cmp_gt_u32 vcc, s4, v4
    s_nop 1
    v_cndmask_b32_e64 v4, 0, v4, vcc
    s_mov_b64 exec, 0x3fff
    global_load_dword v2, v4, s[30:31]
    s_mov_b64 exec, -1
L_ct_1:
    s_waitcnt lgkmcnt(0)
    s_mov_b32 s32, s80
    s_and_b32 s33, s81, 0xffff
    s_mov_b32 s34, 2621440
    s_mov_b32 s35, 0x20000
    s_mov_b32 s36, s82
    s_and_b32 s37, s83, 0xffff
    s_mov_b32 s38, 2457600
    s_mov_b32 s39, 0x20000
    s_mov_b32 s40, s100
    s_and_b32 s41, s101, 0xffff
    s_mov_b32 s42, 67108864
    s_mov_b32 s43, 0x20000
    s_mov_b32 s44, s98
    s_and_b32 s45, s99, 0xffff
    s_mov_b32 s46, 256
    s_mov_b32 s47, 0x20000
    s_or_b32 s4, s2, s14
    s_cmp_eq_u32 s4, 0
    s_cbranch_scc0 L_nz_2
    v_lshlrev_b32 v4, 8, v1
    v_add_u32 v5, 16384, v4
    v_add_u32 v7, 32768, v4
    v_mov_b32_e64 v6, 0
    buffer_store_dword v6, v4, s[40:43], 0 offen offset:0 sc1
    buffer_store_dword v6, v5, s[40:43], 0 offen offset:0 sc1
    buffer_store_dword v6, v7, s[40:43], 0 offen offset:0 sc1
    s_waitcnt vmcnt(0)
    v_mov_b32 v4, 0
    v_mov_b32 v5, 1
    s_mov_b64 exec, 1
    buffer_store_dword v5, v4, s[44:47], 0 offen sc1
    s_mov_b64 exec, -1
L_nz_2:
    s_and_b32 s22, s14, 1
    s_lshr_b32 s23, s14, 1
    s_lshl_b32 s4, s12, 7
    s_lshl_b32 s5, s14, 5
    s_add_u32 s4, s4, s5
    v_lshrrev_b32 v4, 3, v1
    v_add_u32 v4, s4, v4
    v_mul_u32_u24 v4, 1280, v4
    v_lshrrev_b32 v5, 4, v1
    v_and_b32 v6, 7, v1
    v_xor_b32 v7, v5, v6
    v_xor_b32 v8, 4, v7
    v_lshl_add_u32 v230, v7, 4, v4
    v_lshl_add_u32 v231, v8, 4, v4
    v_add_u32 v231, 9216, v231
    v_lshl_add_u32 v232, v7, 4, v4
    v_add_u32 v232, 18432, v232
    v_lshl_add_u32 v233, v8, 4, v4
    v_add_u32 v233, 27648, v233
    s_lshl_b32 s24, s14, 12
    s_add_u32 s25, s24, 81920
    s_mul_i32 s4, s13, 163840
    s_add_u32 s4, s4, s24
    s_add_u32 s4, s4, 17825792
    v_add_u32_e64 v234, s4, v12
    s_mul_i32 s48, s14, 15360
    s_add_u32 s17, s48, 0
    buffer_load_dwordx4 v[28:31], v228, s[36:39], s17 offen
    s_add_u32 s17, s48, 61440
    buffer_load_dwordx4 v[32:35], v228, s[36:39], s17 offen
    v_mov_b32 v36, 0
    v_mov_b32 v37, 0
    v_mov_b32 v38, 0
    v_mov_b32 v39, 0
    s_cmp_ge_u32 s14, 2
    s_cbranch_scc1 L_r3_3
    s_add_u32 s17, s48, 122880
    buffer_load_dwordx4 v[36:39], v228, s[36:39], s17 offen
L_r3_3:
    buffer_load_dword v2, v229, s[32:35], 0 offen
    s_mov_b32 s52, s84
    s_and_b32 s53, s85, 0xffff
    s_mov_b32 s54, 25600
    s_mov_b32 s55, 0x20000
    s_mov_b32 s56, s86
    s_and_b32 s57, s87, 0xffff
    s_mov_b32 s58, 819200
    s_mov_b32 s59, 0x20000
    s_mov_b32 s60, s90
    s_and_b32 s61, s91, 0xffff
    s_mov_b32 s62, 1966080
    s_mov_b32 s63, 0x20000
    s_mov_b32 s64, s92
    s_and_b32 s65, s93, 0xffff
    s_mov_b32 s66, 1966080
    s_mov_b32 s67, 0x20000
    s_mov_b32 s68, s94
    s_and_b32 s69, s95, 0xffff
    s_mov_b32 s70, 1966080
    s_mov_b32 s71, 0x20000
    s_mov_b32 s72, s96
    s_and_b32 s73, s97, 0xffff
    s_mov_b32 s74, 2621440
    s_mov_b32 s75, 0x20000
    s_mov_b32 s26, 0x3f80
    s_mov_b32 s27, 0x3f800000
    v_and_b32 v4, 31, v1
    s_lshl_b32 s4, s23, 6
    v_add_u32 v5, s4, v4
    v_lshlrev_b32 v5, 7, v5
    v_bfe_u32 v6, v1, 1, 3
    v_lshrrev_b32 v7, 5, v1
    v_xor_b32 v6, v6, v7
    v_xor_b32_e64 v8, 0, v6
    v_lshl_add_u32 v235, v8, 4, v5
    v_add_u32 v239, 65536, v235
    v_xor_b32_e64 v8, 2, v6
    v_lshl_add_u32 v236, v8, 4, v5
    v_add_u32 v240, 65536, v236
    v_xor_b32_e64 v8, 4, v6
    v_lshl_add_u32 v237, v8, 4, v5
    v_add_u32 v241, 65536, v237
    v_xor_b32_e64 v8, 6, v6
    v_lshl_add_u32 v238, v8, 4, v5
    v_add_u32 v242, 65536, v238
    v_lshrrev_b32_e64 v4, 5, v1
    v_bfe_u32 v5, v1, 2, 2
    v_lshl_add_u32 v4, v4, 3, v5
    v_lshlrev_b32_e64 v4, 8, v4
    v_add_u32 v4, 81920, v4
    v_and_b32_e64 v6, 3, v1
    v_bfe_u32 v7, v1, 4, 1
    s_mul_i32 s4, s22, 5
    v_lshlrev_b32 v8, 3, v6
    s_mov_b32 s5, 0x15150e04
    v_lshrrev_b32_e64 v9, v8, s5
    v_and_b32 v9, 0xff, v9
    s_mov_b32 s5, 0x18171614
    v_lshrrev_b32_e64 v11, v8, s5
    v_and_b32 v11, 0xff, v11
    v_cmp_eq_u32 vcc, 1, v7
    s_nop 1
    v_cndmask_b32 v8, v6, v9, vcc
    v_add_u32 v8, s4, v8
    v_add_u32 v9, 10, v6
    v_cndmask_b32 v9, v9, v11, vcc
    v_add_u32 v9, s4, v9
    v_lshlrev_b32 v10, 3, v5
    v_xor_b32_e64 v11, v8, v10
    v_lshl_add_u32 v243, v11, 3, v4
    v_xor_b32_e64 v11, v9, v10
    v_lshl_add_u32 v244, v11, 3, v4
    v_mov_b32 v76, 0
    v_mov_b32 v77, 0
    v_mov_b32 v78, 0
    v_mov_b32 v79, 0
    v_mov_b32 v80, 0
    v_mov_b32 v81, 0
    v_mov_b32 v82, 0
    v_mov_b32 v83, 0
    v_mov_b32 v84, 0
    v_mov_b32 v85, 0
    v_mov_b32 v86, 0
    v_mov_b32 v87, 0
    v_mov_b32 v88, 0
    v_mov_b32 v89, 0
    v_mov_b32 v90, 0
    v_mov_b32 v91, 0
    v_mov_b32 v92, 0
    v_mov_b32 v93, 0
    v_mov_b32 v94, 0
    v_mov_b32 v95, 0
    v_mov_b32 v96, 0
    v_mov_b32 v97, 0
    v_mov_b32 v98, 0
    v_mov_b32 v99, 0
    v_mov_b32 v100, 0
    v_mov_b32 v101, 0
    v_mov_b32 v102, 0
    v_mov_b32 v103, 0
    v_mov_b32 v104, 0
    v_mov_b32 v105, 0
    v_mov_b32 v106, 0
    v_mov_b32 v107, 0
    v_mov_b32 v108, 0
    v_mov_b32 v109, 0
    v_mov_b32 v110, 0
    v_mov_b32 v111, 0
    v_mov_b32 v112, 0
    v_mov_b32 v113, 0
    v_mov_b32 v114, 0
    v_mov_b32 v115, 0
    v_mov_b32 v116, 0
    v_mov_b32 v117, 0
    v_mov_b32 v118, 0
    v_mov_b32 v119, 0
    v_mov_b32 v120, 0
    v_mov_b32 v121, 0
    v_mov_b32 v122, 0
    v_mov_b32 v123, 0
    v_mov_b32 v124, 0
    v_mov_b32 v125, 0
    v_mov_b32 v126, 0
    v_mov_b32 v127, 0
    v_mov_b32 v128, 0
    v_mov_b32 v129, 0
    v_mov_b32 v130, 0
    v_mov_b32 v131, 0
    v_mov_b32 v132, 0
    v_mov_b32 v133, 0
    v_mov_b32 v134, 0
    v_mov_b32 v135, 0
    v_mov_b32 v136, 0
    v_mov_b32 v137, 0
    v_mov_b32 v138, 0
    v_mov_b32 v139, 0
    s_cmp_ge_u32 s14, 2
    s_cbranch_scc1 L_pa23_4
    s_mul_i32 s4, s2, 2185
    s_lshr_b32 s4, s4, 16
    s_mul_i32 s5, s4, 30
    s_sub_u32 s5, s2, s5
    s_lshl_b32 s5, s5, 9
    s_lshl_b32 s7, s14, 8
    s_add_u32 s5, s5, s7
    s_mul_i32 s4, s4, 160
    s_mov_b32 s6, 0x1999999a
    s_cmp_lt_u32 s2, 240
    s_cselect_b32 s4, s4, 0x7ffffff0
    s_mov_b32 s7, 0x15555556
    s_mov_b32 s8, 0x55555556
    v_add_u32_e64 v4, s5, v1
    v_mul_hi_u32 v5, v4, s6
    v_mul_u32_u24 v6, 10, v5
    v_sub_u32 v6, v4, v6
    v_lshrrev_b32_e64 v4, 5, v5
    v_mul_hi_u32 v7, v4, s7
    v_mul_u32_u24 v8, 12, v7
    v_sub_u32 v4, v4, v8
    v_mul_hi_u32 v8, v4, s8
    v_mul_u32_u24 v9, 3, v8
    v_sub_u32 v4, v4, v9
    v_lshrrev_b32_e64 v9, 1, v7
    v_lshl_add_u32 v8, v9, 2, v8
    v_and_b32_e64 v7, 1, v7
    v_bfe_u32 v9, v5, 4, 1
    v_cmp_gt_u32 vcc, 2, v4
    s_nop 1
    v_cndmask_b32 v10, v9, v4, vcc
    v_cndmask_b32 v9, 2, v9, vcc
    v_lshl_add_u32 v8, v8, 1, v10
    v_mul_u32_u24 v8, 6, v8
    v_mul_u32_u24 v7, 3, v7
    v_add3_u32 v8, v8, v7, v9
    v_and_b32_e64 v5, 15, v5
    v_lshl_add_u32 v5, v8, 4, v5
    v_mul_u32_u24 v5, 1280, v5
    v_lshl_add_u32 v5, v6, 4, v5
    v_add_u32 v68, s4, v5
    v_add_u32 v4, s5, v1
    v_add_u32_e64 v4, 64, v4
    v_mul_hi_u32 v5, v4, s6
    v_mul_u32_u24 v6, 10, v5
    v_sub_u32 v6, v4, v6
    v_lshrrev_b32_e64 v4, 5, v5
    v_mul_hi_u32 v7, v4, s7
    v_mul_u32_u24 v8, 12, v7
    v_sub_u32 v4, v4, v8
    v_mul_hi_u32 v8, v4, s8
    v_mul_u32_u24 v9, 3, v8
    v_sub_u32 v4, v4, v9
    v_lshrrev_b32_e64 v9, 1, v7
    v_lshl_add_u32 v8, v9, 2, v8
    v_and_b32_e64 v7, 1, v7
    v_bfe_u32 v9, v5, 4, 1
    v_cmp_gt_u32 vcc, 2, v4
    s_nop 1
    v_cndmask_b32 v10, v9, v4, vcc
    v_cndmask_b32 v9, 2, v9, vcc
    v_lshl_add_u32 v8, v8, 1, v10
    v_mul_u32_u24 v8, 6, v8
    v_mul_u32_u24 v7, 3, v7
    v_add3_u32 v8, v8, v7, v9
    v_and_b32_e64 v5, 15, v5
    v_lshl_add_u32 v5, v8, 4, v5
    v_mul_u32_u24 v5, 1280, v5
    v_lshl_add_u32 v5, v6, 4, v5
    v_add_u32 v69, s4, v5
    v_add_u32 v4, s5, v1
    v_add_u32 v4, 128, v4
    v_mul_hi_u32 v5, v4, s6
    v_mul_u32_u24 v6, 10, v5
    v_sub_u32 v6, v4, v6
    v_lshrrev_b32_e64 v4, 5, v5
    v_mul_hi_u32 v7, v4, s7
    v_mul_u32_u24 v8, 12, v7
    v_sub_u32 v4, v4, v8
    v_mul_hi_u32 v8, v4, s8
    v_mul_u32_u24 v9, 3, v8
    v_sub_u32 v4, v4, v9
    v_lshrrev_b32_e64 v9, 1, v7
    v_lshl_add_u32 v8, v9, 2, v8
    v_and_b32_e64 v7, 1, v7
    v_bfe_u32 v9, v5, 4, 1
    v_cmp_gt_u32 vcc, 2, v4
    s_nop 1
    v_cndmask_b32 v10, v9, v4, vcc
    v_cndmask_b32 v9, 2, v9, vcc
    v_lshl_add_u32 v8, v8, 1, v10
    v_mul_u32_u24 v8, 6, v8
    v_mul_u32_u24 v7, 3, v7
    v_add3_u32 v8, v8, v7, v9
    v_and_b32_e64 v5, 15, v5
    v_lshl_add_u32 v5, v8, 4, v5
    v_mul_u32_u24 v5, 1280, v5
    v_lshl_add_u32 v5, v6, 4, v5
    v_add_u32 v70, s4, v5
    v_add_u32 v4, s5, v1
    v_add_u32 v4, 192, v4
    v_mul_hi_u32 v5, v4, s6
    v_mul_u32_u24 v6, 10, v5
    v_sub_u32 v6, v4, v6
    v_lshrrev_b32_e64 v4, 5, v5
    v_mul_hi_u32 v7, v4, s7
    v_mul_u32_u24 v8, 12, v7
    v_sub_u32 v4, v4, v8
    v_mul_hi_u32 v8, v4, s8
    v_mul_u32_u24 v9, 3, v8
    v_sub_u32 v4, v4, v9
    v_lshrrev_b32_e64 v9, 1, v7
    v_lshl_add_u32 v8, v9, 2, v8
    v_and_b32_e64 v7, 1, v7
    v_bfe_u32 v9, v5, 4, 1
    v_cmp_gt_u32 vcc, 2, v4
    s_nop 1
    v_cndmask_b32 v10, v9, v4, vcc
    v_cndmask_b32 v9, 2, v9, vcc
    v_lshl_add_u32 v8, v8, 1, v10
    v_mul_u32_u24 v8, 6, v8
    v_mul_u32_u24 v7, 3, v7
    v_add3_u32 v8, v8, v7, v9
    v_and_b32_e64 v5, 15, v5
    v_lshl_add_u32 v5, v8, 4, v5
    v_mul_u32_u24 v5, 1280, v5
    v_lshl_add_u32 v5, v6, 4, v5
    v_add_u32 v71, s4, v5
    s_lshl_b32 s4, s2, 13
    s_lshl_b32 s5, s14, 12
    s_add_u32 s4, s4, s5
    s_add_u32 s4, s4, 25165824
    s_cmp_lt_u32 s2, 240
    s_cselect_b32 s4, s4, 0x7ffffff0
    v_add_u32 v72, s4, v12
    s_branch L_pae_5
L_pa23_4:
    v_lshrrev_b32 v5, 4, v1
    v_and_b32 v6, 15, v1
    s_mul_i32 s4, s12, 40
    v_add_u32 v4, s4, v5
    s_lshl_b32 s6, s13, 4
    s_add_u32 s6, s6, s12
    v_lshlrev_b32 v10, 5, v6
    v_cmp_eq_u32 vcc, 0, v5
    v_mov_b32 v11, 0x7ffffff0
    s_nop 0
    v_cndmask_b32 v10, v11, v10, vcc
    v_mul_u32_u24 v4, 3072, v4
    s_mul_i32 s5, s13, 192
    v_lshlrev_b32_e64 v8, 4, v6
    v_add3_u32 v4, v4, v8, s5
    v_cmp_gt_u32 vcc, 12, v6
    s_nop 1
    v_cndmask_b32 v4, v11, v4, vcc
    s_lshl_b32 s6, s6, 1
    s_add_u32 s6, s6, s14
    s_sub_u32 s6, s6, 2
    s_lshl_b32 s6, s6, 9
    s_add_u32 s6, s6, 262144
    v_add_u32 v70, s6, v10
    v_mov_b32 v68, v4
    s_sub_u32 s4, s14, 2
    v_cmp_le_u32 vcc, 6, v6
    v_subrev_u32 v8, 6, v6
    s_nop 0
    v_cndmask_b32 v7, v6, v8, vcc
    v_lshlrev_b32_e64 v7, 4, v7
    v_add_u32 v8, 122880, v7
    v_cndmask_b32_e64 v7, v7, v8, vcc
    v_mul_u32_u24 v8, 96, v5
    s_mul_i32 s4, s4, 6144
    s_mul_i32 s5, s13, 245760
    s_add_u32 s4, s4, s5
    s_add_u32 s4, s4, 20971520
    v_add3_u32 v7, v7, v8, s4
    v_cmp_gt_u32 vcc, 12, v6
    v_mov_b32 v8, 0x7ffffff0
    s_nop 0
    v_cndmask_b32 v69, v8, v7, vcc
    v_mov_b32 v71, 0
    v_mov_b32 v72, 0
L_pae_5:
    v_mov_b32 v52, 0x7ffffff0
    v_mov_b32 v53, 0x7ffffff0
    v_mov_b32 v54, 0x7ffffff0
    v_mov_b32 v55, 0x7ffffff0
    v_mov_b32 v56, 0x7ffffff0
    s_waitcnt vmcnt(1)
    s_lshl_b32 s48, s14, 10
    s_add_u32 s17, s48, 0
    buffer_store_dwordx4 v[28:31], v227, s[40:43], s17 offen sc1
    s_add_u32 s17, s48, 4096
    buffer_store_dwordx4 v[32:35], v227, s[40:43], s17 offen sc1
    s_cmp_ge_u32 s14, 2
    s_cbranch_scc1 L_r3s_6
    s_add_u32 s17, s48, 8192
    buffer_store_dwordx4 v[36:39], v227, s[40:43], s17 offen sc1
L_r3s_6:
    v_mov_b32 v4, 0
    buffer_load_dword v245, v4, s[44:47], 0 offen sc1
    v_mov_b32 v188, 0
    v_mov_b32 v189, 0
    v_mov_b32 v190, 0
    v_mov_b32 v191, 0
    v_mov_b32 v192, 0
    v_mov_b32 v193, 0
    v_mov_b32 v194, 0
    v_mov_b32 v195, 0
    v_dot2c_f32_bf16 v188, s26, v28
    v_dot2c_f32_bf16 v189, s27, v28
    v_dot2c_f32_bf16 v190, s26, v29
    v_dot2c_f32_bf16 v191, s27, v29
    v_dot2c_f32_bf16 v192, s26, v30
    v_dot2c_f32_bf16 v193, s27, v30
    v_dot2c_f32_bf16 v194, s26, v31
    v_dot2c_f32_bf16 v195, s27, v31
    v_dot2c_f32_bf16 v188, s26, v32
    v_dot2c_f32_bf16 v189, s27, v32
    v_dot2c_f32_bf16 v190, s26, v33
    v_dot2c_f32_bf16 v191, s27, v33
    v_dot2c_f32_bf16 v192, s26, v34
    v_dot2c_f32_bf16 v193, s27, v34
    v_dot2c_f32_bf16 v194, s26, v35
    v_dot2c_f32_bf16 v195, s27, v35
    v_dot2c_f32_bf16 v188, s26, v36
    v_dot2c_f32_bf16 v189, s27, v36
    v_dot2c_f32_bf16 v190, s26, v37
    v_dot2c_f32_bf16 v191, s27, v37
    v_dot2c_f32_bf16 v192, s26, v38
    v_dot2c_f32_bf16 v193, s27, v38
    v_dot2c_f32_bf16 v194, s26, v39
    v_dot2c_f32_bf16 v195, s27, v39
    v_mov_b32 v196, v188
    v_mov_b32 v197, v189
    v_mov_b32 v198, v190
    v_mov_b32 v199, v191
    v_mov_b32 v200, v192
    v_mov_b32 v201, v193
    v_mov_b32 v202, v194
    v_mov_b32 v203, v195
    v_permlane32_swap_b32 v196, v188
    v_permlane32_swap_b32 v197, v189
    v_permlane32_swap_b32 v198, v190
    v_permlane32_swap_b32 v199, v191
    v_permlane32_swap_b32 v200, v192
    v_permlane32_swap_b32 v201, v193
    v_permlane32_swap_b32 v202, v194
    v_permlane32_swap_b32 v203, v195
    v_add_f32 v188, v188, v196
    v_add_f32 v189, v189, v197
    v_add_f32 v190, v190, v198
    v_add_f32 v191, v191, v199
    v_add_f32 v192, v192, v200
    v_add_f32 v193, v193, v201
    v_add_f32 v194, v194, v202
    v_add_f32 v195, v195, v203
    v_mov_b32 v196, v188
    v_mov_b32 v197, v189
    v_mov_b32 v198, v190
    v_mov_b32 v199, v191
    v_mov_b32 v200, v192
    v_mov_b32 v201, v193
    v_mov_b32 v202, v194
    v_mov_b32 v203, v195
    v_permlane16_swap_b32 v196, v188
    v_permlane16_swap_b32 v197, v189
    v_permlane16_swap_b32 v198, v190
    v_permlane16_swap_b32 v199, v191
    v_permlane16_swap_b32 v200, v192
    v_permlane16_swap_b32 v201, v193
    v_permlane16_swap_b32 v202, v194
    v_permlane16_swap_b32 v203, v195
    v_add_f32 v188, v188, v196
    v_add_f32 v189, v189, v197
    v_add_f32 v190, v190, v198
    v_add_f32 v191, v191, v199
    v_add_f32 v192, v192, v200
    v_add_f32 v193, v193, v201
    v_add_f32 v194, v194, v202
    v_add_f32 v195, v195, v203
    s_lshl_b32 s4, s14, 9
    s_add_u32 s4, s4, 161792
    v_lshl_add_u32 v4, v1, 5, s4
    s_mov_b64 exec, 0xffff
    ds_write_b128 v4, v[188:191]
    ds_write_b128 v4, v[192:195] offset:16
    s_mov_b64 exec, -1
    s_waitcnt vmcnt(0) lgkmcnt(0)
    s_barrier
    s_cmp_eq_u32 s14, 1
    s_cbranch_scc0 L_pw0_7
    v_readfirstlane_b32 s4, v245
    s_mov_b32 s19, 0
    s_cmp_eq_u32 s4, 1
    s_cbranch_scc1 L_flok_12
L_fl_11:
    s_sleep 8
    v_mov_b32 v4, 0
    buffer_load_dword v245, v4, s[44:47], 0 offen sc1
    s_waitcnt vmcnt(0)
    v_readfirstlane_b32 s4, v245
    s_add_u32 s19, s19, 1
    s_cmp_eq_u32 s4, 1
    s_cbranch_scc1 L_flok_12
    s_cmp_lt_u32 s19, 200000
    s_cbranch_scc1 L_fl_11
L_flok_12:
    s_lshl_b32 s4, s13, 8
    s_add_u32 s4, s4, 28672
    v_mov_b32 v8, s4
    v_mov_b32 v6, 1
    s_mov_b64 exec, 1
    buffer_atomic_add v6, v8, s[40:43], 0 offen sc1
    s_mov_b64 exec, -1
    s_mov_b32 s17, 0
    s_add_u32 m0, s24, 0
    s_nop 0
    buffer_load_dwordx4 v230, s[32:35], s17 offen lds
    buffer_load_dwordx4 v231, s[32:35], s17 offen offset:1024 lds
    buffer_load_dwordx4 v232, s[32:35], s17 offen offset:2048 lds
    buffer_load_dwordx4 v233, s[32:35], s17 offen offset:3072 lds
    s_mov_b32 s17, 128
    s_add_u32 m0, s24, 16384
    s_nop 0
    buffer_load_dwordx4 v230, s[32:35], s17 offen lds
    buffer_load_dwordx4 v231, s[32:35], s17 offen offset:1024 lds
    buffer_load_dwordx4 v232, s[32:35], s17 offen offset:2048 lds
    buffer_load_dwordx4 v233, s[32:35], s17 offen offset:3072 lds
    s_mov_b32 s17, 256
    s_add_u32 m0, s24, 32768
    s_nop 0
    buffer_load_dwordx4 v230, s[32:35], s17 offen lds
    buffer_load_dwordx4 v231, s[32:35], s17 offen offset:1024 lds
    buffer_load_dwordx4 v232, s[32:35], s17 offen offset:2048 lds
    buffer_load_dwordx4 v233, s[32:35], s17 offen offset:3072 lds
    s_mov_b32 s17, 384
    s_add_u32 m0, s24, 49152
    s_nop 0
    buffer_load_dwordx4 v230, s[32:35], s17 offen lds
    buffer_load_dwordx4 v231, s[32:35], s17 offen offset:1024 lds
    buffer_load_dwordx4 v232, s[32:35], s17 offen offset:2048 lds
    buffer_load_dwordx4 v233, s[32:35], s17 offen offset:3072 lds
    s_mov_b32 s17, 512
    s_add_u32 m0, s24, 65536
    s_nop 0
    buffer_load_dwordx4 v230, s[32:35], s17 offen lds
    buffer_load_dwordx4 v231, s[32:35], s17 offen offset:1024 lds
    buffer_load_dwordx4 v232, s[32:35], s17 offen offset:2048 lds
    buffer_load_dwordx4 v233, s[32:35], s17 offen offset:3072 lds
    s_mov_b32 s19, 0
L_pkp_13:
    buffer_load_dword v245, v8, s[40:43], 0 offen sc1
    s_waitcnt vmcnt(0)
    v_readfirstlane_b32 s4, v245
    s_add_u32 s19, s19, 1
    s_cmp_ge_u32 s4, 16
    s_cbranch_scc1 L_pko_14
    s_cmp_lt_u32 s19, 200000
    s_cbranch_scc1 L_pkp_13
L_pko_14:
    v_add_u32 v4, 161792, v12
    ds_read_b128 v[188:191], v4 offset:0
    ds_read_b128 v[192:195], v4 offset:512
    ds_read_b128 v[196:199], v4 offset:1024
    ds_read_b128 v[200:203], v4 offset:1536
    s_waitcnt lgkmcnt(0)
    v_pk_add_f32 v[188:189], v[188:189], v[192:193]
    v_pk_add_f32 v[190:191], v[190:191], v[194:195]
    v_pk_add_f32 v[188:189], v[188:189], v[196:197]
    v_pk_add_f32 v[190:191], v[190:191], v[198:199]
    v_pk_add_f32 v[188:189], v[188:189], v[200:201]
    v_pk_add_f32 v[190:191], v[190:191], v[202:203]
    s_lshl_b32 s6, s13, 4
    s_add_u32 s6, s6, s12
    s_lshl_b32 s6, s6, 9
    s_add_u32 s6, s6, 131072
    v_add_u32 v4, s6, v12
    s_mov_b32 exec_hi, 0
    buffer_store_dwordx4 v[188:191], v4, s[40:43], 0 offen sc1
    s_mov_b64 exec, -1
    s_branch L_pwe_9
L_pw0_7:
    s_mov_b32 s17, 0
    s_add_u32 m0, s24, 0
    s_nop 0
    buffer_load_dwordx4 v230, s[32:35], s17 offen lds
    buffer_load_dwordx4 v231, s[32:35], s17 offen offset:1024 lds
    buffer_load_dwordx4 v232, s[32:35], s17 offen offset:2048 lds
    buffer_load_dwordx4 v233, s[32:35], s17 offen offset:3072 lds
    s_mov_b32 s17, 128
    s_add_u32 m0, s24, 16384
    s_nop 0
    buffer_load_dwordx4 v230, s[32:35], s17 offen lds
    buffer_load_dwordx4 v231, s[32:35], s17 offen offset:1024 lds
    buffer_load_dwordx4 v232, s[32:35], s17 offen offset:2048 lds
    buffer_load_dwordx4 v233, s[32:35], s17 offen offset:3072 lds
    s_mov_b32 s17, 256
    s_add_u32 m0, s24, 32768
    s_nop 0
    buffer_load_dwordx4 v230, s[32:35], s17 offen lds
    buffer_load_dwordx4 v231, s[32:35], s17 offen offset:1024 lds
    buffer_load_dwordx4 v232, s[32:35], s17 offen offset:2048 lds
    buffer_load_dwordx4 v233, s[32:35], s17 offen offset:3072 lds
    s_mov_b32 s17, 384
    s_add_u32 m0, s24, 49152
    s_nop 0
    buffer_load_dwordx4 v230, s[32:35], s17 offen lds
    buffer_load_dwordx4 v231, s[32:35], s17 offen offset:1024 lds
    buffer_load_dwordx4 v232, s[32:35], s17 offen offset:2048 lds
    buffer_load_dwordx4 v233, s[32:35], s17 offen offset:3072 lds
    s_mov_b32 s17, 512
    s_add_u32 m0, s24, 65536
    s_nop 0
    buffer_load_dwordx4 v230, s[32:35], s17 offen lds
    buffer_load_dwordx4 v231, s[32:35], s17 offen offset:1024 lds
    buffer_load_dwordx4 v232, s[32:35], s17 offen offset:2048 lds
    buffer_load_dwordx4 v233, s[32:35], s17 offen offset:3072 lds
    s_cmp_eq_u32 s14, 0
    s_cbranch_scc0 L_pw3_10
    s_lshl_b32 s4, s12, 7
    s_lshl_b32 s5, s13, 3
    s_add_u32 s4, s4, s5
    v_lshrrev_b32 v4, 3, v1
    v_add_u32 v4, s4, v4
    v_and_b32 v6, 7, v1
    v_lshlrev_b32_e64 v8, 3, v4
    v_add_u32 v8, 65536, v8
    v_mov_b32 v11, 0x7ffffff0
    v_cmp_eq_u32 vcc, 0, v6
    s_nop 1
    v_cndmask_b32_e64 v226, v11, v8, vcc
    v_mul_u32_u24 v4, 1280, v4
    v_lshl_add_u32 v228, v6, 4, v4
    buffer_load_dwordx4 v[28:31], v228, s[32:35], 0 offen offset:0
    buffer_load_dwordx4 v[32:35], v228, s[32:35], 0 offen offset:128
    buffer_load_dwordx4 v[36:39], v228, s[32:35], 0 offen offset:256
    buffer_load_dwordx4 v[40:43], v228, s[32:35], 0 offen offset:384
    buffer_load_dwordx4 v[44:47], v228, s[32:35], 0 offen offset:512
    buffer_load_dwordx4 v[48:51], v228, s[32:35], 0 offen offset:640
    buffer_load_dwordx4 v[52:55], v228, s[32:35], 0 offen offset:768
    buffer_load_dwordx4 v[56:59], v228, s[32:35], 0 offen offset:896
    buffer_load_dwordx4 v[60:63], v228, s[32:35], 0 offen offset:1024
    buffer_load_dwordx4 v[64:67], v228, s[32:35], 0 offen offset:1152
    s_mov_b32 s8, 0x3f803f80
    v_mov_b32 v188, 0
    v_mov_b32 v189, 0
    v_mov_b32 v190, 0
    v_mov_b32 v191, 0
    s_waitcnt vmcnt(0)
    v_dot2c_f32_bf16 v188, s8, v28
    v_dot2c_f32_bf16 v190, v28, v28
    v_dot2c_f32_bf16 v189, s8, v29
    v_dot2c_f32_bf16 v191, v29, v29
    v_dot2c_f32_bf16 v188, s8, v30
    v_dot2c_f32_bf16 v190, v30, v30
    v_dot2c_f32_bf16 v189, s8, v31
    v_dot2c_f32_bf16 v191, v31, v31
    v_dot2c_f32_bf16 v188, s8, v32
    v_dot2c_f32_bf16 v190, v32, v32
    v_dot2c_f32_bf16 v189, s8, v33
    v_dot2c_f32_bf16 v191, v33, v33
    v_dot2c_f32_bf16 v188, s8, v34
    v_dot2c_f32_bf16 v190, v34, v34
    v_dot2c_f32_bf16 v189, s8, v35
    v_dot2c_f32_bf16 v191, v35, v35
    v_dot2c_f32_bf16 v188, s8, v36
    v_dot2c_f32_bf16 v190, v36, v36
    v_dot2c_f32_bf16 v189, s8, v37
    v_dot2c_f32_bf16 v191, v37, v37
    v_dot2c_f32_bf16 v188, s8, v38
    v_dot2c_f32_bf16 v190, v38, v38
    v_dot2c_f32_bf16 v189, s8, v39
    v_dot2c_f32_bf16 v191, v39, v39
    v_dot2c_f32_bf16 v188, s8, v40
    v_dot2c_f32_bf16 v190, v40, v40
    v_dot2c_f32_bf16 v189, s8, v41
    v_dot2c_f32_bf16 v191, v41, v41
    v_dot2c_f32_bf16 v188, s8, v42
    v_dot2c_f32_bf16 v190, v42, v42
    v_dot2c_f32_bf16 v189, s8, v43
    v_dot2c_f32_bf16 v191, v43, v43
    v_dot2c_f32_bf16 v188, s8, v44
    v_dot2c_f32_bf16 v190, v44, v44
    v_dot2c_f32_bf16 v189, s8, v45
    v_dot2c_f32_bf16 v191, v45, v45
    v_dot2c_f32_bf16 v188, s8, v46
    v_dot2c_f32_bf16 v190, v46, v46
    v_dot2c_f32_bf16 v189, s8, v47
    v_dot2c_f32_bf16 v191, v47, v47
    v_dot2c_f32_bf16 v188, s8, v48
    v_dot2c_f32_bf16 v190, v48, v48
    v_dot2c_f32_bf16 v189, s8, v49
    v_dot2c_f32_bf16 v191, v49, v49
    v_dot2c_f32_bf16 v188, s8, v50
    v_dot2c_f32_bf16 v190, v50, v50
    v_dot2c_f32_bf16 v189, s8, v51
    v_dot2c_f32_bf16 v191, v51, v51
    v_dot2c_f32_bf16 v188, s8, v52
    v_dot2c_f32_bf16 v190, v52, v52
    v_dot2c_f32_bf16 v189, s8, v53
    v_dot2c_f32_bf16 v191, v53, v53
    v_dot2c_f32_bf16 v188, s8, v54
    v_dot2c_f32_bf16 v190, v54, v54
    v_dot2c_f32_bf16 v189, s8, v55
    v_dot2c_f32_bf16 v191, v55, v55
    v_dot2c_f32_bf16 v188, s8, v56
    v_dot2c_f32_bf16 v190, v56, v56
    v_dot2c_f32_bf16 v189, s8, v57
    v_dot2c_f32_bf16 v191, v57, v57
    v_dot2c_f32_bf16 v188, s8, v58
    v_dot2c_f32_bf16 v190, v58, v58
    v_dot2c_f32_bf16 v189, s8, v59
    v_dot2c_f32_bf16 v191, v59, v59
    v_dot2c_f32_bf16 v188, s8, v60
    v_dot2c_f32_bf16 v190, v60, v60
    v_dot2c_f32_bf16 v189, s8, v61
    v_dot2c_f32_bf16 v191, v61, v61
    v_dot2c_f32_bf16 v188, s8, v62
    v_dot2c_f32_bf16 v190, v62, v62
    v_dot2c_f32_bf16 v189, s8, v63
    v_dot2c_f32_bf16 v191, v63, v63
    v_dot2c_f32_bf16 v188, s8, v64
    v_dot2c_f32_bf16 v190, v64, v64
    v_dot2c_f32_bf16 v189, s8, v65
    v_dot2c_f32_bf16 v191, v65, v65
    v_dot2c_f32_bf16 v188, s8, v66
    v_dot2c_f32_bf16 v190, v66, v66
    v_dot2c_f32_bf16 v189, s8, v67
    v_dot2c_f32_bf16 v191, v67, v67
    s_nop 1
    v_add_f32 v188, v188, v189
    v_add_f32 v190, v190, v191
    s_nop 0
    v_add_f32_dpp v188, v188, v188 quad_perm:[1,0,3,2] row_mask:0xf bank_mask:0xf
    v_add_f32_dpp v190, v190, v190 quad_perm:[1,0,3,2] row_mask:0xf bank_mask:0xf
    s_nop 0
    v_add_f32_dpp v188, v188, v188 quad_perm:[2,3,0,1] row_mask:0xf bank_mask:0xf
    v_add_f32_dpp v190, v190, v190 quad_perm:[2,3,0,1] row_mask:0xf bank_mask:0xf
    s_nop 0
    s_nop 0
    v_add_f32_dpp v188, v188, v188 row_half_mirror row_mask:0xf bank_mask:0xf
    v_add_f32_dpp v190, v190, v190 row_half_mirror row_mask:0xf bank_mask:0xf
    v_mul_f32 v188, 0x3acccccd, v188
    v_mul_f32 v190, 0x3acccccd, v190
    v_fma_f32 v190, -v188, v188, v190
    v_max_f32_e64 v190, 0, v190
    v_add_f32 v190, 0x3727c5ac, v190
    v_rsq_f32_e64 v189, v190
    buffer_store_dwordx2 v[188:189], v226, s[40:43], 0 offen sc1
    s_branch L_pwe_9
L_pw3_10:
    s_cmp_eq_u32 s14, 3
    s_cbranch_scc0 L_pwe_9
    s_mul_i32 s4, s2, 2622
    s_lshr_b32 s4, s4, 16
    s_mul_i32 s5, s4, 25
    s_sub_u32 s5, s2, s5
    s_lshl_b32 s5, s5, 8
    s_mul_i32 s4, s4, 160
    s_cmp_lt_u32 s2, 200
    s_cselect_b32 s4, s4, 0x7ffffff0
    s_mov_b32 s6, 0x1999999a
    v_add_u32 v4, s5, v1
    v_mul_hi_u32 v5, v4, s6
    v_mul_u32_u24 v6, 10, v5
    v_sub_u32 v6, v4, v6
    v_bfe_u32 v8, v5, 2, 1
    v_bfe_u32 v9, v5, 3, 1
    v_and_b32_e64 v7, 0xfffffff3, v5
    v_lshl_or_b32 v7, v8, 3, v7
    v_lshl_or_b32 v5, v9, 2, v7
    v_mul_u32_u24 v5, 1280, v5
    v_lshl_add_u32 v5, v6, 4, v5
    v_add_u32 v52, s4, v5
    v_add_u32 v4, s5, v1
    v_add_u32_e64 v4, 64, v4
    v_mul_hi_u32 v5, v4, s6
    v_mul_u32_u24 v6, 10, v5
    v_sub_u32 v6, v4, v6
    v_bfe_u32 v8, v5, 2, 1
    v_bfe_u32 v9, v5, 3, 1
    v_and_b32_e64 v7, 0xfffffff3, v5
    v_lshl_or_b32 v7, v8, 3, v7
    v_lshl_or_b32 v5, v9, 2, v7
    v_mul_u32_u24 v5, 1280, v5
    v_lshl_add_u32 v5, v6, 4, v5
    v_add_u32 v53, s4, v5
    v_add_u32 v4, s5, v1
    v_add_u32 v4, 128, v4
    v_mul_hi_u32 v5, v4, s6
    v_mul_u32_u24 v6, 10, v5
    v_sub_u32 v6, v4, v6
    v_bfe_u32 v8, v5, 2, 1
    v_bfe_u32 v9, v5, 3, 1
    v_and_b32_e64 v7, 0xfffffff3, v5
    v_lshl_or_b32 v7, v8, 3, v7
    v_lshl_or_b32 v5, v9, 2, v7
    v_mul_u32_u24 v5, 1280, v5
    v_lshl_add_u32 v5, v6, 4, v5
    v_add_u32 v54, s4, v5
    v_add_u32 v4, s5, v1
    v_add_u32 v4, 192, v4
    v_mul_hi_u32 v5, v4, s6
    v_mul_u32_u24 v6, 10, v5
    v_sub_u32 v6, v4, v6
    v_bfe_u32 v8, v5, 2, 1
    v_bfe_u32 v9, v5, 3, 1
    v_and_b32_e64 v7, 0xfffffff3, v5
    v_lshl_or_b32 v7, v8, 3, v7
    v_lshl_or_b32 v5, v9, 2, v7
    v_mul_u32_u24 v5, 1280, v5
    v_lshl_add_u32 v5, v6, 4, v5
    v_add_u32 v55, s4, v5
    s_lshl_b32 s4, s2, 12
    s_add_u32 s4, s4, 27262976
    s_cmp_lt_u32 s2, 200
    s_cselect_b32 s4, s4, 0x7ffffff0
    v_add_u32 v56, s4, v12
L_pwe_9:
    s_barrier
    s_mov_b32 s18, 0
    s_add_u32 m0, s25, 0
    s_nop 0
    buffer_load_dwordx4 v234, s[40:43], s18 offen sc1 lds
    buffer_load_dwordx4 v234, s[40:43], s18 offen offset:1024 sc1 lds
    buffer_load_dwordx4 v234, s[40:43], s18 offen offset:2048 sc1 lds
    buffer_load_dwordx4 v234, s[40:43], s18 offen offset:3072 sc1 lds
    s_mov_b32 s18, 16384
    s_add_u32 m0, s25, 16384
    s_nop 0
    buffer_load_dwordx4 v234, s[40:43], s18 offen sc1 lds
    buffer_load_dwordx4 v234, s[40:43], s18 offen offset:1024 sc1 lds
    buffer_load_dwordx4 v234, s[40:43], s18 offen offset:2048 sc1 lds
    buffer_load_dwordx4 v234, s[40:43], s18 offen offset:3072 sc1 lds
    s_mov_b32 s18, 32768
    s_add_u32 m0, s25, 32768
    s_nop 0
    buffer_load_dwordx4 v234, s[40:43], s18 offen sc1 lds
    buffer_load_dwordx4 v234, s[40:43], s18 offen offset:1024 sc1 lds
    buffer_load_dwordx4 v234, s[40:43], s18 offen offset:2048 sc1 lds
    buffer_load_dwordx4 v234, s[40:43], s18 offen offset:3072 sc1 lds
    s_waitcnt vmcnt(8)
    s_barrier
    ds_read_b64_tr_b16 v[140:141], v243 offset:0
    ds_read_b64_tr_b16 v[142:143], v243 offset:1024
    ds_read_b128 v[148:151], v235 offset:0
    ds_read_b128 v[152:155], v235 offset:4096
    ds_read_b64_tr_b16 v[144:145], v244 offset:0
    ds_read_b64_tr_b16 v[146:147], v244 offset:1024
    ds_read_b64_tr_b16 v[156:157], v243 offset:4096
    ds_read_b64_tr_b16 v[158:159], v243 offset:5120
    ds_read_b128 v[164:167], v236 offset:0
    ds_read_b128 v[168:171], v236 offset:4096
    ds_read_b64_tr_b16 v[160:161], v244 offset:4096
    ds_read_b64_tr_b16 v[162:163], v244 offset:5120
    s_cmp_lg_u32 s14, 0
    s_cbranch_scc1 L_s0sig_15
    v_mov_b32 v8, 1
    s_lshl_b32 s4, s12, 8
    s_add_u32 s4, s4, 0
    v_mov_b32 v4, s4
    s_lshl_b32 s4, s13, 8
    s_add_u32 s4, s4, 4096
    v_mov_b32 v5, s4
    s_mov_b64 exec, 1
    buffer_atomic_add v8, v4, s[40:43], 0 offen sc1
    buffer_atomic_add v8, v5, s[40:43], 0 offen sc1
    s_mov_b64 exec, -1
L_s0sig_15:
    s_waitcnt lgkmcnt(6)
    v_mfma_f32_32x32x16_bf16 v[76:91], v[140:143], v[148:151], v[76:91]
    ds_read_b64_tr_b16 v[172:173], v243 offset:8192
    ds_read_b64_tr_b16 v[174:175], v243 offset:9216
    v_mfma_f32_32x32x16_bf16 v[92:107], v[140:143], v[152:155], v[92:107]
    ds_read_b128 v[180:183], v237 offset:0
    ds_read_b128 v[184:187], v237 offset:4096
    v_mfma_f32_32x32x16_bf16 v[108:123], v[144:147], v[148:151], v[108:123]
    ds_read_b64_tr_b16 v[176:177], v244 offset:8192
    s_mov_b32 s18, 49152
    s_add_u32 m0, s25, 49152
    s_nop 0
    buffer_load_dwordx4 v234, s[40:43], s18 offen sc1 lds
    v_mfma_f32_32x32x16_bf16 v[124:139], v[144:147], v[152:155], v[124:139]
    ds_read_b64_tr_b16 v[178:179], v244 offset:9216
    buffer_load_dwordx4 v234, s[40:43], s18 offen offset:1024 sc1 lds
    s_waitcnt vmcnt(6) lgkmcnt(6)
    s_barrier
    v_mfma_f32_32x32x16_bf16 v[76:91], v[156:159], v[164:167], v[76:91]
    ds_read_b64_tr_b16 v[140:141], v243 offset:12288
    ds_read_b64_tr_b16 v[142:143], v243 offset:13312
    v_mfma_f32_32x32x16_bf16 v[92:107], v[156:159], v[168:171], v[92:107]
    ds_read_b128 v[148:151], v238 offset:0
    ds_read_b128 v[152:155], v238 offset:4096
    v_mfma_f32_32x32x16_bf16 v[108:123], v[160:163], v[164:167], v[108:123]
    ds_read_b64_tr_b16 v[144:145], v244 offset:12288
    buffer_load_dwordx4 v234, s[40:43], s18 offen offset:2048 sc1 lds
    v_mfma_f32_32x32x16_bf16 v[124:139], v[160:163], v[168:171], v[124:139]
    ds_read_b64_tr_b16 v[146:147], v244 offset:13312
    buffer_load_dwordx4 v234, s[40:43], s18 offen offset:3072 sc1 lds
    s_cmp_eq_u32 s14, 3
    s_cbranch_scc0 L_wol_16
    buffer_load_dwordx4 a[40:43], v52, s[56:59], 0 offen
    buffer_load_dwordx4 a[44:47], v53, s[56:59], 0 offen
    buffer_load_dwordx4 a[48:51], v54, s[56:59], 0 offen
    buffer_load_dwordx4 a[52:55], v55, s[56:59], 0 offen
L_wol_16:
    s_waitcnt lgkmcnt(6)
    v_mfma_f32_32x32x16_bf16 v[76:91], v[172:175], v[180:183], v[76:91]
    ds_read_b64_tr_b16 v[156:157], v243 offset:16384
    ds_read_b64_tr_b16 v[158:159], v243 offset:17408
    v_mfma_f32_32x32x16_bf16 v[92:107], v[172:175], v[184:187], v[92:107]
    ds_read_b128 v[164:167], v235 offset:16384
    ds_read_b128 v[168:171], v235 offset:20480
    v_mfma_f32_32x32x16_bf16 v[108:123], v[176:179], v[180:183], v[108:123]
    ds_read_b64_tr_b16 v[160:161], v244 offset:16384
    v_mfma_f32_32x32x16_bf16 v[124:139], v[176:179], v[184:187], v[124:139]
    ds_read_b64_tr_b16 v[162:163], v244 offset:17408
    s_waitcnt lgkmcnt(6)
    v_mfma_f32_32x32x16_bf16 v[76:91], v[140:143], v[148:151], v[76:91]
    ds_read_b64_tr_b16 v[172:173], v243 offset:20480
    ds_read_b64_tr_b16 v[174:175], v243 offset:21504
    v_mfma_f32_32x32x16_bf16 v[92:107], v[140:143], v[152:155], v[92:107]
    ds_read_b128 v[180:183], v236 offset:16384
    ds_read_b128 v[184:187], v236 offset:20480
    v_mfma_f32_32x32x16_bf16 v[108:123], v[144:147], v[148:151], v[108:123]
    ds_read_b64_tr_b16 v[176:177], v244 offset:20480
    v_mfma_f32_32x32x16_bf16 v[124:139], v[144:147], v[152:155], v[124:139]
    ds_read_b64_tr_b16 v[178:179], v244 offset:21504
    s_waitcnt lgkmcnt(6)
    v_mfma_f32_32x32x16_bf16 v[76:91], v[156:159], v[164:167], v[76:91]
    ds_read_b64_tr_b16 v[140:141], v243 offset:24576
    ds_read_b64_tr_b16 v[142:143], v243 offset:25600
    v_mfma_f32_32x32x16_bf16 v[92:107], v[156:159], v[168:171], v[92:107]
    ds_read_b128 v[148:151], v237 offset:16384
    ds_read_b128 v[152:155], v237 offset:20480
    v_mfma_f32_32x32x16_bf16 v[108:123], v[160:163], v[164:167], v[108:123]
    ds_read_b64_tr_b16 v[144:145], v244 offset:24576
    v_mfma_f32_32x32x16_bf16 v[124:139], v[160:163], v[168:171], v[124:139]
    ds_read_b64_tr_b16 v[146:147], v244 offset:25600
    s_waitcnt vmcnt(4) lgkmcnt(6)
    s_barrier
    v_mfma_f32_32x32x16_bf16 v[76:91], v[172:175], v[180:183], v[76:91]
    ds_read_b64_tr_b16 v[156:157], v243 offset:28672
    ds_read_b64_tr_b16 v[158:159], v243 offset:29696
    v_mfma_f32_32x32x16_bf16 v[92:107], v[172:175], v[184:187], v[92:107]
    ds_read_b128 v[164:167], v238 offset:16384
    ds_read_b128 v[168:171], v238 offset:20480
    v_mfma_f32_32x32x16_bf16 v[108:123], v[176:179], v[180:183], v[108:123]
    ds_read_b64_tr_b16 v[160:161], v244 offset:28672
    s_mov_b32 s18, 65536
    s_add_u32 m0, s25, 0
    s_nop 0
    buffer_load_dwordx4 v234, s[40:43], s18 offen sc1 lds
    v_mfma_f32_32x32x16_bf16 v[124:139], v[176:179], v[184:187], v[124:139]
    ds_read_b64_tr_b16 v[162:163], v244 offset:29696
    buffer_load_dwordx4 v234, s[40:43], s18 offen offset:1024 sc1 lds
    s_waitcnt lgkmcnt(6)
    v_mfma_f32_32x32x16_bf16 v[76:91], v[140:143], v[148:151], v[76:91]
    ds_read_b64_tr_b16 v[172:173], v243 offset:32768
    ds_read_b64_tr_b16 v[174:175], v243 offset:33792
    v_mfma_f32_32x32x16_bf16 v[92:107], v[140:143], v[152:155], v[92:107]
    ds_read_b128 v[180:183], v235 offset:32768
    ds_read_b128 v[184:187], v235 offset:36864
    v_mfma_f32_32x32x16_bf16 v[108:123], v[144:147], v[148:151], v[108:123]
    ds_read_b64_tr_b16 v[176:177], v244 offset:32768
    buffer_load_dwordx4 v234, s[40:43], s18 offen offset:2048 sc1 lds
    v_mfma_f32_32x32x16_bf16 v[124:139], v[144:147], v[152:155], v[124:139]
    ds_read_b64_tr_b16 v[178:179], v244 offset:33792
    buffer_load_dwordx4 v234, s[40:43], s18 offen offset:3072 sc1 lds
    s_waitcnt lgkmcnt(6)
    v_mfma_f32_32x32x16_bf16 v[76:91], v[156:159], v[164:167], v[76:91]
    ds_read_b64_tr_b16 v[140:141], v243 offset:36864
    ds_read_b64_tr_b16 v[142:143], v243 offset:37888
    v_mfma_f32_32x32x16_bf16 v[92:107], v[156:159], v[168:171], v[92:107]
    ds_read_b128 v[148:151], v236 offset:32768
    ds_read_b128 v[152:155], v236 offset:36864
    v_mfma_f32_32x32x16_bf16 v[108:123], v[160:163], v[164:167], v[108:123]
    ds_read_b64_tr_b16 v[144:145], v244 offset:36864
    s_mov_b32 s17, 640
    s_add_u32 m0, s24, 0
    s_nop 0
    buffer_load_dwordx4 v230, s[32:35], s17 offen lds
    v_mfma_f32_32x32x16_bf16 v[124:139], v[160:163], v[168:171], v[124:139]
    ds_read_b64_tr_b16 v[146:147], v244 offset:37888
    buffer_load_dwordx4 v231, s[32:35], s17 offen offset:1024 lds
    s_waitcnt lgkmcnt(6)
    v_mfma_f32_32x32x16_bf16 v[76:91], v[172:175], v[180:183], v[76:91]
    ds_read_b64_tr_b16 v[156:157], v243 offset:40960
    ds_read_b64_tr_b16 v[158:159], v243 offset:41984
    v_mfma_f32_32x32x16_bf16 v[92:107], v[172:175], v[184:187], v[92:107]
    ds_read_b128 v[164:167], v237 offset:32768
    ds_read_b128 v[168:171], v237 offset:36864
    v_mfma_f32_32x32x16_bf16 v[108:123], v[176:179], v[180:183], v[108:123]
    ds_read_b64_tr_b16 v[160:161], v244 offset:40960
    buffer_load_dwordx4 v232, s[32:35], s17 offen offset:2048 lds
    v_mfma_f32_32x32x16_bf16 v[124:139], v[176:179], v[184:187], v[124:139]
    ds_read_b64_tr_b16 v[162:163], v244 offset:41984
    buffer_load_dwordx4 v233, s[32:35], s17 offen offset:3072 lds
    s_waitcnt vmcnt(8) lgkmcnt(6)
    s_barrier
    v_mfma_f32_32x32x16_bf16 v[76:91], v[140:143], v[148:151], v[76:91]
    ds_read_b64_tr_b16 v[172:173], v243 offset:45056
    ds_read_b64_tr_b16 v[174:175], v243 offset:46080
    v_mfma_f32_32x32x16_bf16 v[92:107], v[140:143], v[152:155], v[92:107]
    ds_read_b128 v[180:183], v238 offset:32768
    ds_read_b128 v[184:187], v238 offset:36864
    v_mfma_f32_32x32x16_bf16 v[108:123], v[144:147], v[148:151], v[108:123]
    ds_read_b64_tr_b16 v[176:177], v244 offset:45056
    s_mov_b32 s18, 81920
    s_add_u32 m0, s25, 16384
    s_nop 0
    buffer_load_dwordx4 v234, s[40:43], s18 offen sc1 lds
    v_mfma_f32_32x32x16_bf16 v[124:139], v[144:147], v[152:155], v[124:139]
    ds_read_b64_tr_b16 v[178:179], v244 offset:46080
    buffer_load_dwordx4 v234, s[40:43], s18 offen offset:1024 sc1 lds
    s_waitcnt lgkmcnt(6)
    v_mfma_f32_32x32x16_bf16 v[76:91], v[156:159], v[164:167], v[76:91]
    ds_read_b64_tr_b16 v[140:141], v243 offset:49152
    ds_read_b64_tr_b16 v[142:143], v243 offset:50176
    v_mfma_f32_32x32x16_bf16 v[92:107], v[156:159], v[168:171], v[92:107]
    ds_read_b128 v[148:151], v235 offset:49152
    ds_read_b128 v[152:155], v235 offset:53248
    v_mfma_f32_32x32x16_bf16 v[108:123], v[160:163], v[164:167], v[108:123]
    ds_read_b64_tr_b16 v[144:145], v244 offset:49152
    buffer_load_dwordx4 v234, s[40:43], s18 offen offset:2048 sc1 lds
    v_mfma_f32_32x32x16_bf16 v[124:139], v[160:163], v[168:171], v[124:139]
    ds_read_b64_tr_b16 v[146:147], v244 offset:50176
    buffer_load_dwordx4 v234, s[40:43], s18 offen offset:3072 sc1 lds
    s_waitcnt lgkmcnt(6)
    v_mfma_f32_32x32x16_bf16 v[76:91], v[172:175], v[180:183], v[76:91]
    ds_read_b64_tr_b16 v[156:157], v243 offset:53248
    ds_read_b64_tr_b16 v[158:159], v243 offset:54272
    v_mfma_f32_32x32x16_bf16 v[92:107], v[172:175], v[184:187], v[92:107]
    ds_read_b128 v[164:167], v236 offset:49152
    ds_read_b128 v[168:171], v236 offset:53248
    v_mfma_f32_32x32x16_bf16 v[108:123], v[176:179], v[180:183], v[108:123]
    ds_read_b64_tr_b16 v[160:161], v244 offset:53248
    s_mov_b32 s17, 768
    s_add_u32 m0, s24, 16384
    s_nop 0
    buffer_load_dwordx4 v230, s[32:35], s17 offen lds
    v_mfma_f32_32x32x16_bf16 v[124:139], v[176:179], v[184:187], v[124:139]
    ds_read_b64_tr_b16 v[162:163], v244 offset:54272
    buffer_load_dwordx4 v231, s[32:35], s17 offen offset:1024 lds
    s_waitcnt lgkmcnt(6)
    v_mfma_f32_32x32x16_bf16 v[76:91], v[140:143], v[148:151], v[76:91]
    ds_read_b64_tr_b16 v[172:173], v243 offset:57344
    ds_read_b64_tr_b16 v[174:175], v243 offset:58368
    v_mfma_f32_32x32x16_bf16 v[92:107], v[140:143], v[152:155], v[92:107]
    ds_read_b128 v[180:183], v237 offset:49152
    ds_read_b128 v[184:187], v237 offset:53248
    v_mfma_f32_32x32x16_bf16 v[108:123], v[144:147], v[148:151], v[108:123]
    ds_read_b64_tr_b16 v[176:177], v244 offset:57344
    buffer_load_dwordx4 v232, s[32:35], s17 offen offset:2048 lds
    v_mfma_f32_32x32x16_bf16 v[124:139], v[144:147], v[152:155], v[124:139]
    ds_read_b64_tr_b16 v[178:179], v244 offset:58368
    buffer_load_dwordx4 v233, s[32:35], s17 offen offset:3072 lds
    s_waitcnt vmcnt(12) lgkmcnt(6)
    s_barrier
    v_mfma_f32_32x32x16_bf16 v[76:91], v[156:159], v[164:167], v[76:91]
    ds_read_b64_tr_b16 v[140:141], v243 offset:61440
    ds_read_b64_tr_b16 v[142:143], v243 offset:62464
    v_mfma_f32_32x32x16_bf16 v[92:107], v[156:159], v[168:171], v[92:107]
    ds_read_b128 v[148:151], v238 offset:49152
    ds_read_b128 v[152:155], v238 offset:53248
    v_mfma_f32_32x32x16_bf16 v[108:123], v[160:163], v[164:167], v[108:123]
    ds_read_b64_tr_b16 v[144:145], v244 offset:61440
    s_mov_b32 s18, 98304
    s_add_u32 m0, s25, 32768
    s_nop 0
    buffer_load_dwordx4 v234, s[40:43], s18 offen sc1 lds
    v_mfma_f32_32x32x16_bf16 v[124:139], v[160:163], v[168:171], v[124:139]
    ds_read_b64_tr_b16 v[146:147], v244 offset:62464
    buffer_load_dwordx4 v234, s[40:43], s18 offen offset:1024 sc1 lds
    s_waitcnt lgkmcnt(6)
    v_mfma_f32_32x32x16_bf16 v[76:91], v[172:175], v[180:183], v[76:91]
    ds_read_b64_tr_b16 v[156:157], v243 offset:0
    ds_read_b64_tr_b16 v[158:159], v243 offset:1024
    v_mfma_f32_32x32x16_bf16 v[92:107], v[172:175], v[184:187], v[92:107]
    ds_read_b128 v[164:167], v239 offset:0
    ds_read_b128 v[168:171], v239 offset:4096
    v_mfma_f32_32x32x16_bf16 v[108:123], v[176:179], v[180:183], v[108:123]
    ds_read_b64_tr_b16 v[160:161], v244 offset:0
    buffer_load_dwordx4 v234, s[40:43], s18 offen offset:2048 sc1 lds
    v_mfma_f32_32x32x16_bf16 v[124:139], v[176:179], v[184:187], v[124:139]
    ds_read_b64_tr_b16 v[162:163], v244 offset:1024
    buffer_load_dwordx4 v234, s[40:43], s18 offen offset:3072 sc1 lds
    s_cmp_eq_u32 s14, 3
    s_cbranch_scc0 L_wos_17
    buffer_store_dwordx4 a[40:43], v56, s[40:43], 0 offen offset:0 sc1
    buffer_store_dwordx4 a[44:47], v56, s[40:43], 0 offen offset:1024 sc1
    buffer_store_dwordx4 a[48:51], v56, s[40:43], 0 offen offset:2048 sc1
    buffer_store_dwordx4 a[52:55], v56, s[40:43], 0 offen offset:3072 sc1
L_wos_17:
    s_waitcnt lgkmcnt(6)
    v_mfma_f32_32x32x16_bf16 v[76:91], v[140:143], v[148:151], v[76:91]
    ds_read_b64_tr_b16 v[172:173], v243 offset:4096
    ds_read_b64_tr_b16 v[174:175], v243 offset:5120
    v_mfma_f32_32x32x16_bf16 v[92:107], v[140:143], v[152:155], v[92:107]
    ds_read_b128 v[180:183], v240 offset:0
    ds_read_b128 v[184:187], v240 offset:4096
    v_mfma_f32_32x32x16_bf16 v[108:123], v[144:147], v[148:151], v[108:123]
    ds_read_b64_tr_b16 v[176:177], v244 offset:4096
    s_mov_b32 s17, 896
    s_add_u32 m0, s24, 32768
    s_nop 0
    buffer_load_dwordx4 v230, s[32:35], s17 offen lds
    v_mfma_f32_32x32x16_bf16 v[124:139], v[144:147], v[152:155], v[124:139]
    ds_read_b64_tr_b16 v[178:179], v244 offset:5120
    buffer_load_dwordx4 v231, s[32:35], s17 offen offset:1024 lds
    s_waitcnt lgkmcnt(6)
    v_mfma_f32_32x32x16_bf16 v[76:91], v[156:159], v[164:167], v[76:91]
    ds_read_b64_tr_b16 v[140:141], v243 offset:8192
    ds_read_b64_tr_b16 v[142:143], v243 offset:9216
    v_mfma_f32_32x32x16_bf16 v[92:107], v[156:159], v[168:171], v[92:107]
    ds_read_b128 v[148:151], v241 offset:0
    ds_read_b128 v[152:155], v241 offset:4096
    v_mfma_f32_32x32x16_bf16 v[108:123], v[160:163], v[164:167], v[108:123]
    ds_read_b64_tr_b16 v[144:145], v244 offset:8192
    buffer_load_dwordx4 v232, s[32:35], s17 offen offset:2048 lds
    v_mfma_f32_32x32x16_bf16 v[124:139], v[160:163], v[168:171], v[124:139]
    ds_read_b64_tr_b16 v[146:147], v244 offset:9216
    buffer_load_dwordx4 v233, s[32:35], s17 offen offset:3072 lds
    s_waitcnt vmcnt(12) lgkmcnt(6)
    s_barrier
    v_mfma_f32_32x32x16_bf16 v[76:91], v[172:175], v[180:183], v[76:91]
    ds_read_b64_tr_b16 v[156:157], v243 offset:12288
    ds_read_b64_tr_b16 v[158:159], v243 offset:13312
    v_mfma_f32_32x32x16_bf16 v[92:107], v[172:175], v[184:187], v[92:107]
    ds_read_b128 v[164:167], v242 offset:0
    ds_read_b128 v[168:171], v242 offset:4096
    v_mfma_f32_32x32x16_bf16 v[108:123], v[176:179], v[180:183], v[108:123]
    ds_read_b64_tr_b16 v[160:161], v244 offset:12288
    s_mov_b32 s18, 114688
    s_add_u32 m0, s25, 49152
    s_nop 0
    buffer_load_dwordx4 v234, s[40:43], s18 offen sc1 lds
    v_mfma_f32_32x32x16_bf16 v[124:139], v[176:179], v[184:187], v[124:139]
    ds_read_b64_tr_b16 v[162:163], v244 offset:13312
    buffer_load_dwordx4 v234, s[40:43], s18 offen offset:1024 sc1 lds
    s_waitcnt lgkmcnt(6)
    v_mfma_f32_32x32x16_bf16 v[76:91], v[140:143], v[148:151], v[76:91]
    ds_read_b64_tr_b16 v[172:173], v243 offset:16384
    ds_read_b64_tr_b16 v[174:175], v243 offset:17408
    v_mfma_f32_32x32x16_bf16 v[92:107], v[140:143], v[152:155], v[92:107]
    ds_read_b128 v[180:183], v235 offset:0
    ds_read_b128 v[184:187], v235 offset:4096
    v_mfma_f32_32x32x16_bf16 v[108:123], v[144:147], v[148:151], v[108:123]
    ds_read_b64_tr_b16 v[176:177], v244 offset:16384
    buffer_load_dwordx4 v234, s[40:43], s18 offen offset:2048 sc1 lds
    v_mfma_f32_32x32x16_bf16 v[124:139], v[144:147], v[152:155], v[124:139]
    ds_read_b64_tr_b16 v[178:179], v244 offset:17408
    buffer_load_dwordx4 v234, s[40:43], s18 offen offset:3072 sc1 lds
    s_lshl_b32 s4, s12, 8
    s_add_u32 s4, s4, 0
    s_lshl_b32 s5, s13, 8
    s_add_u32 s5, s5, 4096
    v_subrev_u32 v4, 2, v1
    v_lshlrev_b32 v5, 8, v4
    v_add_u32 v5, 32768, v5
    v_mov_b32 v6, s4
    v_cmp_gt_u32 vcc, 0, v4
    s_nop 1
    v_cndmask_b32 v247, v6, v5, vcc
    v_mov_b32 v6, s5
    v_cmp_eq_u32 vcc, 1, v1
    s_nop 1
    v_cndmask_b32 v247, v247, v6, vcc
    buffer_load_dword v246, v247, s[40:43], 0 offen sc1
    s_waitcnt lgkmcnt(6)
    v_mfma_f32_32x32x16_bf16 v[76:91], v[156:159], v[164:167], v[76:91]
    ds_read_b64_tr_b16 v[140:141], v243 offset:20480
    ds_read_b64_tr_b16 v[142:143], v243 offset:21504
    v_mfma_f32_32x32x16_bf16 v[92:107], v[156:159], v[168:171], v[92:107]
    ds_read_b128 v[148:151], v236 offset:0
    ds_read_b128 v[152:155], v236 offset:4096
    v_mfma_f32_32x32x16_bf16 v[108:123], v[160:163], v[164:167], v[108:123]
    ds_read_b64_tr_b16 v[144:145], v244 offset:20480
    s_mov_b32 s17, 1024
    s_add_u32 m0, s24, 49152
    s_nop 0
    buffer_load_dwordx4 v230, s[32:35], s17 offen lds
    v_mfma_f32_32x32x16_bf16 v[124:139], v[160:163], v[168:171], v[124:139]
    ds_read_b64_tr_b16 v[146:147], v244 offset:21504
    buffer_load_dwordx4 v231, s[32:35], s17 offen offset:1024 lds
    s_waitcnt lgkmcnt(6)
    v_mfma_f32_32x32x16_bf16 v[76:91], v[172:175], v[180:183], v[76:91]
    ds_read_b64_tr_b16 v[156:157], v243 offset:24576
    ds_read_b64_tr_b16 v[158:159], v243 offset:25600
    v_mfma_f32_32x32x16_bf16 v[92:107], v[172:175], v[184:187], v[92:107]
    ds_read_b128 v[164:167], v237 offset:0
    ds_read_b128 v[168:171], v237 offset:4096
    v_mfma_f32_32x32x16_bf16 v[108:123], v[176:179], v[180:183], v[108:123]
    ds_read_b64_tr_b16 v[160:161], v244 offset:24576
    buffer_load_dwordx4 v232, s[32:35], s17 offen offset:2048 lds
    v_mfma_f32_32x32x16_bf16 v[124:139], v[176:179], v[184:187], v[124:139]
    ds_read_b64_tr_b16 v[162:163], v244 offset:25600
    buffer_load_dwordx4 v233, s[32:35], s17 offen offset:3072 lds
    s_waitcnt vmcnt(13) lgkmcnt(6)
    s_barrier
    v_mfma_f32_32x32x16_bf16 v[76:91], v[140:143], v[148:151], v[76:91]
    ds_read_b64_tr_b16 v[172:173], v243 offset:28672
    ds_read_b64_tr_b16 v[174:175], v243 offset:29696
    v_mfma_f32_32x32x16_bf16 v[92:107], v[140:143], v[152:155], v[92:107]
    ds_read_b128 v[180:183], v238 offset:0
    ds_read_b128 v[184:187], v238 offset:4096
    v_mfma_f32_32x32x16_bf16 v[108:123], v[144:147], v[148:151], v[108:123]
    ds_read_b64_tr_b16 v[176:177], v244 offset:28672
    s_mov_b32 s18, 131072
    s_add_u32 m0, s25, 0
    s_nop 0
    buffer_load_dwordx4 v234, s[40:43], s18 offen sc1 lds
    v_mfma_f32_32x32x16_bf16 v[124:139], v[144:147], v[152:155], v[124:139]
    ds_read_b64_tr_b16 v[178:179], v244 offset:29696
    buffer_load_dwordx4 v234, s[40:43], s18 offen offset:1024 sc1 lds
    s_waitcnt lgkmcnt(6)
    v_mfma_f32_32x32x16_bf16 v[76:91], v[156:159], v[164:167], v[76:91]
    ds_read_b64_tr_b16 v[140:141], v243 offset:32768
    ds_read_b64_tr_b16 v[142:143], v243 offset:33792
    v_mfma_f32_32x32x16_bf16 v[92:107], v[156:159], v[168:171], v[92:107]
    ds_read_b128 v[148:151], v235 offset:16384
    ds_read_b128 v[152:155], v235 offset:20480
    v_mfma_f32_32x32x16_bf16 v[108:123], v[160:163], v[164:167], v[108:123]
    ds_read_b64_tr_b16 v[144:145], v244 offset:32768
    buffer_load_dwordx4 v234, s[40:43], s18 offen offset:2048 sc1 lds
    v_mfma_f32_32x32x16_bf16 v[124:139], v[160:163], v[168:171], v[124:139]
    ds_read_b64_tr_b16 v[146:147], v244 offset:33792
    buffer_load_dwordx4 v234, s[40:43], s18 offen offset:3072 sc1 lds
    s_waitcnt lgkmcnt(6)
    v_mfma_f32_32x32x16_bf16 v[76:91], v[172:175], v[180:183], v[76:91]
    ds_read_b64_tr_b16 v[156:157], v243 offset:36864
    ds_read_b64_tr_b16 v[158:159], v243 offset:37888
    v_mfma_f32_32x32x16_bf16 v[92:107], v[172:175], v[184:187], v[92:107]
    ds_read_b128 v[164:167], v236 offset:16384
    ds_read_b128 v[168:171], v236 offset:20480
    v_mfma_f32_32x32x16_bf16 v[108:123], v[176:179], v[180:183], v[108:123]
    ds_read_b64_tr_b16 v[160:161], v244 offset:36864
    s_mov_b32 s17, 1152
    s_add_u32 m0, s24, 65536
    s_nop 0
    buffer_load_dwordx4 v230, s[32:35], s17 offen lds
    v_mfma_f32_32x32x16_bf16 v[124:139], v[176:179], v[184:187], v[124:139]
    ds_read_b64_tr_b16 v[162:163], v244 offset:37888
    buffer_load_dwordx4 v231, s[32:35], s17 offen offset:1024 lds
    s_waitcnt vmcnt(10)
    s_mov_b32 s19, 0
L_s0w_18:
    v_cmp_gt_u32 vcc, 16, v246
    s_add_u32 s19, s19, 1
    s_cmp_eq_u64 vcc, 0
    s_cbranch_scc1 L_s0wd_19
    buffer_load_dword v246, v247, s[40:43], 0 offen sc1
    s_waitcnt vmcnt(0)
    s_cmp_lt_u32 s19, 200000
    s_cbranch_scc1 L_s0w_18
L_s0wd_19:
    s_lshl_b32 s4, s12, 7
    s_lshl_b32 s5, s23, 6
    s_add_u32 s4, s4, s5
    v_and_b32 v248, 31, v1
    v_add_u32 v248, s4, v248
    v_lshlrev_b32 v248, 3, v248
    v_add_u32 v248, 65536, v248
    s_lshl_b32 s4, s13, 13
    s_add_u32 s4, s4, 131072
    v_lshlrev_b32 v249, 3, v1
    v_add_u32 v249, s4, v249
    v_and_b32 v4, 31, v1
    v_lshrrev_b32 v5, 3, v4
    v_and_b32 v6, 3, v4
    v_lshl_add_u32 v5, v5, 2, v6
    v_bfe_u32 v6, v4, 2, 1
    v_mul_u32_u24 v6, 10, v6
    v_add_u32 v6, v6, v5
    s_lshl_b32 s4, s13, 1
    s_add_u32 s4, s4, s22
    s_mul_i32 s4, s4, 800
    v_lshl_add_u32 v6, v6, 1, s4
    v_cmp_gt_u32 vcc, 10, v5
    v_mov_b32 v11, 0x7ffffff0
    s_nop 0
    v_cndmask_b32 v65, v11, v6, vcc
    v_lshrrev_b32 v7, 5, v1
    v_mul_u32_u24 v7, 160, v7
    v_add_u32 v6, v6, v7
    v_cndmask_b32 v64, v11, v6, vcc
    s_waitcnt lgkmcnt(6)
    v_mfma_f32_32x32x16_bf16 v[76:91], v[140:143], v[148:151], v[76:91]
    ds_read_b64_tr_b16 v[172:173], v243 offset:40960
    ds_read_b64_tr_b16 v[174:175], v243 offset:41984
    v_mfma_f32_32x32x16_bf16 v[92:107], v[140:143], v[152:155], v[92:107]
    ds_read_b128 v[180:183], v237 offset:16384
    ds_read_b128 v[184:187], v237 offset:20480
    v_mfma_f32_32x32x16_bf16 v[108:123], v[144:147], v[148:151], v[108:123]
    ds_read_b64_tr_b16 v[176:177], v244 offset:40960
    buffer_load_dwordx4 v232, s[32:35], s17 offen offset:2048 lds
    v_mfma_f32_32x32x16_bf16 v[124:139], v[144:147], v[152:155], v[124:139]
    ds_read_b64_tr_b16 v[178:179], v244 offset:41984
    buffer_load_dwordx4 v233, s[32:35], s17 offen offset:3072 lds
    s_waitcnt lgkmcnt(6)
    s_barrier
    v_mfma_f32_32x32x16_bf16 v[76:91], v[156:159], v[164:167], v[76:91]
    ds_read_b64_tr_b16 v[140:141], v243 offset:45056
    ds_read_b64_tr_b16 v[142:143], v243 offset:46080
    v_mfma_f32_32x32x16_bf16 v[92:107], v[156:159], v[168:171], v[92:107]
    ds_read_b128 v[148:151], v238 offset:16384
    ds_read_b128 v[152:155], v238 offset:20480
    v_mfma_f32_32x32x16_bf16 v[108:123], v[160:163], v[164:167], v[108:123]
    ds_read_b64_tr_b16 v[144:145], v244 offset:45056
    s_mov_b32 s18, 147456
    s_add_u32 m0, s25, 16384
    s_nop 0
    buffer_load_dwordx4 v234, s[40:43], s18 offen sc1 lds
    v_mfma_f32_32x32x16_bf16 v[124:139], v[160:163], v[168:171], v[124:139]
    ds_read_b64_tr_b16 v[146:147], v244 offset:46080
    buffer_load_dwordx4 v234, s[40:43], s18 offen offset:1024 sc1 lds
    s_cmp_lg_u32 s14, 0
    s_cbranch_scc1 L_sig_20
    s_lshl_b32 s4, s12, 8
    s_add_u32 s4, s4, 32768
    v_mov_b32 v4, s4
    v_mov_b32 v5, 1
    s_mov_b64 exec, 1
    buffer_atomic_add v5, v4, s[40:43], 0 offen sc1
    s_mov_b64 exec, -1
L_sig_20:
    s_waitcnt lgkmcnt(6)
    v_mfma_f32_32x32x16_bf16 v[76:91], v[172:175], v[180:183], v[76:91]
    ds_read_b64_tr_b16 v[156:157], v243 offset:49152
    ds_read_b64_tr_b16 v[158:159], v243 offset:50176
    v_mfma_f32_32x32x16_bf16 v[92:107], v[172:175], v[184:187], v[92:107]
    ds_read_b128 v[164:167], v235 offset:32768
    ds_read_b128 v[168:171], v235 offset:36864
    v_mfma_f32_32x32x16_bf16 v[108:123], v[176:179], v[180:183], v[108:123]
    ds_read_b64_tr_b16 v[160:161], v244 offset:49152
    buffer_load_dwordx4 v234, s[40:43], s18 offen offset:2048 sc1 lds
    v_mfma_f32_32x32x16_bf16 v[124:139], v[176:179], v[184:187], v[124:139]
    ds_read_b64_tr_b16 v[162:163], v244 offset:50176
    buffer_load_dwordx4 v234, s[40:43], s18 offen offset:3072 sc1 lds
    s_waitcnt lgkmcnt(6)
    v_mfma_f32_32x32x16_bf16 v[76:91], v[140:143], v[148:151], v[76:91]
    ds_read_b64_tr_b16 v[172:173], v243 offset:53248
    ds_read_b64_tr_b16 v[174:175], v243 offset:54272
    v_mfma_f32_32x32x16_bf16 v[92:107], v[140:143], v[152:155], v[92:107]
    ds_read_b128 v[180:183], v236 offset:32768
    ds_read_b128 v[184:187], v236 offset:36864
    v_mfma_f32_32x32x16_bf16 v[108:123], v[144:147], v[148:151], v[108:123]
    ds_read_b64_tr_b16 v[176:177], v244 offset:53248
    buffer_load_dwordx2 v[220:221], v248, s[40:43], 0 offen sc1
    v_mfma_f32_32x32x16_bf16 v[124:139], v[144:147], v[152:155], v[124:139]
    ds_read_b64_tr_b16 v[178:179], v244 offset:54272
    buffer_load_dwordx2 v[222:223], v248, s[40:43], 0 offen offset:256 sc1
    s_waitcnt lgkmcnt(6)
    v_mfma_f32_32x32x16_bf16 v[76:91], v[156:159], v[164:167], v[76:91]
    ds_read_b64_tr_b16 v[140:141], v243 offset:57344
    ds_read_b64_tr_b16 v[142:143], v243 offset:58368
    v_mfma_f32_32x32x16_bf16 v[92:107], v[156:159], v[168:171], v[92:107]
    ds_read_b128 v[148:151], v237 offset:32768
    ds_read_b128 v[152:155], v237 offset:36864
    v_mfma_f32_32x32x16_bf16 v[108:123], v[160:163], v[164:167], v[108:123]
    ds_read_b64_tr_b16 v[144:145], v244 offset:57344
    buffer_load_dwordx2 v[188:189], v249, s[40:43], 0 offen offset:0 sc1
    v_mfma_f32_32x32x16_bf16 v[124:139], v[160:163], v[168:171], v[124:139]
    ds_read_b64_tr_b16 v[146:147], v244 offset:58368
    buffer_load_dwordx2 v[190:191], v249, s[40:43], 0 offen offset:512 sc1
    s_waitcnt vmcnt(12) lgkmcnt(6)
    s_barrier
    v_mfma_f32_32x32x16_bf16 v[76:91], v[172:175], v[180:183], v[76:91]
    ds_read_b64_tr_b16 v[156:157], v243 offset:61440
    ds_read_b64_tr_b16 v[158:159], v243 offset:62464
    v_mfma_f32_32x32x16_bf16 v[92:107], v[172:175], v[184:187], v[92:107]
    ds_read_b128 v[164:167], v238 offset:32768
    ds_read_b128 v[168:171], v238 offset:36864
    v_mfma_f32_32x32x16_bf16 v[108:123], v[176:179], v[180:183], v[108:123]
    ds_read_b64_tr_b16 v[160:161], v244 offset:61440
    buffer_load_dwordx2 v[192:193], v249, s[40:43], 0 offen offset:1024 sc1
    v_mfma_f32_32x32x16_bf16 v[124:139], v[176:179], v[184:187], v[124:139]
    ds_read_b64_tr_b16 v[162:163], v244 offset:62464
    buffer_load_dwordx2 v[194:195], v249, s[40:43], 0 offen offset:1536 sc1
    s_waitcnt lgkmcnt(6)
    v_mfma_f32_32x32x16_bf16 v[76:91], v[140:143], v[148:151], v[76:91]
    ds_read_b64_tr_b16 v[172:173], v243 offset:0
    ds_read_b64_tr_b16 v[174:175], v243 offset:1024
    v_mfma_f32_32x32x16_bf16 v[92:107], v[140:143], v[152:155], v[92:107]
    ds_read_b128 v[180:183], v235 offset:49152
    ds_read_b128 v[184:187], v235 offset:53248
    v_mfma_f32_32x32x16_bf16 v[108:123], v[144:147], v[148:151], v[108:123]
    ds_read_b64_tr_b16 v[176:177], v244 offset:0
    buffer_load_dwordx2 v[196:197], v249, s[40:43], 0 offen offset:2048 sc1
    v_mfma_f32_32x32x16_bf16 v[124:139], v[144:147], v[152:155], v[124:139]
    ds_read_b64_tr_b16 v[178:179], v244 offset:1024
    buffer_load_dwordx2 v[198:199], v249, s[40:43], 0 offen offset:2560 sc1
    s_waitcnt lgkmcnt(6)
    v_mfma_f32_32x32x16_bf16 v[76:91], v[156:159], v[164:167], v[76:91]
    ds_read_b64_tr_b16 v[140:141], v243 offset:4096
    ds_read_b64_tr_b16 v[142:143], v243 offset:5120
    v_mfma_f32_32x32x16_bf16 v[92:107], v[156:159], v[168:171], v[92:107]
    ds_read_b128 v[148:151], v236 offset:49152
    ds_read_b128 v[152:155], v236 offset:53248
    v_mfma_f32_32x32x16_bf16 v[108:123], v[160:163], v[164:167], v[108:123]
    ds_read_b64_tr_b16 v[144:145], v244 offset:4096
    buffer_load_dwordx2 v[200:201], v249, s[40:43], 0 offen offset:3072 sc1
    v_mfma_f32_32x32x16_bf16 v[124:139], v[160:163], v[168:171], v[124:139]
    ds_read_b64_tr_b16 v[146:147], v244 offset:5120
    buffer_load_dwordx2 v[202:203], v249, s[40:43], 0 offen offset:3584 sc1
    s_waitcnt lgkmcnt(6)
    v_mfma_f32_32x32x16_bf16 v[76:91], v[172:175], v[180:183], v[76:91]
    ds_read_b64_tr_b16 v[156:157], v243 offset:8192
    ds_read_b64_tr_b16 v[158:159], v243 offset:9216
    v_mfma_f32_32x32x16_bf16 v[92:107], v[172:175], v[184:187], v[92:107]
    ds_read_b128 v[164:167], v237 offset:49152
    ds_read_b128 v[168:171], v237 offset:53248
    v_mfma_f32_32x32x16_bf16 v[108:123], v[176:179], v[180:183], v[108:123]
    ds_read_b64_tr_b16 v[160:161], v244 offset:8192
    v_add_u32 v249, 4096, v249
    buffer_load_dwordx2 v[204:205], v249, s[40:43], 0 offen offset:0 sc1
    v_mfma_f32_32x32x16_bf16 v[124:139], v[176:179], v[184:187], v[124:139]
    ds_read_b64_tr_b16 v[162:163], v244 offset:9216
    buffer_load_dwordx2 v[206:207], v249, s[40:43], 0 offen offset:512 sc1
    s_waitcnt vmcnt(12) lgkmcnt(6)
    s_barrier
    v_mfma_f32_32x32x16_bf16 v[76:91], v[140:143], v[148:151], v[76:91]
    ds_read_b64_tr_b16 v[172:173], v243 offset:12288
    ds_read_b64_tr_b16 v[174:175], v243 offset:13312
    v_mfma_f32_32x32x16_bf16 v[92:107], v[140:143], v[152:155], v[92:107]
    ds_read_b128 v[180:183], v238 offset:49152
    ds_read_b128 v[184:187], v238 offset:53248
    v_mfma_f32_32x32x16_bf16 v[108:123], v[144:147], v[148:151], v[108:123]
    ds_read_b64_tr_b16 v[176:177], v244 offset:12288
    buffer_load_dwordx2 v[208:209], v249, s[40:43], 0 offen offset:1024 sc1
    v_mfma_f32_32x32x16_bf16 v[124:139], v[144:147], v[152:155], v[124:139]
    ds_read_b64_tr_b16 v[178:179], v244 offset:13312
    buffer_load_dwordx2 v[210:211], v249, s[40:43], 0 offen offset:1536 sc1
    s_waitcnt lgkmcnt(6)
    v_mfma_f32_32x32x16_bf16 v[76:91], v[156:159], v[164:167], v[76:91]
    ds_read_b64_tr_b16 v[140:141], v243 offset:16384
    ds_read_b64_tr_b16 v[142:143], v243 offset:17408
    v_mfma_f32_32x32x16_bf16 v[92:107], v[156:159], v[168:171], v[92:107]
    ds_read_b128 v[148:151], v239 offset:0
    ds_read_b128 v[152:155], v239 offset:4096
    v_mfma_f32_32x32x16_bf16 v[108:123], v[160:163], v[164:167], v[108:123]
    ds_read_b64_tr_b16 v[144:145], v244 offset:16384
    buffer_load_dwordx2 v[212:213], v249, s[40:43], 0 offen offset:2048 sc1
    v_mfma_f32_32x32x16_bf16 v[124:139], v[160:163], v[168:171], v[124:139]
    ds_read_b64_tr_b16 v[146:147], v244 offset:17408
    buffer_load_dwordx2 v[214:215], v249, s[40:43], 0 offen offset:2560 sc1
    s_waitcnt lgkmcnt(6)
    v_mfma_f32_32x32x16_bf16 v[76:91], v[172:175], v[180:183], v[76:91]
    ds_read_b64_tr_b16 v[156:157], v243 offset:20480
    ds_read_b64_tr_b16 v[158:159], v243 offset:21504
    v_mfma_f32_32x32x16_bf16 v[92:107], v[172:175], v[184:187], v[92:107]
    ds_read_b128 v[164:167], v240 offset:0
    ds_read_b128 v[168:171], v240 offset:4096
    v_mfma_f32_32x32x16_bf16 v[108:123], v[176:179], v[180:183], v[108:123]
    ds_read_b64_tr_b16 v[160:161], v244 offset:20480
    buffer_load_dwordx2 v[216:217], v249, s[40:43], 0 offen offset:3072 sc1
    v_mfma_f32_32x32x16_bf16 v[124:139], v[176:179], v[184:187], v[124:139]
    ds_read_b64_tr_b16 v[162:163], v244 offset:21504
    buffer_load_dwordx2 v[218:219], v249, s[40:43], 0 offen offset:3584 sc1
    s_waitcnt lgkmcnt(6)
    v_mfma_f32_32x32x16_bf16 v[76:91], v[140:143], v[148:151], v[76:91]
    ds_read_b64_tr_b16 v[172:173], v243 offset:24576
    ds_read_b64_tr_b16 v[174:175], v243 offset:25600
    v_mfma_f32_32x32x16_bf16 v[92:107], v[140:143], v[152:155], v[92:107]
    ds_read_b128 v[180:183], v241 offset:0
    ds_read_b128 v[184:187], v241 offset:4096
    v_mfma_f32_32x32x16_bf16 v[108:123], v[144:147], v[148:151], v[108:123]
    ds_read_b64_tr_b16 v[176:177], v244 offset:24576
    buffer_load_ushort v52, v64, s[52:55], 0 offen offset:0
    v_mfma_f32_32x32x16_bf16 v[124:139], v[144:147], v[152:155], v[124:139]
    ds_read_b64_tr_b16 v[178:179], v244 offset:25600
    buffer_load_short_d16_hi v53, v64, s[52:55], 0 offen offset:40
    s_waitcnt lgkmcnt(6)
    v_mfma_f32_32x32x16_bf16 v[76:91], v[156:159], v[164:167], v[76:91]
    ds_read_b64_tr_b16 v[140:141], v243 offset:28672
    ds_read_b64_tr_b16 v[142:143], v243 offset:29696
    v_mfma_f32_32x32x16_bf16 v[92:107], v[156:159], v[168:171], v[92:107]
    ds_read_b128 v[148:151], v242 offset:0
    ds_read_b128 v[152:155], v242 offset:4096
    v_mfma_f32_32x32x16_bf16 v[108:123], v[160:163], v[164:167], v[108:123]
    ds_read_b64_tr_b16 v[144:145], v244 offset:28672
    buffer_load_ushort v54, v64, s[52:55], 0 offen offset:80
    v_mfma_f32_32x32x16_bf16 v[124:139], v[160:163], v[168:171], v[124:139]
    ds_read_b64_tr_b16 v[146:147], v244 offset:29696
    buffer_load_short_d16_hi v55, v64, s[52:55], 0 offen offset:120
    s_waitcnt lgkmcnt(6)
    v_mfma_f32_32x32x16_bf16 v[76:91], v[172:175], v[180:183], v[76:91]
    v_mfma_f32_32x32x16_bf16 v[92:107], v[172:175], v[184:187], v[92:107]
    v_mfma_f32_32x32x16_bf16 v[108:123], v[176:179], v[180:183], v[108:123]
    buffer_load_ushort v56, v64, s[52:55], 0 offen offset:320
    v_mfma_f32_32x32x16_bf16 v[124:139], v[176:179], v[184:187], v[124:139]
    buffer_load_short_d16_hi v57, v64, s[52:55], 0 offen offset:360
    s_waitcnt lgkmcnt(0)
    v_mfma_f32_32x32x16_bf16 v[76:91], v[140:143], v[148:151], v[76:91]
    v_mfma_f32_32x32x16_bf16 v[92:107], v[140:143], v[152:155], v[92:107]
    v_mfma_f32_32x32x16_bf16 v[108:123], v[144:147], v[148:151], v[108:123]
    buffer_load_ushort v58, v64, s[52:55], 0 offen offset:400
    v_mfma_f32_32x32x16_bf16 v[124:139], v[144:147], v[152:155], v[124:139]
    buffer_load_short_d16_hi v59, v64, s[52:55], 0 offen offset:440
    buffer_load_ushort v60, v65, s[52:55], 0 offen offset:640
    buffer_load_short_d16_hi v61, v65, s[52:55], 0 offen offset:680
    buffer_load_ushort v62, v65, s[52:55], 0 offen offset:720
    buffer_load_short_d16_hi v63, v65, s[52:55], 0 offen offset:760
    v_lshlrev_b32 v225, 8, v1
    v_add_u32 v225, 32768, v225
    s_mov_b64 exec, 0xffff
    buffer_load_dword v224, v225, s[40:43], 0 offen sc1
    s_mov_b64 exec, -1
    s_waitcnt vmcnt(1)
    s_cmp_ge_u32 s14, 2
    s_cbranch_scc1 L_pl23_21
    buffer_load_dwordx4 a[0:3], v68, s[68:71], 0 offen
    buffer_load_dwordx4 a[4:7], v69, s[68:71], 0 offen
    buffer_load_dwordx4 a[8:11], v70, s[68:71], 0 offen
    buffer_load_dwordx4 a[12:15], v71, s[68:71], 0 offen
    s_branch L_ple_23
L_pl23_21:
    s_cmp_eq_u32 s14, 2
    s_cbranch_scc0 L_plu_22
    s_mov_b32 s17, 0
    buffer_load_dwordx4 a[0:3], v68, s[60:63], s17 offen
    s_mov_b32 s17, 12288
    buffer_load_dwordx4 a[4:7], v68, s[60:63], s17 offen
    s_mov_b32 s17, 24576
    buffer_load_dwordx4 a[8:11], v68, s[60:63], s17 offen
    s_mov_b32 s17, 36864
    buffer_load_dwordx4 a[12:15], v68, s[60:63], s17 offen
    s_mov_b32 s17, 49152
    buffer_load_dwordx4 a[16:19], v68, s[60:63], s17 offen
    s_mov_b32 s17, 61440
    buffer_load_dwordx4 a[20:23], v68, s[60:63], s17 offen
    s_mov_b32 s17, 73728
    buffer_load_dwordx4 a[24:27], v68, s[60:63], s17 offen
    s_mov_b32 s17, 86016
    buffer_load_dwordx4 a[28:31], v68, s[60:63], s17 offen
    s_mov_b32 s17, 98304
    buffer_load_dwordx4 a[32:35], v68, s[60:63], s17 offen
    s_mov_b32 s17, 110592
    buffer_load_dwordx4 a[36:39], v68, s[60:63], s17 offen
    s_branch L_ple_23
L_plu_22:
    s_mov_b32 s17, 0
    buffer_load_dwordx4 a[0:3], v68, s[64:67], s17 offen
    s_mov_b32 s17, 12288
    buffer_load_dwordx4 a[4:7], v68, s[64:67], s17 offen
    s_mov_b32 s17, 24576
    buffer_load_dwordx4 a[8:11], v68, s[64:67], s17 offen
    s_mov_b32 s17, 36864
    buffer_load_dwordx4 a[12:15], v68, s[64:67], s17 offen
    s_mov_b32 s17, 49152
    buffer_load_dwordx4 a[16:19], v68, s[64:67], s17 offen
    s_mov_b32 s17, 61440
    buffer_load_dwordx4 a[20:23], v68, s[64:67], s17 offen
    s_mov_b32 s17, 73728
    buffer_load_dwordx4 a[24:27], v68, s[64:67], s17 offen
    s_mov_b32 s17, 86016
    buffer_load_dwordx4 a[28:31], v68, s[64:67], s17 offen
    s_mov_b32 s17, 98304
    buffer_load_dwordx4 a[32:35], v68, s[64:67], s17 offen
    s_mov_b32 s17, 110592
    buffer_load_dwordx4 a[36:39], v68, s[64:67], s17 offen
L_ple_23:
    v_or_b32 v14, v52, v53
    v_or_b32 v15, v54, v55
    v_or_b32 v16, v56, v57
    v_or_b32 v17, v58, v59
    v_or_b32 v60, v60, v61
    v_or_b32 v61, v62, v63
    v_cmp_gt_u32 vcc, 32, v1
    s_nop 1
    v_cndmask_b32 v18, 0, v60, vcc
    v_cndmask_b32 v19, 0, v61, vcc
    v_cmp_le_u32 vcc, 32, v1
    s_nop 1
    v_cndmask_b32 v22, 0, v60, vcc
    v_cndmask_b32 v23, 0, v61, vcc
    v_mov_b32 v20, 0
    v_mov_b32 v24, 0
    v_mov_b32 v21, 0
    v_mov_b32 v25, 0
    v_pk_add_f32 v[188:189], v[188:189], v[204:205]
    v_pk_add_f32 v[190:191], v[190:191], v[206:207]
    v_pk_add_f32 v[192:193], v[192:193], v[208:209]
    v_pk_add_f32 v[194:195], v[194:195], v[210:211]
    v_pk_add_f32 v[196:197], v[196:197], v[212:213]
    v_pk_add_f32 v[198:199], v[198:199], v[214:215]
    v_pk_add_f32 v[200:201], v[200:201], v[216:217]
    v_pk_add_f32 v[202:203], v[202:203], v[218:219]
    v_pk_add_f32 v[188:189], v[188:189], v[196:197]
    v_pk_add_f32 v[190:191], v[190:191], v[198:199]
    v_pk_add_f32 v[192:193], v[192:193], v[200:201]
    v_pk_add_f32 v[194:195], v[194:195], v[202:203]
    v_pk_add_f32 v[188:189], v[188:189], v[192:193]
    v_pk_add_f32 v[190:191], v[190:191], v[194:195]
    v_pk_add_f32 v[188:189], v[188:189], v[190:191]
    s_lshl_b32 s4, s14, 9
    s_add_u32 s4, s4, 161792
    v_lshl_add_u32 v4, v1, 3, s4
    ds_write_b64 v4, v[188:189]
    s_mul_i32 s5, s22, 80
    s_add_u32 s4, s4, s5
    v_lshrrev_b32_e64 v5, 5, v1
    v_lshl_add_u32 v6, v5, 4, s4
    v_mul_u32_u24 v7, 160, v5
    v_add_u32 v7, s4, v7
    v_mov_b32 v8, s4
    s_waitcnt lgkmcnt(0)
    v_lshl_add_u32 v9, v5, 5, s4
    ds_read_b128 v[188:191], v6 offset:0
    ds_read_b128 v[192:195], v6 offset:32
    ds_read_b128 v[196:199], v7 offset:64
    ds_read_b128 v[200:203], v8 offset:336
    ds_read_b128 v[204:207], v6 offset:160
    ds_read_b128 v[208:211], v6 offset:192
    ds_read_b128 v[212:215], v9 offset:320
    ds_read_b128 v[216:219], v6 offset:368
    v_sub_f32 v226, 0, v220
    v_mul_f32 v230, 0x3fb8aa3b, v221
    v_sub_f32 v231, 0, v230
    v_mov_b32 v234, v221
    v_sub_f32_e64 v228, 0, v222
    v_mul_f32 v232, 0x3fb8aa3b, v223
    v_sub_f32 v233, 0, v232
    v_mov_b32 v236, v223
    s_barrier
    s_waitcnt lgkmcnt(0)
    v_pk_fma_f32 v[76:77], v[188:189], v[226:227], v[76:77] op_sel_hi:[1,0,1]
    v_pk_fma_f32 v[78:79], v[190:191], v[226:227], v[78:79] op_sel_hi:[1,0,1]
    v_pk_fma_f32 v[80:81], v[192:193], v[226:227], v[80:81] op_sel_hi:[1,0,1]
    v_pk_fma_f32 v[82:83], v[194:195], v[226:227], v[82:83] op_sel_hi:[1,0,1]
    v_pk_fma_f32 v[84:85], v[196:197], v[226:227], v[84:85] op_sel_hi:[1,0,1]
    v_pk_fma_f32 v[86:87], v[198:199], v[226:227], v[86:87] op_sel_hi:[1,0,1]
    v_pk_fma_f32 v[88:89], v[200:201], v[226:227], v[88:89] op_sel_hi:[1,0,1]
    v_pk_fma_f32 v[90:91], v[202:203], v[226:227], v[90:91] op_sel_hi:[1,0,1]
    v_pk_fma_f32 v[108:109], v[204:205], v[226:227], v[108:109] op_sel_hi:[1,0,1]
    v_pk_fma_f32 v[110:111], v[206:207], v[226:227], v[110:111] op_sel_hi:[1,0,1]
    v_pk_fma_f32 v[112:113], v[208:209], v[226:227], v[112:113] op_sel_hi:[1,0,1]
    v_pk_fma_f32 v[114:115], v[210:211], v[226:227], v[114:115] op_sel_hi:[1,0,1]
    v_pk_fma_f32 v[116:117], v[212:213], v[226:227], v[116:117] op_sel_hi:[1,0,1]
    v_pk_fma_f32 v[118:119], v[214:215], v[226:227], v[118:119] op_sel_hi:[1,0,1]
    v_pk_fma_f32 v[120:121], v[216:217], v[226:227], v[120:121] op_sel_hi:[1,0,1]
    v_pk_fma_f32 v[122:123], v[218:219], v[226:227], v[122:123] op_sel_hi:[1,0,1]
    v_pk_mul_f32 v[116:117], v[116:117], v[234:235] op_sel_hi:[1,0]
    v_pk_mul_f32 v[118:119], v[118:119], v[234:235] op_sel_hi:[1,0]
    v_pk_mul_f32 v[120:121], v[120:121], v[234:235] op_sel_hi:[1,0]
    v_pk_mul_f32 v[122:123], v[122:123], v[234:235] op_sel_hi:[1,0]
    v_pk_mul_f32 v[88:89], v[88:89], v[234:235] op_sel_hi:[1,0]
    v_pk_mul_f32 v[90:91], v[90:91], v[234:235] op_sel_hi:[1,0]
    v_cvt_pk_bf16_f32 v140, v76, v77
    v_cvt_pk_bf16_f32 v141, v78, v79
    v_cvt_pk_bf16_f32 v142, v80, v81
    v_cvt_pk_bf16_f32 v143, v82, v83
    v_cvt_pk_bf16_f32 v144, v84, v85
    v_cvt_pk_bf16_f32 v145, v86, v87
    v_cvt_pk_bf16_f32 v146, v88, v89
    v_cvt_pk_bf16_f32 v147, v90, v91
    v_cvt_pk_bf16_f32 v156, v108, v109
    v_cvt_pk_bf16_f32 v157, v110, v111
    v_cvt_pk_bf16_f32 v158, v112, v113
    v_cvt_pk_bf16_f32 v159, v114, v115
    v_cvt_pk_bf16_f32 v160, v116, v117
    v_cvt_pk_bf16_f32 v161, v118, v119
    v_cvt_pk_bf16_f32 v162, v120, v121
    v_cvt_pk_bf16_f32 v163, v122, v123
    v_pk_fma_f32 v[92:93], v[188:189], v[228:229], v[92:93] op_sel_hi:[1,0,1]
    v_pk_fma_f32 v[94:95], v[190:191], v[228:229], v[94:95] op_sel_hi:[1,0,1]
    v_pk_fma_f32 v[96:97], v[192:193], v[228:229], v[96:97] op_sel_hi:[1,0,1]
    v_pk_fma_f32 v[98:99], v[194:195], v[228:229], v[98:99] op_sel_hi:[1,0,1]
    v_pk_fma_f32 v[100:101], v[196:197], v[228:229], v[100:101] op_sel_hi:[1,0,1]
    v_pk_fma_f32 v[102:103], v[198:199], v[228:229], v[102:103] op_sel_hi:[1,0,1]
    v_pk_fma_f32 v[104:105], v[200:201], v[228:229], v[104:105] op_sel_hi:[1,0,1]
    v_pk_fma_f32 v[106:107], v[202:203], v[228:229], v[106:107] op_sel_hi:[1,0,1]
    v_pk_fma_f32 v[124:125], v[204:205], v[228:229], v[124:125] op_sel_hi:[1,0,1]
    v_pk_fma_f32 v[126:127], v[206:207], v[228:229], v[126:127] op_sel_hi:[1,0,1]
    v_pk_fma_f32 v[128:129], v[208:209], v[228:229], v[128:129] op_sel_hi:[1,0,1]
    v_pk_fma_f32 v[130:131], v[210:211], v[228:229], v[130:131] op_sel_hi:[1,0,1]
    v_pk_fma_f32 v[132:133], v[212:213], v[228:229], v[132:133] op_sel_hi:[1,0,1]
    v_pk_fma_f32 v[134:135], v[214:215], v[228:229], v[134:135] op_sel_hi:[1,0,1]
    v_pk_fma_f32 v[136:137], v[216:217], v[228:229], v[136:137] op_sel_hi:[1,0,1]
    v_pk_fma_f32 v[138:139], v[218:219], v[228:229], v[138:139] op_sel_hi:[1,0,1]
    v_pk_mul_f32 v[132:133], v[132:133], v[236:237] op_sel_hi:[1,0]
    v_pk_mul_f32 v[134:135], v[134:135], v[236:237] op_sel_hi:[1,0]
    v_pk_mul_f32 v[136:137], v[136:137], v[236:237] op_sel_hi:[1,0]
    v_pk_mul_f32 v[138:139], v[138:139], v[236:237] op_sel_hi:[1,0]
    v_pk_mul_f32 v[104:105], v[104:105], v[236:237] op_sel_hi:[1,0]
    v_pk_mul_f32 v[106:107], v[106:107], v[236:237] op_sel_hi:[1,0]
    v_cvt_pk_bf16_f32 v148, v92, v93
    v_cvt_pk_bf16_f32 v149, v94, v95
    v_cvt_pk_bf16_f32 v150, v96, v97
    v_cvt_pk_bf16_f32 v151, v98, v99
    v_cvt_pk_bf16_f32 v152, v100, v101
    v_cvt_pk_bf16_f32 v153, v102, v103
    v_cvt_pk_bf16_f32 v154, v104, v105
    v_cvt_pk_bf16_f32 v155, v106, v107
    v_cvt_pk_bf16_f32 v164, v124, v125
    v_cvt_pk_bf16_f32 v165, v126, v127
    v_cvt_pk_bf16_f32 v166, v128, v129
    v_cvt_pk_bf16_f32 v167, v130, v131
    v_cvt_pk_bf16_f32 v168, v132, v133
    v_cvt_pk_bf16_f32 v169, v134, v135
    v_cvt_pk_bf16_f32 v170, v136, v137
    v_cvt_pk_bf16_f32 v171, v138, v139
    v_mfma_f32_32x32x16_bf16 v[76:91], v[14:17], v[156:159], 0
    v_mfma_f32_32x32x16_bf16 v[76:91], v[22:25], v[144:147], v[76:91]
    v_mfma_f32_32x32x16_bf16 v[92:107], v[14:17], v[164:167], 0
    v_mfma_f32_32x32x16_bf16 v[92:107], v[22:25], v[152:155], v[92:107]
    v_mfma_f32_32x32x16_bf16 v[108:123], v[14:17], v[140:143], 0
    v_mfma_f32_32x32x16_bf16 v[108:123], v[18:21], v[144:147], v[108:123]
    v_mfma_f32_32x32x16_bf16 v[124:139], v[14:17], v[148:151], 0
    v_mfma_f32_32x32x16_bf16 v[124:139], v[18:21], v[152:155], v[124:139]
    v_and_b32 v4, 31, v1
    s_lshl_b32 s4, s23, 6
    v_add_u32 v5, s4, v4
    v_lshlrev_b32 v5, 6, v5
    s_lshl_b32 s5, s22, 13
    v_add_u32 v5, s5, v5
    v_bfe_u32 v6, v1, 1, 2
    v_lshrrev_b32 v7, 5, v1
    v_xor_b32 v8, 1, v7
    v_xor_b32_e64 v9, v7, v6
    v_lshl_add_u32 v242, v9, 4, v5
    v_add_u32 v10, 1, v7
    v_xor_b32 v9, v10, v6
    v_lshl_add_u32 v243, v9, 4, v5
    v_lshl_add_u32 v243, v8, 3, v243
    v_lshlrev_b32 v10, 1, v7
    v_xor_b32 v9, v10, v6
    v_lshl_add_u32 v244, v9, 4, v5
    v_add_u32_e64 v244, 8, v244
    v_add_u32 v242, 135168, v242
    v_add_u32 v243, 135168, v243
    v_add_u32 v244, 135168, v244
    ds_write_b64 v242, v[160:161] offset:0
    ds_write_b64 v243, v[162:163] offset:0
    ds_write_b64 v244, v[146:147] offset:0
    ds_write_b64 v242, v[168:169] offset:2048
    ds_write_b64 v243, v[170:171] offset:2048
    ds_write_b64 v244, v[154:155] offset:2048
    v_mov_b32 v184, 0x3f80
    v_mov_b32_e64 v185, 0
    v_mov_b32 v186, 0x3f80
    v_mov_b32 v187, 0
    v_add_u32 v10, s4, v1
    v_lshlrev_b32 v10, 6, v10
    v_add_u32 v10, s5, v10
    v_xor_b32_e64 v9, 3, v6
    v_lshl_add_u32 v10, v9, 4, v10
    v_add_u32 v10, 135168, v10
    ds_write_b128 v10, v[184:187]
    v_xor_b32_e64 v9, 0, v6
    v_lshl_add_u32 v245, v9, 4, v5
    v_lshl_add_u32 v245, v7, 3, v245
    v_add_u32 v245, 102400, v245
    v_xor_b32_e64 v9, 1, v6
    v_lshl_add_u32 v246, v9, 4, v5
    v_lshl_add_u32 v246, v7, 3, v246
    v_add_u32 v246, 102400, v246
    v_xor_b32_e64 v9, 2, v6
    v_lshl_add_u32 v247, v9, 4, v5
    v_lshl_add_u32 v247, v7, 3, v247
    v_add_u32 v247, 102400, v247
    v_xor_b32_e64 v9, 3, v6
    v_lshl_add_u32 v248, v9, 4, v5
    v_lshl_add_u32 v248, v7, 3, v248
    v_add_u32 v248, 102400, v248
    v_max3_f32 v188, v76, v77, v78
    v_max3_f32 v189, -v76, -v77, -v78
    v_max3_f32 v188, v188, v79, v80
    v_max3_f32 v189, v189, -v79, -v80
    v_max3_f32 v188, v188, v81, v82
    v_max3_f32 v189, v189, -v81, -v82
    v_max3_f32 v188, v188, v83, v84
    v_max3_f32 v189, v189, -v83, -v84
    v_max_f32_e64 v188, v188, v85
    v_max_f32_e64 v189, v189, -v85
    s_nop 1
    v_permlane32_swap_b32 v188, v189
    v_max_f32 v188, v188, v189
    v_mov_b32 v189, v188
    s_nop 1
    v_permlane32_swap_b32 v188, v189
    v_mul_f32 v212, v231, v188
    v_mul_f32 v214, v231, v189
    v_pk_fma_f32 v[192:193], v[76:77], v[230:231], v[212:213] op_sel_hi:[1,0,0]
    v_pk_fma_f32 v[202:203], v[76:77], v[230:231], v[214:215] op_sel:[0,1,0] op_sel_hi:[1,1,0]
    v_pk_fma_f32 v[194:195], v[78:79], v[230:231], v[212:213] op_sel_hi:[1,0,0]
    v_pk_fma_f32 v[204:205], v[78:79], v[230:231], v[214:215] op_sel:[0,1,0] op_sel_hi:[1,1,0]
    v_pk_fma_f32 v[196:197], v[80:81], v[230:231], v[212:213] op_sel_hi:[1,0,0]
    v_pk_fma_f32 v[206:207], v[80:81], v[230:231], v[214:215] op_sel:[0,1,0] op_sel_hi:[1,1,0]
    v_pk_fma_f32 v[198:199], v[82:83], v[230:231], v[212:213] op_sel_hi:[1,0,0]
    v_pk_fma_f32 v[208:209], v[82:83], v[230:231], v[214:215] op_sel:[0,1,0] op_sel_hi:[1,1,0]
    v_pk_fma_f32 v[200:201], v[84:85], v[230:231], v[212:213] op_sel_hi:[1,0,0]
    v_pk_fma_f32 v[210:211], v[84:85], v[230:231], v[214:215] op_sel:[0,1,0] op_sel_hi:[1,1,0]
    v_exp_f32 v192, v192
    v_exp_f32 v202, v202
    v_exp_f32 v193, v193
    v_exp_f32 v203, v203
    v_exp_f32 v194, v194
    v_exp_f32 v204, v204
    v_exp_f32 v195, v195
    v_exp_f32 v205, v205
    v_exp_f32 v196, v196
    v_exp_f32 v206, v206
    v_exp_f32 v197, v197
    v_exp_f32 v207, v207
    v_exp_f32 v198, v198
    v_exp_f32 v208, v208
    v_exp_f32 v199, v199
    v_exp_f32 v209, v209
    v_exp_f32 v200, v200
    v_exp_f32 v210, v210
    v_exp_f32 v201, v201
    v_exp_f32 v211, v211
    v_pk_add_f32 v[212:213], v[192:193], v[194:195]
    v_pk_add_f32 v[214:215], v[202:203], v[204:205]
    v_pk_add_f32 v[212:213], v[212:213], v[196:197]
    v_pk_add_f32 v[214:215], v[214:215], v[206:207]
    v_pk_add_f32 v[212:213], v[212:213], v[198:199]
    v_pk_add_f32 v[214:215], v[214:215], v[208:209]
    v_pk_add_f32 v[212:213], v[212:213], v[200:201]
    v_pk_add_f32 v[214:215], v[214:215], v[210:211]
    v_add_f32 v188, v212, v213
    v_add_f32 v189, v214, v215
    s_nop 1
    v_permlane32_swap_b32 v188, v189
    v_add_f32 v188, v188, v189
    v_mov_b32 v189, v188
    s_nop 1
    v_permlane32_swap_b32 v188, v189
    v_rcp_f32 v212, v188
    v_rcp_f32 v214, v189
    v_pk_mul_f32 v[192:193], v[192:193], v[212:213] op_sel_hi:[1,0]
    v_pk_mul_f32 v[202:203], v[202:203], v[214:215] op_sel_hi:[1,0]
    v_pk_mul_f32 v[194:195], v[194:195], v[212:213] op_sel_hi:[1,0]
    v_pk_mul_f32 v[204:205], v[204:205], v[214:215] op_sel_hi:[1,0]
    v_pk_mul_f32 v[196:197], v[196:197], v[212:213] op_sel_hi:[1,0]
    v_pk_mul_f32 v[206:207], v[206:207], v[214:215] op_sel_hi:[1,0]
    v_pk_mul_f32 v[198:199], v[198:199], v[212:213] op_sel_hi:[1,0]
    v_pk_mul_f32 v[208:209], v[208:209], v[214:215] op_sel_hi:[1,0]
    v_pk_mul_f32 v[200:201], v[200:201], v[212:213] op_sel_hi:[1,0]
    v_pk_mul_f32 v[210:211], v[210:211], v[214:215] op_sel_hi:[1,0]
    v_cvt_pk_bf16_f32 v172, v192, v193
    v_cvt_pk_bf16_f32 v177, v202, v203
    v_cvt_pk_bf16_f32 v173, v194, v195
    v_cvt_pk_bf16_f32 v178, v204, v205
    v_cvt_pk_bf16_f32 v174, v196, v197
    v_cvt_pk_bf16_f32 v179, v206, v207
    v_cvt_pk_bf16_f32 v175, v198, v199
    v_cvt_pk_bf16_f32 v180, v208, v209
    v_cvt_pk_bf16_f32 v176, v200, v201
    v_cvt_pk_bf16_f32 v181, v210, v211
    ds_write_b64 v245, v[172:173] offset:0
    ds_write_b64 v246, v[174:175] offset:0
    ds_write_b64 v247, v[176:177] offset:0
    ds_write_b64 v248, v[178:179] offset:0
    ds_write_b64 v245, v[180:181] offset:16384
    v_max3_f32 v188, v92, v93, v94
    v_max3_f32 v189, -v92, -v93, -v94
    v_max3_f32 v188, v188, v95, v96
    v_max3_f32 v189, v189, -v95, -v96
    v_max3_f32 v188, v188, v97, v98
    v_max3_f32 v189, v189, -v97, -v98
    v_max3_f32 v188, v188, v99, v100
    v_max3_f32 v189, v189, -v99, -v100
    v_max_f32_e64 v188, v188, v101
    v_max_f32_e64 v189, v189, -v101
    s_nop 1
    v_permlane32_swap_b32 v188, v189
    v_max_f32 v188, v188, v189
    v_mov_b32 v189, v188
    s_nop 1
    v_permlane32_swap_b32 v188, v189
    v_mul_f32 v212, v233, v188
    v_mul_f32 v214, v233, v189
    v_pk_fma_f32 v[192:193], v[92:93], v[232:233], v[212:213] op_sel_hi:[1,0,0]
    v_pk_fma_f32 v[202:203], v[92:93], v[232:233], v[214:215] op_sel:[0,1,0] op_sel_hi:[1,1,0]
    v_pk_fma_f32 v[194:195], v[94:95], v[232:233], v[212:213] op_sel_hi:[1,0,0]
    v_pk_fma_f32 v[204:205], v[94:95], v[232:233], v[214:215] op_sel:[0,1,0] op_sel_hi:[1,1,0]
    v_pk_fma_f32 v[196:197], v[96:97], v[232:233], v[212:213] op_sel_hi:[1,0,0]
    v_pk_fma_f32 v[206:207], v[96:97], v[232:233], v[214:215] op_sel:[0,1,0] op_sel_hi:[1,1,0]
    v_pk_fma_f32 v[198:199], v[98:99], v[232:233], v[212:213] op_sel_hi:[1,0,0]
    v_pk_fma_f32 v[208:209], v[98:99], v[232:233], v[214:215] op_sel:[0,1,0] op_sel_hi:[1,1,0]
    v_pk_fma_f32 v[200:201], v[100:101], v[232:233], v[212:213] op_sel_hi:[1,0,0]
    v_pk_fma_f32 v[210:211], v[100:101], v[232:233], v[214:215] op_sel:[0,1,0] op_sel_hi:[1,1,0]
    v_exp_f32 v192, v192
    v_exp_f32 v202, v202
    v_exp_f32 v193, v193
    v_exp_f32 v203, v203
    v_exp_f32 v194, v194
    v_exp_f32 v204, v204
    v_exp_f32 v195, v195
    v_exp_f32 v205, v205
    v_exp_f32 v196, v196
    v_exp_f32 v206, v206
    v_exp_f32 v197, v197
    v_exp_f32 v207, v207
    v_exp_f32 v198, v198
    v_exp_f32 v208, v208
    v_exp_f32 v199, v199
    v_exp_f32 v209, v209
    v_exp_f32 v200, v200
    v_exp_f32 v210, v210
    v_exp_f32 v201, v201
    v_exp_f32 v211, v211
    v_pk_add_f32 v[212:213], v[192:193], v[194:195]
    v_pk_add_f32 v[214:215], v[202:203], v[204:205]
    v_pk_add_f32 v[212:213], v[212:213], v[196:197]
    v_pk_add_f32 v[214:215], v[214:215], v[206:207]
    v_pk_add_f32 v[212:213], v[212:213], v[198:199]
    v_pk_add_f32 v[214:215], v[214:215], v[208:209]
    v_pk_add_f32 v[212:213], v[212:213], v[200:201]
    v_pk_add_f32 v[214:215], v[214:215], v[210:211]
    v_add_f32 v188, v212, v213
    v_add_f32 v189, v214, v215
    s_nop 1
    v_permlane32_swap_b32 v188, v189
    v_add_f32 v188, v188, v189
    v_mov_b32 v189, v188
    s_nop 1
    v_permlane32_swap_b32 v188, v189
    v_rcp_f32 v212, v188
    v_rcp_f32 v214, v189
    v_pk_mul_f32 v[192:193], v[192:193], v[212:213] op_sel_hi:[1,0]
    v_pk_mul_f32 v[202:203], v[202:203], v[214:215] op_sel_hi:[1,0]
    v_pk_mul_f32 v[194:195], v[194:195], v[212:213] op_sel_hi:[1,0]
    v_pk_mul_f32 v[204:205], v[204:205], v[214:215] op_sel_hi:[1,0]
    v_pk_mul_f32 v[196:197], v[196:197], v[212:213] op_sel_hi:[1,0]
    v_pk_mul_f32 v[206:207], v[206:207], v[214:215] op_sel_hi:[1,0]
    v_pk_mul_f32 v[198:199], v[198:199], v[212:213] op_sel_hi:[1,0]
    v_pk_mul_f32 v[208:209], v[208:209], v[214:215] op_sel_hi:[1,0]
    v_pk_mul_f32 v[200:201], v[200:201], v[212:213] op_sel_hi:[1,0]
    v_pk_mul_f32 v[210:211], v[210:211], v[214:215] op_sel_hi:[1,0]
    v_cvt_pk_bf16_f32 v172, v192, v193
    v_cvt_pk_bf16_f32 v177, v202, v203
    v_cvt_pk_bf16_f32 v173, v194, v195
    v_cvt_pk_bf16_f32 v178, v204, v205
    v_cvt_pk_bf16_f32 v174, v196, v197
    v_cvt_pk_bf16_f32 v179, v206, v207
    v_cvt_pk_bf16_f32 v175, v198, v199
    v_cvt_pk_bf16_f32 v180, v208, v209
    v_cvt_pk_bf16_f32 v176, v200, v201
    v_cvt_pk_bf16_f32 v181, v210, v211
    ds_write_b64 v245, v[172:173] offset:2048
    ds_write_b64 v246, v[174:175] offset:2048
    ds_write_b64 v247, v[176:177] offset:2048
    ds_write_b64 v248, v[178:179] offset:2048
    ds_write_b64 v245, v[180:181] offset:18432
    s_waitcnt lgkmcnt(0)
    s_barrier
    s_mul_i32 s4, s16, 102400
    s_add_u32 s4, s4, 27262976
    v_add_u32 v73, s4, v12
    s_mov_b32 s29, 0
    s_cmp_eq_u32 s23, 0
    s_cbranch_scc1 L_kvw_24
    s_waitcnt vmcnt(10)
    s_mov_b32 s19, 0
L_pkd_26:
    v_cmp_gt_u32 vcc, 16, v224
    s_add_u32 s19, s19, 1
    s_and_b32 s4, vcc_lo, 0xffff
    s_cmp_eq_u32 s4, 0
    s_cbranch_scc1 L_pkdd_27
    s_mov_b64 exec, 0xffff
    buffer_load_dword v224, v225, s[40:43], 0 offen sc1
    s_mov_b64 exec, -1
    s_waitcnt vmcnt(0)
    s_cmp_lt_u32 s19, 200000
    s_cbranch_scc1 L_pkd_26
L_pkdd_27:
    s_sub_u32 s4, s14, 2
    s_mul_i32 s29, s4, 51200
    v_max3_f32 v188, v108, v109, v110
    v_max3_f32 v189, -v108, -v109, -v110
    s_mov_b32 m0, s29
    s_nop 0
    buffer_load_dwordx4 v73, s[40:43], s29 offen sc1 lds
    v_max3_f32 v188, v188, v111, v112
    v_max3_f32 v189, v189, -v111, -v112
    v_max3_f32 v188, v188, v113, v114
    v_max3_f32 v189, v189, -v113, -v114
    v_max3_f32 v188, v188, v115, v116
    buffer_load_dwordx4 v73, s[40:43], s29 offen offset:1024 sc1 lds
    v_max3_f32 v189, v189, -v115, -v116
    v_max_f32_e64 v188, v188, v117
    v_max_f32_e64 v189, v189, -v117
    s_nop 1
    v_permlane32_swap_b32 v188, v189
    v_max_f32_e64 v188, v188, v189
    buffer_load_dwordx4 v73, s[40:43], s29 offen offset:2048 sc1 lds
    v_mov_b32 v189, v188
    s_nop 1
    v_permlane32_swap_b32 v188, v189
    v_mul_f32 v212, v231, v188
    v_mul_f32_e64 v214, v231, v189
    v_pk_fma_f32 v[192:193], v[108:109], v[230:231], v[212:213] op_sel_hi:[1,0,0]
    buffer_load_dwordx4 v73, s[40:43], s29 offen offset:3072 sc1 lds
    v_pk_fma_f32 v[202:203], v[108:109], v[230:231], v[214:215] op_sel:[0,1,0] op_sel_hi:[1,1,0]
    v_pk_fma_f32 v[194:195], v[110:111], v[230:231], v[212:213] op_sel_hi:[1,0,0]
    v_pk_fma_f32 v[204:205], v[110:111], v[230:231], v[214:215] op_sel:[0,1,0] op_sel_hi:[1,1,0]
    v_pk_fma_f32 v[196:197], v[112:113], v[230:231], v[212:213] op_sel_hi:[1,0,0]
    v_pk_fma_f32 v[206:207], v[112:113], v[230:231], v[214:215] op_sel:[0,1,0] op_sel_hi:[1,1,0]
    s_add_u32 s28, s29, 4096
    s_mov_b32 m0, s28
    s_nop 0
    buffer_load_dwordx4 v73, s[40:43], s28 offen sc1 lds
    v_pk_fma_f32 v[198:199], v[114:115], v[230:231], v[212:213] op_sel_hi:[1,0,0]
    v_pk_fma_f32 v[208:209], v[114:115], v[230:231], v[214:215] op_sel:[0,1,0] op_sel_hi:[1,1,0]
    v_pk_fma_f32 v[200:201], v[116:117], v[230:231], v[212:213] op_sel_hi:[1,0,0]
    v_pk_fma_f32 v[210:211], v[116:117], v[230:231], v[214:215] op_sel:[0,1,0] op_sel_hi:[1,1,0]
    v_exp_f32_e64 v192, v192
    s_add_u32 s29, s29, 5120
    s_mov_b32 m0, s29
    s_nop 0
    buffer_load_dwordx4 v73, s[40:43], s29 offen sc1 lds
    v_exp_f32 v202, v202
    v_exp_f32 v193, v193
    v_exp_f32 v203, v203
    v_exp_f32 v194, v194
    v_exp_f32_e64 v204, v204
    buffer_load_dwordx4 v73, s[40:43], s29 offen offset:1024 sc1 lds
    v_exp_f32 v195, v195
    v_exp_f32 v205, v205
    v_exp_f32 v196, v196
    v_exp_f32 v206, v206
    v_exp_f32_e64 v197, v197
    buffer_load_dwordx4 v73, s[40:43], s29 offen offset:2048 sc1 lds
    v_exp_f32 v207, v207
    v_exp_f32 v198, v198
    v_exp_f32 v208, v208
    v_exp_f32 v199, v199
    v_exp_f32_e64 v209, v209
    buffer_load_dwordx4 v73, s[40:43], s29 offen offset:3072 sc1 lds
    v_exp_f32 v200, v200
    v_exp_f32 v210, v210
    v_exp_f32 v201, v201
    v_exp_f32 v211, v211
    v_pk_add_f32 v[212:213], v[192:193], v[194:195]
    s_add_u32 s28, s29, 4096
    s_mov_b32 m0, s28
    s_nop 0
    buffer_load_dwordx4 v73, s[40:43], s28 offen sc1 lds
    v_pk_add_f32 v[214:215], v[202:203], v[204:205]
    v_pk_add_f32 v[212:213], v[212:213], v[196:197]
    v_pk_add_f32 v[214:215], v[214:215], v[206:207]
    v_pk_add_f32 v[212:213], v[212:213], v[198:199]
    v_pk_add_f32 v[214:215], v[214:215], v[208:209]
    s_add_u32 s29, s29, 5120
    s_mov_b32 m0, s29
    s_nop 0
    buffer_load_dwordx4 v73, s[40:43], s29 offen sc1 lds
    v_pk_add_f32 v[212:213], v[212:213], v[200:201]
    v_pk_add_f32 v[214:215], v[214:215], v[210:211]
    v_add_f32 v188, v212, v213
    v_add_f32 v189, v214, v215
    s_nop 1
    v_permlane32_swap_b32 v188, v189
    buffer_load_dwordx4 v73, s[40:43], s29 offen offset:1024 sc1 lds
    v_add_f32 v188, v188, v189
    v_mov_b32 v189, v188
    s_nop 1
    v_permlane32_swap_b32 v188, v189
    v_rcp_f32 v212, v188
    v_rcp_f32 v214, v189
    buffer_load_dwordx4 v73, s[40:43], s29 offen offset:2048 sc1 lds
    v_pk_mul_f32 v[192:193], v[192:193], v[212:213] op_sel_hi:[1,0]
    v_pk_mul_f32 v[202:203], v[202:203], v[214:215] op_sel_hi:[1,0]
    v_pk_mul_f32 v[194:195], v[194:195], v[212:213] op_sel_hi:[1,0]
    v_pk_mul_f32 v[204:205], v[204:205], v[214:215] op_sel_hi:[1,0]
    v_pk_mul_f32 v[196:197], v[196:197], v[212:213] op_sel_hi:[1,0]
    buffer_load_dwordx4 v73, s[40:43], s29 offen offset:3072 sc1 lds
    v_pk_mul_f32 v[206:207], v[206:207], v[214:215] op_sel_hi:[1,0]
    v_pk_mul_f32 v[198:199], v[198:199], v[212:213] op_sel_hi:[1,0]
    v_pk_mul_f32 v[208:209], v[208:209], v[214:215] op_sel_hi:[1,0]
    v_pk_mul_f32 v[200:201], v[200:201], v[212:213] op_sel_hi:[1,0]
    v_pk_mul_f32 v[210:211], v[210:211], v[214:215] op_sel_hi:[1,0]
    s_add_u32 s28, s29, 4096
    s_mov_b32 m0, s28
    s_nop 0
    buffer_load_dwordx4 v73, s[40:43], s28 offen sc1 lds
    v_cvt_pk_bf16_f32 v28, v192, v193
    v_cvt_pk_bf16_f32 v33, v202, v203
    v_cvt_pk_bf16_f32 v29, v194, v195
    v_cvt_pk_bf16_f32 v34, v204, v205
    v_cvt_pk_bf16_f32 v30, v196, v197
    s_add_u32 s29, s29, 5120
    s_mov_b32 m0, s29
    s_nop 0
    buffer_load_dwordx4 v73, s[40:43], s29 offen sc1 lds
    v_cvt_pk_bf16_f32 v35, v206, v207
    v_cvt_pk_bf16_f32 v31, v198, v199
    v_cvt_pk_bf16_f32 v36, v208, v209
    v_cvt_pk_bf16_f32 v32, v200, v201
    v_cvt_pk_bf16_f32 v37, v210, v211
    buffer_load_dwordx4 v73, s[40:43], s29 offen offset:1024 sc1 lds
    v_mov_b32 v38, 0
    v_mov_b32 v39, 0
    v_max3_f32 v188, v124, v125, v126
    v_max3_f32 v189, -v124, -v125, -v126
    v_max3_f32 v188, v188, v127, v128
    buffer_load_dwordx4 v73, s[40:43], s29 offen offset:2048 sc1 lds
    v_max3_f32 v189, v189, -v127, -v128
    v_max3_f32 v188, v188, v129, v130
    v_max3_f32 v189, v189, -v129, -v130
    v_max3_f32 v188, v188, v131, v132
    v_max3_f32 v189, v189, -v131, -v132
    buffer_load_dwordx4 v73, s[40:43], s29 offen offset:3072 sc1 lds
    v_max_f32_e64 v188, v188, v133
    v_max_f32_e64 v189, v189, -v133
    s_nop 1
    v_permlane32_swap_b32 v188, v189
    v_max_f32 v188, v188, v189
    v_mov_b32 v189, v188
    s_add_u32 s28, s29, 4096
    s_mov_b32 m0, s28
    s_nop 0
    buffer_load_dwordx4 v73, s[40:43], s28 offen sc1 lds
    v_permlane32_swap_b32 v188, v189
    v_mul_f32 v212, v233, v188
    v_mul_f32_e64 v214, v233, v189
    v_pk_fma_f32 v[192:193], v[124:125], v[232:233], v[212:213] op_sel_hi:[1,0,0]
    v_pk_fma_f32 v[202:203], v[124:125], v[232:233], v[214:215] op_sel:[0,1,0] op_sel_hi:[1,1,0]
    s_add_u32 s29, s29, 5120
    s_mov_b32 m0, s29
    s_nop 0
    buffer_load_dwordx4 v73, s[40:43], s29 offen sc1 lds
    v_pk_fma_f32 v[194:195], v[126:127], v[232:233], v[212:213] op_sel_hi:[1,0,0]
    v_pk_fma_f32 v[204:205], v[126:127], v[232:233], v[214:215] op_sel:[0,1,0] op_sel_hi:[1,1,0]
    v_pk_fma_f32 v[196:197], v[128:129], v[232:233], v[212:213] op_sel_hi:[1,0,0]
    v_pk_fma_f32 v[206:207], v[128:129], v[232:233], v[214:215] op_sel:[0,1,0] op_sel_hi:[1,1,0]
    v_pk_fma_f32 v[198:199], v[130:131], v[232:233], v[212:213] op_sel_hi:[1,0,0]
    buffer_load_dwordx4 v73, s[40:43], s29 offen offset:1024 sc1 lds
    v_pk_fma_f32 v[208:209], v[130:131], v[232:233], v[214:215] op_sel:[0,1,0] op_sel_hi:[1,1,0]
    v_pk_fma_f32 v[200:201], v[132:133], v[232:233], v[212:213] op_sel_hi:[1,0,0]
    v_pk_fma_f32 v[210:211], v[132:133], v[232:233], v[214:215] op_sel:[0,1,0] op_sel_hi:[1,1,0]
    v_exp_f32 v192, v192
    v_exp_f32 v202, v202
    buffer_load_dwordx4 v73, s[40:43], s29 offen offset:2048 sc1 lds
    v_exp_f32 v193, v193
    v_exp_f32 v203, v203
    v_exp_f32 v194, v194
    v_exp_f32 v204, v204
    v_exp_f32_e64 v195, v195
    buffer_load_dwordx4 v73, s[40:43], s29 offen offset:3072 sc1 lds
    v_exp_f32 v205, v205
    v_exp_f32 v196, v196
    v_exp_f32 v206, v206
    v_exp_f32 v197, v197
    v_exp_f32_e64 v207, v207
    s_add_u32 s28, s29, 4096
    s_mov_b32 m0, s28
    s_nop 0
    buffer_load_dwordx4 v73, s[40:43], s28 offen sc1 lds
    v_exp_f32 v198, v198
    v_exp_f32 v208, v208
    v_exp_f32 v199, v199
    v_exp_f32 v209, v209
    v_exp_f32_e64 v200, v200
    s_add_u32 s29, s29, 5120
    s_mov_b32 m0, s29
    s_nop 0
    buffer_load_dwordx4 v73, s[40:43], s29 offen sc1 lds
    v_exp_f32 v210, v210
    v_exp_f32 v201, v201
    v_exp_f32_e64 v211, v211
    v_pk_add_f32 v[212:213], v[192:193], v[194:195]
    v_pk_add_f32 v[214:215], v[202:203], v[204:205]
    buffer_load_dwordx4 v73, s[40:43], s29 offen offset:1024 sc1 lds
    v_pk_add_f32 v[212:213], v[212:213], v[196:197]
    v_pk_add_f32 v[214:215], v[214:215], v[206:207]
    v_pk_add_f32 v[212:213], v[212:213], v[198:199]
    v_pk_add_f32 v[214:215], v[214:215], v[208:209]
    v_pk_add_f32 v[212:213], v[212:213], v[200:201]
    buffer_load_dwordx4 v73, s[40:43], s29 offen offset:2048 sc1 lds
    v_pk_add_f32 v[214:215], v[214:215], v[210:211]
    v_add_f32 v188, v212, v213
    v_add_f32 v189, v214, v215
    s_nop 1
    v_permlane32_swap_b32 v188, v189
    v_add_f32_e64 v188, v188, v189
    buffer_load_dwordx4 v73, s[40:43], s29 offen offset:3072 sc1 lds
    v_mov_b32 v189, v188
    s_nop 1
    v_permlane32_swap_b32 v188, v189
    v_rcp_f32 v212, v188
    v_rcp_f32_e64 v214, v189
    v_pk_mul_f32 v[192:193], v[192:193], v[212:213] op_sel_hi:[1,0]
    s_add_u32 s28, s29, 4096
    s_mov_b32 m0, s28
    s_nop 0
    buffer_load_dwordx4 v73, s[40:43], s28 offen sc1 lds
    v_pk_mul_f32 v[202:203], v[202:203], v[214:215] op_sel_hi:[1,0]
    v_pk_mul_f32 v[194:195], v[194:195], v[212:213] op_sel_hi:[1,0]
    v_pk_mul_f32 v[204:205], v[204:205], v[214:215] op_sel_hi:[1,0]
    v_pk_mul_f32 v[196:197], v[196:197], v[212:213] op_sel_hi:[1,0]
    v_pk_mul_f32 v[206:207], v[206:207], v[214:215] op_sel_hi:[1,0]
    s_add_u32 s29, s29, 5120
    s_mov_b32 m0, s29
    s_nop 0
    buffer_load_dwordx4 v73, s[40:43], s29 offen sc1 lds
    v_pk_mul_f32 v[198:199], v[198:199], v[212:213] op_sel_hi:[1,0]
    v_pk_mul_f32 v[208:209], v[208:209], v[214:215] op_sel_hi:[1,0]
    v_pk_mul_f32 v[200:201], v[200:201], v[212:213] op_sel_hi:[1,0]
    v_pk_mul_f32 v[210:211], v[210:211], v[214:215] op_sel_hi:[1,0]
    v_cvt_pk_bf16_f32 v40, v192, v193
    buffer_load_dwordx4 v73, s[40:43], s29 offen offset:1024 sc1 lds
    v_cvt_pk_bf16_f32 v45, v202, v203
    v_cvt_pk_bf16_f32 v41, v194, v195
    v_cvt_pk_bf16_f32 v46, v204, v205
    v_cvt_pk_bf16_f32 v42, v196, v197
    v_cvt_pk_bf16_f32 v47, v206, v207
    buffer_load_dwordx4 v73, s[40:43], s29 offen offset:2048 sc1 lds
    v_cvt_pk_bf16_f32 v43, v198, v199
    v_cvt_pk_bf16_f32 v48, v208, v209
    v_cvt_pk_bf16_f32 v44, v200, v201
    v_cvt_pk_bf16_f32 v49, v210, v211
    v_mov_b32_e64 v50, 0
    buffer_load_dwordx4 v73, s[40:43], s29 offen offset:3072 sc1 lds
    v_mov_b32_e64 v51, 0
    s_add_u32 s28, s29, 4096
    s_mov_b32 m0, s28
    s_nop 0
    buffer_load_dwordx4 v73, s[40:43], s28 offen sc1 lds
    s_branch L_kve_25
L_kvw_24:
    v_lshrrev_b32 v4, 5, v1
    v_bfe_u32 v5, v1, 2, 2
    v_lshl_add_u32 v4, v4, 3, v5
    v_lshlrev_b32_e64 v4, 6, v4
    v_bfe_u32 v6, v1, 4, 1
    v_bfe_u32 v7, v1, 1, 1
    v_lshl_add_u32 v6, v6, 1, v7
    v_lshrrev_b32 v5, 1, v5
    v_xor_b32 v6, v6, v5
    v_and_b32 v7, 1, v1
    v_lshlrev_b32 v7, 3, v7
    v_add_u32 v4, v4, v7
    s_lshl_b32 s5, s22, 13
    s_add_u32 s6, s5, 102400
    s_add_u32 s5, s5, 135168
    v_xor_b32_e64 v8, 0, v6
    v_lshl_add_u32 v8, v8, 4, v4
    v_add_u32 v249, s6, v8
    v_add_u32 v251, s5, v8
    v_xor_b32_e64 v8, 2, v6
    v_lshl_add_u32 v8, v8, 4, v4
    v_add_u32 v250, s6, v8
    v_add_u32 v252, s5, v8
    ds_read_b64_tr_b16 v[140:141], v249 offset:0
    ds_read_b64_tr_b16 v[144:145], v251 offset:0
    ds_read_b64_tr_b16 v[142:143], v250 offset:256
    ds_read_b64_tr_b16 v[146:147], v252 offset:256
    ds_read_b64_tr_b16 v[148:149], v249 offset:1024
    ds_read_b64_tr_b16 v[152:153], v251 offset:1024
    ds_read_b64_tr_b16 v[150:151], v250 offset:1280
    ds_read_b64_tr_b16 v[154:155], v252 offset:1280
    ds_read_b64_tr_b16 v[156:157], v249 offset:2048
    ds_read_b64_tr_b16 v[160:161], v251 offset:2048
    ds_read_b64_tr_b16 v[158:159], v250 offset:2304
    ds_read_b64_tr_b16 v[162:163], v252 offset:2304
    ds_read_b64_tr_b16 v[164:165], v249 offset:3072
    ds_read_b64_tr_b16 v[168:169], v251 offset:3072
    ds_read_b64_tr_b16 v[166:167], v250 offset:3328
    ds_read_b64_tr_b16 v[170:171], v252 offset:3328
    ds_read_b64_tr_b16 v[172:173], v249 offset:4096
    ds_read_b64_tr_b16 v[176:177], v251 offset:4096
    ds_read_b64_tr_b16 v[174:175], v250 offset:4352
    ds_read_b64_tr_b16 v[178:179], v252 offset:4352
    ds_read_b64_tr_b16 v[180:181], v249 offset:5120
    ds_read_b64_tr_b16 v[184:185], v251 offset:5120
    ds_read_b64_tr_b16 v[182:183], v250 offset:5376
    ds_read_b64_tr_b16 v[186:187], v252 offset:5376
    ds_read_b64_tr_b16 v[188:189], v249 offset:6144
    ds_read_b64_tr_b16 v[192:193], v251 offset:6144
    ds_read_b64_tr_b16 v[190:191], v250 offset:6400
    ds_read_b64_tr_b16 v[194:195], v252 offset:6400
    ds_read_b64_tr_b16 v[196:197], v249 offset:7168
    ds_read_b64_tr_b16 v[200:201], v251 offset:7168
    ds_read_b64_tr_b16 v[198:199], v250 offset:7424
    ds_read_b64_tr_b16 v[202:203], v252 offset:7424
    s_waitcnt lgkmcnt(15)
    v_mfma_f32_32x32x16_bf16 v[76:91], v[140:143], v[144:147], 0
    ds_read_b64_tr_b16 v[140:141], v249 offset:16384
    ds_read_b64_tr_b16 v[142:143], v250 offset:16640
    s_waitcnt lgkmcnt(15)
    v_mfma_f32_32x32x16_bf16 v[76:91], v[148:151], v[152:155], v[76:91]
    ds_read_b64_tr_b16 v[148:149], v249 offset:17408
    ds_read_b64_tr_b16 v[150:151], v250 offset:17664
    s_waitcnt lgkmcnt(15)
    v_mfma_f32_32x32x16_bf16 v[76:91], v[156:159], v[160:163], v[76:91]
    ds_read_b64_tr_b16 v[156:157], v249 offset:18432
    ds_read_b64_tr_b16 v[158:159], v250 offset:18688
    s_waitcnt lgkmcnt(15)
    v_mfma_f32_32x32x16_bf16 v[76:91], v[164:167], v[168:171], v[76:91]
    ds_read_b64_tr_b16 v[164:165], v249 offset:19456
    ds_read_b64_tr_b16 v[166:167], v250 offset:19712
    s_waitcnt lgkmcnt(15)
    v_mfma_f32_32x32x16_bf16 v[76:91], v[172:175], v[176:179], v[76:91]
    ds_read_b64_tr_b16 v[172:173], v249 offset:20480
    ds_read_b64_tr_b16 v[174:175], v250 offset:20736
    s_waitcnt lgkmcnt(15)
    v_mfma_f32_32x32x16_bf16 v[76:91], v[180:183], v[184:187], v[76:91]
    ds_read_b64_tr_b16 v[180:181], v249 offset:21504
    ds_read_b64_tr_b16 v[182:183], v250 offset:21760
    s_waitcnt lgkmcnt(15)
    v_mfma_f32_32x32x16_bf16 v[76:91], v[188:191], v[192:195], v[76:91]
    ds_read_b64_tr_b16 v[188:189], v249 offset:22528
    ds_read_b64_tr_b16 v[190:191], v250 offset:22784
    s_waitcnt lgkmcnt(14)
    v_mfma_f32_32x32x16_bf16 v[76:91], v[196:199], v[200:203], v[76:91]
    ds_read_b64_tr_b16 v[196:197], v249 offset:23552
    ds_read_b64_tr_b16 v[198:199], v250 offset:23808
    s_waitcnt lgkmcnt(14)
    v_mfma_f32_32x32x16_bf16 v[92:107], v[140:143], v[144:147], 0
    s_waitcnt lgkmcnt(12)
    v_mfma_f32_32x32x16_bf16 v[92:107], v[148:151], v[152:155], v[92:107]
    s_waitcnt lgkmcnt(10)
    v_mfma_f32_32x32x16_bf16 v[92:107], v[156:159], v[160:163], v[92:107]
    s_waitcnt lgkmcnt(8)
    v_mfma_f32_32x32x16_bf16 v[92:107], v[164:167], v[168:171], v[92:107]
    s_waitcnt lgkmcnt(6)
    v_mfma_f32_32x32x16_bf16 v[92:107], v[172:175], v[176:179], v[92:107]
    s_waitcnt lgkmcnt(4)
    v_mfma_f32_32x32x16_bf16 v[92:107], v[180:183], v[184:187], v[92:107]
    s_waitcnt lgkmcnt(2)
    v_mfma_f32_32x32x16_bf16 v[92:107], v[188:191], v[192:195], v[92:107]
    s_waitcnt lgkmcnt(0)
    v_mfma_f32_32x32x16_bf16 v[92:107], v[196:199], v[200:203], v[92:107]
    s_lshl_b32 s4, s13, 4
    s_add_u32 s4, s4, s12
    s_lshl_b32 s4, s4, 1
    s_add_u32 s4, s4, s22
    s_mul_i32 s4, s4, 2560
    s_add_u32 s4, s4, 1048576
    v_add_u32_e64 v4, s4, v12
    v_lshl_add_u32 v5, v1, 3, s4
    v_cvt_pk_bf16_f32 v204, v76, v77
    v_cvt_pk_bf16_f32 v205, v78, v79
    v_cvt_pk_bf16_f32 v206, v80, v81
    v_cvt_pk_bf16_f32 v207, v82, v83
    v_cvt_pk_bf16_f32 v208, v84, v85
    v_cvt_pk_bf16_f32 v209, v86, v87
    v_cvt_pk_bf16_f32 v210, v88, v89
    v_cvt_pk_bf16_f32 v211, v90, v91
    buffer_store_dwordx4 v[204:207], v4, s[40:43], 0 offen sc1
    buffer_store_dwordx4 v[208:211], v4, s[40:43], 0 offen offset:1024 sc1
    v_cvt_pk_bf16_f32 v212, v92, v93
    v_cvt_pk_bf16_f32 v213, v94, v95
    buffer_store_dwordx2 v[212:213], v5, s[40:43], 0 offen offset:2048 sc1
    s_waitcnt vmcnt(0)
L_kve_25:
    s_barrier
    s_cmp_lg_u32 s14, 0
    s_cbranch_scc1 L_sig_28
    s_lshl_b32 s4, s13, 8
    s_add_u32 s4, s4, 8192
    v_mov_b32 v4, s4
    v_mov_b32 v5, 1
    s_mov_b64 exec, 1
    buffer_atomic_add v5, v4, s[40:43], 0 offen sc1
    s_mov_b64 exec, -1
L_sig_28:
    s_cmp_ge_u32 s14, 2
    s_cbranch_scc1 L_qw23_29
    s_nop 0
    buffer_store_dwordx4 a[0:3], v72, s[40:43], 0 offen offset:0 sc1
    buffer_store_dwordx4 a[4:7], v72, s[40:43], 0 offen offset:1024 sc1
    buffer_store_dwordx4 a[8:11], v72, s[40:43], 0 offen offset:2048 sc1
    buffer_store_dwordx4 a[12:15], v72, s[40:43], 0 offen offset:3072 sc1
    v_max3_f32 v188, v108, v109, v110
    v_max3_f32 v189, -v108, -v109, -v110
    v_max3_f32 v188, v188, v111, v112
    v_max3_f32 v189, v189, -v111, -v112
    v_max3_f32 v188, v188, v113, v114
    v_max3_f32 v189, v189, -v113, -v114
    v_max3_f32 v188, v188, v115, v116
    v_max3_f32 v189, v189, -v115, -v116
    v_max_f32_e64 v188, v188, v117
    v_max_f32_e64 v189, v189, -v117
    s_nop 1
    v_permlane32_swap_b32 v188, v189
    v_max_f32 v188, v188, v189
    v_mov_b32 v189, v188
    s_nop 1
    v_permlane32_swap_b32 v188, v189
    v_mul_f32 v212, v231, v188
    v_mul_f32 v214, v231, v189
    v_pk_fma_f32 v[192:193], v[108:109], v[230:231], v[212:213] op_sel_hi:[1,0,0]
    v_pk_fma_f32 v[202:203], v[108:109], v[230:231], v[214:215] op_sel:[0,1,0] op_sel_hi:[1,1,0]
    v_pk_fma_f32 v[194:195], v[110:111], v[230:231], v[212:213] op_sel_hi:[1,0,0]
    v_pk_fma_f32 v[204:205], v[110:111], v[230:231], v[214:215] op_sel:[0,1,0] op_sel_hi:[1,1,0]
    v_pk_fma_f32 v[196:197], v[112:113], v[230:231], v[212:213] op_sel_hi:[1,0,0]
    v_pk_fma_f32 v[206:207], v[112:113], v[230:231], v[214:215] op_sel:[0,1,0] op_sel_hi:[1,1,0]
    v_pk_fma_f32 v[198:199], v[114:115], v[230:231], v[212:213] op_sel_hi:[1,0,0]
    v_pk_fma_f32 v[208:209], v[114:115], v[230:231], v[214:215] op_sel:[0,1,0] op_sel_hi:[1,1,0]
    v_pk_fma_f32 v[200:201], v[116:117], v[230:231], v[212:213] op_sel_hi:[1,0,0]
    v_pk_fma_f32 v[210:211], v[116:117], v[230:231], v[214:215] op_sel:[0,1,0] op_sel_hi:[1,1,0]
    v_exp_f32 v192, v192
    v_exp_f32 v202, v202
    v_exp_f32 v193, v193
    v_exp_f32 v203, v203
    v_exp_f32 v194, v194
    v_exp_f32 v204, v204
    v_exp_f32 v195, v195
    v_exp_f32 v205, v205
    v_exp_f32 v196, v196
    v_exp_f32 v206, v206
    v_exp_f32 v197, v197
    v_exp_f32 v207, v207
    v_exp_f32 v198, v198
    v_exp_f32 v208, v208
    v_exp_f32 v199, v199
    v_exp_f32 v209, v209
    v_exp_f32 v200, v200
    v_exp_f32 v210, v210
    v_exp_f32 v201, v201
    v_exp_f32 v211, v211
    v_pk_add_f32 v[212:213], v[192:193], v[194:195]
    v_pk_add_f32 v[214:215], v[202:203], v[204:205]
    v_pk_add_f32 v[212:213], v[212:213], v[196:197]
    v_pk_add_f32 v[214:215], v[214:215], v[206:207]
    v_pk_add_f32 v[212:213], v[212:213], v[198:199]
    v_pk_add_f32 v[214:215], v[214:215], v[208:209]
    v_pk_add_f32 v[212:213], v[212:213], v[200:201]
    v_pk_add_f32 v[214:215], v[214:215], v[210:211]
    v_add_f32 v188, v212, v213
    v_add_f32 v189, v214, v215
    s_nop 1
    v_permlane32_swap_b32 v188, v189
    v_add_f32 v188, v188, v189
    v_mov_b32 v189, v188
    s_nop 1
    v_permlane32_swap_b32 v188, v189
    v_rcp_f32 v212, v188
    v_rcp_f32 v214, v189
    v_pk_mul_f32 v[192:193], v[192:193], v[212:213] op_sel_hi:[1,0]
    v_pk_mul_f32 v[202:203], v[202:203], v[214:215] op_sel_hi:[1,0]
    v_pk_mul_f32 v[194:195], v[194:195], v[212:213] op_sel_hi:[1,0]
    v_pk_mul_f32 v[204:205], v[204:205], v[214:215] op_sel_hi:[1,0]
    v_pk_mul_f32 v[196:197], v[196:197], v[212:213] op_sel_hi:[1,0]
    v_pk_mul_f32 v[206:207], v[206:207], v[214:215] op_sel_hi:[1,0]
    v_pk_mul_f32 v[198:199], v[198:199], v[212:213] op_sel_hi:[1,0]
    v_pk_mul_f32 v[208:209], v[208:209], v[214:215] op_sel_hi:[1,0]
    v_pk_mul_f32 v[200:201], v[200:201], v[212:213] op_sel_hi:[1,0]
    v_pk_mul_f32 v[210:211], v[210:211], v[214:215] op_sel_hi:[1,0]
    v_cvt_pk_bf16_f32 v28, v192, v193
    v_cvt_pk_bf16_f32 v33, v202, v203
    v_cvt_pk_bf16_f32 v29, v194, v195
    v_cvt_pk_bf16_f32 v34, v204, v205
    v_cvt_pk_bf16_f32 v30, v196, v197
    v_cvt_pk_bf16_f32 v35, v206, v207
    v_cvt_pk_bf16_f32 v31, v198, v199
    v_cvt_pk_bf16_f32 v36, v208, v209
    v_cvt_pk_bf16_f32 v32, v200, v201
    v_cvt_pk_bf16_f32 v37, v210, v211
    v_mov_b32 v38, 0
    v_mov_b32 v39, 0
    v_max3_f32 v188, v124, v125, v126
    v_max3_f32 v189, -v124, -v125, -v126
    v_max3_f32 v188, v188, v127, v128
    v_max3_f32 v189, v189, -v127, -v128
    v_max3_f32 v188, v188, v129, v130
    v_max3_f32 v189, v189, -v129, -v130
    v_max3_f32 v188, v188, v131, v132
    v_max3_f32 v189, v189, -v131, -v132
    v_max_f32_e64 v188, v188, v133
    v_max_f32_e64 v189, v189, -v133
    s_nop 1
    v_permlane32_swap_b32 v188, v189
    v_max_f32 v188, v188, v189
    v_mov_b32 v189, v188
    s_nop 1
    v_permlane32_swap_b32 v188, v189
    v_mul_f32 v212, v233, v188
    v_mul_f32 v214, v233, v189
    v_pk_fma_f32 v[192:193], v[124:125], v[232:233], v[212:213] op_sel_hi:[1,0,0]
    v_pk_fma_f32 v[202:203], v[124:125], v[232:233], v[214:215] op_sel:[0,1,0] op_sel_hi:[1,1,0]
    v_pk_fma_f32 v[194:195], v[126:127], v[232:233], v[212:213] op_sel_hi:[1,0,0]
    v_pk_fma_f32 v[204:205], v[126:127], v[232:233], v[214:215] op_sel:[0,1,0] op_sel_hi:[1,1,0]
    v_pk_fma_f32 v[196:197], v[128:129], v[232:233], v[212:213] op_sel_hi:[1,0,0]
    v_pk_fma_f32 v[206:207], v[128:129], v[232:233], v[214:215] op_sel:[0,1,0] op_sel_hi:[1,1,0]
    v_pk_fma_f32 v[198:199], v[130:131], v[232:233], v[212:213] op_sel_hi:[1,0,0]
    v_pk_fma_f32 v[208:209], v[130:131], v[232:233], v[214:215] op_sel:[0,1,0] op_sel_hi:[1,1,0]
    v_pk_fma_f32 v[200:201], v[132:133], v[232:233], v[212:213] op_sel_hi:[1,0,0]
    v_pk_fma_f32 v[210:211], v[132:133], v[232:233], v[214:215] op_sel:[0,1,0] op_sel_hi:[1,1,0]
    v_exp_f32 v192, v192
    v_exp_f32 v202, v202
    v_exp_f32 v193, v193
    v_exp_f32 v203, v203
    v_exp_f32 v194, v194
    v_exp_f32 v204, v204
    v_exp_f32 v195, v195
    v_exp_f32 v205, v205
    v_exp_f32 v196, v196
    v_exp_f32 v206, v206
    v_exp_f32 v197, v197
    v_exp_f32 v207, v207
    v_exp_f32 v198, v198
    v_exp_f32 v208, v208
    v_exp_f32 v199, v199
    v_exp_f32 v209, v209
    v_exp_f32 v200, v200
    v_exp_f32 v210, v210
    v_exp_f32 v201, v201
    v_exp_f32 v211, v211
    v_pk_add_f32 v[212:213], v[192:193], v[194:195]
    v_pk_add_f32 v[214:215], v[202:203], v[204:205]
    v_pk_add_f32 v[212:213], v[212:213], v[196:197]
    v_pk_add_f32 v[214:215], v[214:215], v[206:207]
    v_pk_add_f32 v[212:213], v[212:213], v[198:199]
    v_pk_add_f32 v[214:215], v[214:215], v[208:209]
    v_pk_add_f32 v[212:213], v[212:213], v[200:201]
    v_pk_add_f32 v[214:215], v[214:215], v[210:211]
    v_add_f32 v188, v212, v213
    v_add_f32 v189, v214, v215
    s_nop 1
    v_permlane32_swap_b32 v188, v189
    v_add_f32 v188, v188, v189
    v_mov_b32 v189, v188
    s_nop 1
    v_permlane32_swap_b32 v188, v189
    v_rcp_f32 v212, v188
    v_rcp_f32 v214, v189
    v_pk_mul_f32 v[192:193], v[192:193], v[212:213] op_sel_hi:[1,0]
    v_pk_mul_f32 v[202:203], v[202:203], v[214:215] op_sel_hi:[1,0]
    v_pk_mul_f32 v[194:195], v[194:195], v[212:213] op_sel_hi:[1,0]
    v_pk_mul_f32 v[204:205], v[204:205], v[214:215] op_sel_hi:[1,0]
    v_pk_mul_f32 v[196:197], v[196:197], v[212:213] op_sel_hi:[1,0]
    v_pk_mul_f32 v[206:207], v[206:207], v[214:215] op_sel_hi:[1,0]
    v_pk_mul_f32 v[198:199], v[198:199], v[212:213] op_sel_hi:[1,0]
    v_pk_mul_f32 v[208:209], v[208:209], v[214:215] op_sel_hi:[1,0]
    v_pk_mul_f32 v[200:201], v[200:201], v[212:213] op_sel_hi:[1,0]
    v_pk_mul_f32 v[210:211], v[210:211], v[214:215] op_sel_hi:[1,0]
    v_cvt_pk_bf16_f32 v40, v192, v193
    v_cvt_pk_bf16_f32 v45, v202, v203
    v_cvt_pk_bf16_f32 v41, v194, v195
    v_cvt_pk_bf16_f32 v46, v204, v205
    v_cvt_pk_bf16_f32 v42, v196, v197
    v_cvt_pk_bf16_f32 v47, v206, v207
    v_cvt_pk_bf16_f32 v43, v198, v199
    v_cvt_pk_bf16_f32 v48, v208, v209
    v_cvt_pk_bf16_f32 v44, v200, v201
    v_cvt_pk_bf16_f32 v49, v210, v211
    v_mov_b32 v50, 0
    v_mov_b32 v51, 0
    s_branch L_qe_30
L_qw23_29:
    s_add_u32 s29, s29, 5120
    s_mov_b32 m0, s29
    s_nop 0
    buffer_load_dwordx4 v73, s[40:43], s29 offen sc1 lds
    buffer_load_dwordx4 v73, s[40:43], s29 offen offset:1024 sc1 lds
    buffer_load_dwordx4 v73, s[40:43], s29 offen offset:2048 sc1 lds
    buffer_load_dwordx4 v73, s[40:43], s29 offen offset:3072 sc1 lds
    s_add_u32 s28, s29, 4096
    s_mov_b32 m0, s28
    s_nop 0
    buffer_load_dwordx4 v73, s[40:43], s28 offen sc1 lds
    s_add_u32 s29, s29, 5120
    s_mov_b32 m0, s29
    s_nop 0
    buffer_load_dwordx4 v73, s[40:43], s29 offen sc1 lds
    buffer_load_dwordx4 v73, s[40:43], s29 offen offset:1024 sc1 lds
    buffer_load_dwordx4 v73, s[40:43], s29 offen offset:2048 sc1 lds
    buffer_load_dwordx4 v73, s[40:43], s29 offen offset:3072 sc1 lds
    s_add_u32 s28, s29, 4096
    s_mov_b32 m0, s28
    s_nop 0
    buffer_load_dwordx4 v73, s[40:43], s28 offen sc1 lds
    s_add_u32 s29, s29, 5120
    s_mov_b32 m0, s29
    s_nop 0
    buffer_load_dwordx4 v73, s[40:43], s29 offen sc1 lds
    buffer_load_dwordx4 v73, s[40:43], s29 offen offset:1024 sc1 lds
    buffer_load_dwordx4 v73, s[40:43], s29 offen offset:2048 sc1 lds
    buffer_load_dwordx4 v73, s[40:43], s29 offen offset:3072 sc1 lds
    s_add_u32 s28, s29, 4096
    s_mov_b32 m0, s28
    s_nop 0
    buffer_load_dwordx4 v73, s[40:43], s28 offen sc1 lds
    s_cmp_lt_u32 s14, 2
    s_cbranch_scc1 L_guf_31
    s_mul_i32 s6, s12, 40
    s_sub_u32 s7, s14, 2
    s_lshl_b32 s7, s7, 2
    s_waitcnt vmcnt(50)
    v_and_b32 v4, 15, v1
    v_mov_b32 v144, 0
    v_cmp_eq_u32 vcc, 0, v4
    v_mov_b32 v5, 0x3f80
    s_nop 0
    v_cndmask_b32 v144, v144, v5, vcc
    v_cmp_eq_u32 vcc, 1, v4
    v_mov_b32 v5, 0x3f800000
    s_nop 0
    v_cndmask_b32 v144, v144, v5, vcc
    v_mov_b32 v145, 0
    v_cmp_eq_u32 vcc, 2, v4
    v_mov_b32 v5, 0x3f80
    s_nop 0
    v_cndmask_b32 v145, v145, v5, vcc
    v_cmp_eq_u32 vcc, 3, v4
    v_mov_b32 v5, 0x3f800000
    s_nop 0
    v_cndmask_b32 v145, v145, v5, vcc
    v_mov_b32 v146, 0
    v_cmp_eq_u32 vcc, 4, v4
    v_mov_b32 v5, 0x3f80
    s_nop 0
    v_cndmask_b32 v146, v146, v5, vcc
    v_cmp_eq_u32 vcc, 5, v4
    v_mov_b32 v5, 0x3f800000
    s_nop 0
    v_cndmask_b32 v146, v146, v5, vcc
    v_mov_b32 v147, 0
    v_cmp_eq_u32 vcc, 6, v4
    v_mov_b32 v5, 0x3f80
    s_nop 0
    v_cndmask_b32 v147, v147, v5, vcc
    v_cmp_eq_u32 vcc, 7, v4
    v_mov_b32 v5, 0x3f800000
    s_nop 0
    v_cndmask_b32 v147, v147, v5, vcc
    s_add_u32 s4, s6, 0
    s_lshr_b32 s5, s4, 6
    s_mul_i32 s5, s5, 12288
    s_and_b32 s4, s4, 63
    s_xor_b32 s4, s4, s7
    s_mul_i32 s4, s4, 96
    s_add_u32 s18, s4, s5
    buffer_store_dwordx4 a[0:3], v69, s[40:43], s18 offen sc1
    v_mfma_f32_16x16x32_bf16 v[140:143], a[0:3], v[144:147], 0
    s_add_u32 s4, s6, 4
    s_lshr_b32 s5, s4, 6
    s_mul_i32 s5, s5, 12288
    s_and_b32 s4, s4, 63
    s_xor_b32 s4, s4, s7
    s_mul_i32 s4, s4, 96
    s_add_u32 s18, s4, s5
    buffer_store_dwordx4 a[4:7], v69, s[40:43], s18 offen sc1
    v_mfma_f32_16x16x32_bf16 v[140:143], a[4:7], v[144:147], v[140:143]
    s_add_u32 s4, s6, 8
    s_lshr_b32 s5, s4, 6
    s_mul_i32 s5, s5, 12288
    s_and_b32 s4, s4, 63
    s_xor_b32 s4, s4, s7
    s_mul_i32 s4, s4, 96
    s_add_u32 s18, s4, s5
    buffer_store_dwordx4 a[8:11], v69, s[40:43], s18 offen sc1
    v_mfma_f32_16x16x32_bf16 v[140:143], a[8:11], v[144:147], v[140:143]
    s_add_u32 s4, s6, 12
    s_lshr_b32 s5, s4, 6
    s_mul_i32 s5, s5, 12288
    s_and_b32 s4, s4, 63
    s_xor_b32 s4, s4, s7
    s_mul_i32 s4, s4, 96
    s_add_u32 s18, s4, s5
    buffer_store_dwordx4 a[12:15], v69, s[40:43], s18 offen sc1
    v_mfma_f32_16x16x32_bf16 v[140:143], a[12:15], v[144:147], v[140:143]
    s_add_u32 s4, s6, 16
    s_lshr_b32 s5, s4, 6
    s_mul_i32 s5, s5, 12288
    s_and_b32 s4, s4, 63
    s_xor_b32 s4, s4, s7
    s_mul_i32 s4, s4, 96
    s_add_u32 s18, s4, s5
    buffer_store_dwordx4 a[16:19], v69, s[40:43], s18 offen sc1
    v_mfma_f32_16x16x32_bf16 v[140:143], a[16:19], v[144:147], v[140:143]
    s_add_u32 s4, s6, 20
    s_lshr_b32 s5, s4, 6
    s_mul_i32 s5, s5, 12288
    s_and_b32 s4, s4, 63
    s_xor_b32 s4, s4, s7
    s_mul_i32 s4, s4, 96
    s_add_u32 s18, s4, s5
    buffer_store_dwordx4 a[20:23], v69, s[40:43], s18 offen sc1
    v_mfma_f32_16x16x32_bf16 v[140:143], a[20:23], v[144:147], v[140:143]
    s_add_u32 s4, s6, 24
    s_lshr_b32 s5, s4, 6
    s_mul_i32 s5, s5, 12288
    s_and_b32 s4, s4, 63
    s_xor_b32 s4, s4, s7
    s_mul_i32 s4, s4, 96
    s_add_u32 s18, s4, s5
    buffer_store_dwordx4 a[24:27], v69, s[40:43], s18 offen sc1
    v_mfma_f32_16x16x32_bf16 v[140:143], a[24:27], v[144:147], v[140:143]
    s_add_u32 s4, s6, 28
    s_lshr_b32 s5, s4, 6
    s_mul_i32 s5, s5, 12288
    s_and_b32 s4, s4, 63
    s_xor_b32 s4, s4, s7
    s_mul_i32 s4, s4, 96
    s_add_u32 s18, s4, s5
    buffer_store_dwordx4 a[28:31], v69, s[40:43], s18 offen sc1
    v_mfma_f32_16x16x32_bf16 v[140:143], a[28:31], v[144:147], v[140:143]
    s_add_u32 s4, s6, 32
    s_lshr_b32 s5, s4, 6
    s_mul_i32 s5, s5, 12288
    s_and_b32 s4, s4, 63
    s_xor_b32 s4, s4, s7
    s_mul_i32 s4, s4, 96
    s_add_u32 s18, s4, s5
    buffer_store_dwordx4 a[32:35], v69, s[40:43], s18 offen sc1
    v_mfma_f32_16x16x32_bf16 v[140:143], a[32:35], v[144:147], v[140:143]
    s_add_u32 s4, s6, 36
    s_lshr_b32 s5, s4, 6
    s_mul_i32 s5, s5, 12288
    s_and_b32 s4, s4, 63
    s_xor_b32 s4, s4, s7
    s_mul_i32 s4, s4, 96
    s_add_u32 s18, s4, s5
    buffer_store_dwordx4 a[36:39], v69, s[40:43], s18 offen sc1
    v_mfma_f32_16x16x32_bf16 v[140:143], a[36:39], v[144:147], v[140:143]
    s_sub_u32 s4, s14, 2
    s_lshl_b32 s4, s4, 9
    s_add_u32 s4, s4, 155648
    v_lshrrev_b32 v4, 4, v1
    v_lshlrev_b32 v4, 7, v4
    v_and_b32_e64 v5, 15, v1
    v_lshl_add_u32 v4, v5, 2, v4
    v_add_u32 v4, s4, v4
    v_cmp_gt_u32 vcc, 8, v5
    s_mov_b64 exec, vcc
    ds_write_b32 v4, v140 offset:0
    ds_write_b32 v4, v141 offset:32
    ds_write_b32 v4, v142 offset:64
    ds_write_b32 v4, v143 offset:96
    s_mov_b64 exec, -1
    v_add_u32 v4, s4, v12
    s_waitcnt lgkmcnt(0)
    ds_read_b128 v[148:151], v4
    s_lshl_b32 s4, s13, 4
    s_add_u32 s4, s4, s12
    s_lshl_b32 s4, s4, 1
    s_add_u32 s4, s4, s14
    s_sub_u32 s4, s4, 2
    s_lshl_b32 s4, s4, 9
    s_add_u32 s4, s4, 262144
    v_add_u32 v4, s4, v12
    s_waitcnt lgkmcnt(0)
    s_mov_b32 exec_hi, 0
    buffer_store_dwordx4 v[148:151], v4, s[40:43], 0 offen sc1
    s_mov_b64 exec, -1
L_guf_31:
L_qe_30:
    s_lshl_b32 s4, s13, 4
    s_lshl_b32 s5, s23, 3
    s_add_u32 s4, s4, s5
    s_lshl_b32 s4, s4, 1
    s_add_u32 s4, s4, s22
    s_mul_i32 s4, s4, 2560
    s_add_u32 s4, s4, 1048576
    v_add_u32 v208, s4, v12
    v_lshl_add_u32 v209, v1, 3, s4
    s_mul_i32 s4, s14, 5120
    s_add_u32 s4, s4, 102400
    v_add_u32 v210, s4, v12
    s_xor_b32 s5, s14, 2
    s_mul_i32 s5, s5, 5120
    s_add_u32 s5, s5, 102400
    v_add_u32 v211, s5, v12
    v_and_b32 v4, 31, v1
    s_lshl_b32 s4, s23, 6
    v_add_u32 v4, s4, v4
    v_mul_u32_u24 v4, 80, v4
    s_mul_i32 s4, s22, 40
    s_add_u32 s4, s4, 122880
    v_add_u32 v4, s4, v4
    v_lshrrev_b32_e64 v5, 5, v1
    v_lshl_add_u32 v212, v5, 3, v4
    v_lshlrev_b32_e64 v6, 3, v1
    v_add_u32 v6, 133088, v6
    v_cmp_gt_u32 vcc, 32, v1
    s_nop 1
    v_cndmask_b32_e64 v213, v6, v4, vcc
    v_add_u32 v9, 2560, v213
    v_cndmask_b32 v214, v213, v9, vcc
    s_add_u32 s4, s14, 0
    s_lshr_b32 s5, s4, 1
    s_and_b32 s6, s4, 1
    s_lshl_b32 s6, s6, 6
    v_add_u32 v4, s6, v1
    v_mul_u32_u24 v5, 80, v4
    s_lshl_b32 s7, s5, 4
    s_add_u32 s7, s7, 122880
    v_add_u32 v215, s7, v5
    s_mul_i32 s7, s13, 5
    s_add_u32 s7, s7, s5
    s_lshr_b32 s8, s7, 2
    s_lshl_b32 s8, s8, 10
    s_and_b32 s7, s7, 3
    s_lshl_b32 s7, s7, 8
    s_add_u32 s7, s7, s8
    s_mul_i32 s8, s12, 163840
    s_add_u32 s7, s7, s8
    s_add_u32 s7, s7, 3145728
    s_cmp_lt_u32 s4, 10
    s_cselect_b32 s7, s7, 0x7ffffff0
    v_lshrrev_b32 v5, 4, v4
    v_mul_u32_u24 v5, 20480, v5
    v_and_b32_e64 v6, 15, v4
    v_lshl_add_u32 v5, v6, 4, v5
    v_add_u32 v218, s7, v5
    s_add_u32 s4, s14, 4
    s_lshr_b32 s5, s4, 1
    s_and_b32 s6, s4, 1
    s_lshl_b32 s6, s6, 6
    v_add_u32 v4, s6, v1
    v_mul_u32_u24 v5, 80, v4
    s_lshl_b32 s7, s5, 4
    s_add_u32 s7, s7, 122880
    v_add_u32 v216, s7, v5
    s_mul_i32 s7, s13, 5
    s_add_u32 s7, s7, s5
    s_lshr_b32 s8, s7, 2
    s_lshl_b32 s8, s8, 10
    s_and_b32 s7, s7, 3
    s_lshl_b32 s7, s7, 8
    s_add_u32 s7, s7, s8
    s_mul_i32 s8, s12, 163840
    s_add_u32 s7, s7, s8
    s_add_u32 s7, s7, 3145728
    s_cmp_lt_u32 s4, 10
    s_cselect_b32 s7, s7, 0x7ffffff0
    v_lshrrev_b32 v5, 4, v4
    v_mul_u32_u24 v5, 20480, v5
    v_and_b32_e64 v6, 15, v4
    v_lshl_add_u32 v5, v6, 4, v5
    v_add_u32 v219, s7, v5
    s_add_u32 s4, s14, 8
    s_lshr_b32 s5, s4, 1
    s_and_b32 s6, s4, 1
    s_lshl_b32 s6, s6, 6
    v_add_u32 v4, s6, v1
    v_mul_u32_u24 v5, 80, v4
    s_lshl_b32 s7, s5, 4
    s_add_u32 s7, s7, 122880
    v_add_u32 v217, s7, v5
    s_mul_i32 s7, s13, 5
    s_add_u32 s7, s7, s5
    s_lshr_b32 s8, s7, 2
    s_lshl_b32 s8, s8, 10
    s_and_b32 s7, s7, 3
    s_lshl_b32 s7, s7, 8
    s_add_u32 s7, s7, s8
    s_mul_i32 s8, s12, 163840
    s_add_u32 s7, s7, s8
    s_add_u32 s7, s7, 3145728
    s_cmp_lt_u32 s4, 10
    s_cselect_b32 s7, s7, 0x7ffffff0
    v_lshrrev_b32 v5, 4, v4
    v_mul_u32_u24 v5, 20480, v5
    v_and_b32_e64 v6, 15, v4
    v_lshl_add_u32 v5, v6, 4, v5
    v_add_u32 v220, s7, v5
    v_mov_b32 v156, 0
    v_mov_b32 v157, 0
    v_mov_b32 v158, 0
    v_mov_b32 v159, 0
    v_mov_b32 v160, 0
    v_mov_b32 v161, 0
    v_mov_b32 v162, 0
    v_mov_b32 v163, 0
    v_mov_b32 v164, 0
    v_mov_b32 v165, 0
    v_mov_b32 v166, 0
    v_mov_b32 v167, 0
    v_mov_b32 v168, 0
    v_mov_b32 v169, 0
    v_mov_b32 v170, 0
    v_mov_b32 v171, 0
    v_mov_b32 v172, 0
    v_mov_b32 v173, 0
    v_mov_b32 v174, 0
    v_mov_b32 v175, 0
    v_mov_b32 v186, 0
    v_mov_b32 v187, 0
    s_cmp_lg_u32 s14, 0
    s_cbranch_scc1 L_pe_32
    s_lshl_b32 s4, s13, 8
    s_add_u32 s4, s4, 8192
    v_mov_b32 v4, s4
    s_mov_b32 s19, 0
    s_mov_b64 exec, 1
L_pl_33:
    buffer_load_dword v5, v4, s[40:43], 0 offen sc1
    s_waitcnt vmcnt(0)
    v_cmp_gt_u32 vcc, 16, v5
    s_add_u32 s19, s19, 1
    s_cmp_eq_u64 vcc, 0
    s_cbranch_scc1 L_pe_32x
    s_cmp_lt_u32 s19, 200000
    s_cbranch_scc1 L_pl_33
L_pe_32x:
    s_mov_b64 exec, -1
L_pe_32:
    s_barrier
    s_mov_b32 s17, 0
    buffer_load_dwordx4 v[76:79], v208, s[40:43], s17 offen sc1
    buffer_load_dwordx4 v[80:83], v208, s[40:43], s17 offen offset:1024 sc1
    buffer_load_dwordx2 v[84:85], v209, s[40:43], s17 offen offset:2048 sc1
    s_mov_b32 s17, 5120
    buffer_load_dwordx4 v[86:89], v208, s[40:43], s17 offen sc1
    buffer_load_dwordx4 v[90:93], v208, s[40:43], s17 offen offset:1024 sc1
    buffer_load_dwordx2 v[94:95], v209, s[40:43], s17 offen offset:2048 sc1
    s_mov_b32 s17, 10240
    buffer_load_dwordx4 v[96:99], v208, s[40:43], s17 offen sc1
    buffer_load_dwordx4 v[100:103], v208, s[40:43], s17 offen offset:1024 sc1
    buffer_load_dwordx2 v[104:105], v209, s[40:43], s17 offen offset:2048 sc1
    s_mov_b32 s17, 15360
    buffer_load_dwordx4 v[106:109], v208, s[40:43], s17 offen sc1
    buffer_load_dwordx4 v[110:113], v208, s[40:43], s17 offen offset:1024 sc1
    buffer_load_dwordx2 v[114:115], v209, s[40:43], s17 offen offset:2048 sc1
    s_mov_b32 s17, 20480
    buffer_load_dwordx4 v[116:119], v208, s[40:43], s17 offen sc1
    buffer_load_dwordx4 v[120:123], v208, s[40:43], s17 offen offset:1024 sc1
    buffer_load_dwordx2 v[124:125], v209, s[40:43], s17 offen offset:2048 sc1
    s_mov_b32 s17, 25600
    buffer_load_dwordx4 v[126:129], v208, s[40:43], s17 offen sc1
    buffer_load_dwordx4 v[130:133], v208, s[40:43], s17 offen offset:1024 sc1
    buffer_load_dwordx2 v[134:135], v209, s[40:43], s17 offen offset:2048 sc1
    s_mov_b32 s17, 30720
    buffer_load_dwordx4 v[136:139], v208, s[40:43], s17 offen sc1
    buffer_load_dwordx4 v[140:143], v208, s[40:43], s17 offen offset:1024 sc1
    buffer_load_dwordx2 v[144:145], v209, s[40:43], s17 offen offset:2048 sc1
    s_mov_b32 s17, 35840
    buffer_load_dwordx4 v[146:149], v208, s[40:43], s17 offen sc1
    buffer_load_dwordx4 v[150:153], v208, s[40:43], s17 offen offset:1024 sc1
    buffer_load_dwordx2 v[154:155], v209, s[40:43], s17 offen offset:2048 sc1
    s_waitcnt vmcnt(21)
    v_dot2c_f32_bf16 v156, s26, v76
    v_dot2c_f32_bf16 v157, s27, v76
    v_dot2c_f32_bf16 v158, s26, v77
    v_dot2c_f32_bf16 v159, s27, v77
    v_dot2c_f32_bf16 v160, s26, v78
    v_dot2c_f32_bf16 v161, s27, v78
    v_dot2c_f32_bf16 v162, s26, v79
    v_dot2c_f32_bf16 v163, s27, v79
    v_dot2c_f32_bf16 v164, s26, v80
    v_dot2c_f32_bf16 v165, s27, v80
    v_dot2c_f32_bf16 v166, s26, v81
    v_dot2c_f32_bf16 v167, s27, v81
    v_dot2c_f32_bf16 v168, s26, v82
    v_dot2c_f32_bf16 v169, s27, v82
    v_dot2c_f32_bf16 v170, s26, v83
    v_dot2c_f32_bf16 v171, s27, v83
    v_dot2c_f32_bf16 v172, s26, v84
    v_dot2c_f32_bf16 v173, s27, v84
    v_dot2c_f32_bf16 v174, s26, v85
    v_dot2c_f32_bf16 v175, s27, v85
    s_waitcnt vmcnt(18)
    v_dot2c_f32_bf16 v156, s26, v86
    v_dot2c_f32_bf16 v157, s27, v86
    v_dot2c_f32_bf16 v158, s26, v87
    v_dot2c_f32_bf16 v159, s27, v87
    v_dot2c_f32_bf16 v160, s26, v88
    v_dot2c_f32_bf16 v161, s27, v88
    v_dot2c_f32_bf16 v162, s26, v89
    v_dot2c_f32_bf16 v163, s27, v89
    v_dot2c_f32_bf16 v164, s26, v90
    v_dot2c_f32_bf16 v165, s27, v90
    v_dot2c_f32_bf16 v166, s26, v91
    v_dot2c_f32_bf16 v167, s27, v91
    v_dot2c_f32_bf16 v168, s26, v92
    v_dot2c_f32_bf16 v169, s27, v92
    v_dot2c_f32_bf16 v170, s26, v93
    v_dot2c_f32_bf16 v171, s27, v93
    v_dot2c_f32_bf16 v172, s26, v94
    v_dot2c_f32_bf16 v173, s27, v94
    v_dot2c_f32_bf16 v174, s26, v95
    v_dot2c_f32_bf16 v175, s27, v95
    s_waitcnt vmcnt(15)
    v_dot2c_f32_bf16 v156, s26, v96
    v_dot2c_f32_bf16 v157, s27, v96
    v_dot2c_f32_bf16 v158, s26, v97
    v_dot2c_f32_bf16 v159, s27, v97
    v_dot2c_f32_bf16 v160, s26, v98
    v_dot2c_f32_bf16 v161, s27, v98
    v_dot2c_f32_bf16 v162, s26, v99
    v_dot2c_f32_bf16 v163, s27, v99
    v_dot2c_f32_bf16 v164, s26, v100
    v_dot2c_f32_bf16 v165, s27, v100
    v_dot2c_f32_bf16 v166, s26, v101
    v_dot2c_f32_bf16 v167, s27, v101
    v_dot2c_f32_bf16 v168, s26, v102
    v_dot2c_f32_bf16 v169, s27, v102
    v_dot2c_f32_bf16 v170, s26, v103
    v_dot2c_f32_bf16 v171, s27, v103
    v_dot2c_f32_bf16 v172, s26, v104
    v_dot2c_f32_bf16 v173, s27, v104
    v_dot2c_f32_bf16 v174, s26, v105
    v_dot2c_f32_bf16 v175, s27, v105
    s_waitcnt vmcnt(12)
    v_dot2c_f32_bf16 v156, s26, v106
    v_dot2c_f32_bf16 v157, s27, v106
    v_dot2c_f32_bf16 v158, s26, v107
    v_dot2c_f32_bf16 v159, s27, v107
    v_dot2c_f32_bf16 v160, s26, v108
    v_dot2c_f32_bf16 v161, s27, v108
    v_dot2c_f32_bf16 v162, s26, v109
    v_dot2c_f32_bf16 v163, s27, v109
    v_dot2c_f32_bf16 v164, s26, v110
    v_dot2c_f32_bf16 v165, s27, v110
    v_dot2c_f32_bf16 v166, s26, v111
    v_dot2c_f32_bf16 v167, s27, v111
    v_dot2c_f32_bf16 v168, s26, v112
    v_dot2c_f32_bf16 v169, s27, v112
    v_dot2c_f32_bf16 v170, s26, v113
    v_dot2c_f32_bf16 v171, s27, v113
    v_dot2c_f32_bf16 v172, s26, v114
    v_dot2c_f32_bf16 v173, s27, v114
    v_dot2c_f32_bf16 v174, s26, v115
    v_dot2c_f32_bf16 v175, s27, v115
    s_waitcnt vmcnt(9)
    v_dot2c_f32_bf16 v156, s26, v116
    v_dot2c_f32_bf16 v157, s27, v116
    v_dot2c_f32_bf16 v158, s26, v117
    v_dot2c_f32_bf16 v159, s27, v117
    v_dot2c_f32_bf16 v160, s26, v118
    v_dot2c_f32_bf16 v161, s27, v118
    v_dot2c_f32_bf16 v162, s26, v119
    v_dot2c_f32_bf16 v163, s27, v119
    v_dot2c_f32_bf16 v164, s26, v120
    v_dot2c_f32_bf16 v165, s27, v120
    v_dot2c_f32_bf16 v166, s26, v121
    v_dot2c_f32_bf16 v167, s27, v121
    v_dot2c_f32_bf16 v168, s26, v122
    v_dot2c_f32_bf16 v169, s27, v122
    v_dot2c_f32_bf16 v170, s26, v123
    v_dot2c_f32_bf16 v171, s27, v123
    v_dot2c_f32_bf16 v172, s26, v124
    v_dot2c_f32_bf16 v173, s27, v124
    v_dot2c_f32_bf16 v174, s26, v125
    v_dot2c_f32_bf16 v175, s27, v125
    s_waitcnt vmcnt(6)
    v_dot2c_f32_bf16 v156, s26, v126
    v_dot2c_f32_bf16 v157, s27, v126
    v_dot2c_f32_bf16 v158, s26, v127
    v_dot2c_f32_bf16 v159, s27, v127
    v_dot2c_f32_bf16 v160, s26, v128
    v_dot2c_f32_bf16 v161, s27, v128
    v_dot2c_f32_bf16 v162, s26, v129
    v_dot2c_f32_bf16 v163, s27, v129
    v_dot2c_f32_bf16 v164, s26, v130
    v_dot2c_f32_bf16 v165, s27, v130
    v_dot2c_f32_bf16 v166, s26, v131
    v_dot2c_f32_bf16 v167, s27, v131
    v_dot2c_f32_bf16 v168, s26, v132
    v_dot2c_f32_bf16 v169, s27, v132
    v_dot2c_f32_bf16 v170, s26, v133
    v_dot2c_f32_bf16 v171, s27, v133
    v_dot2c_f32_bf16 v172, s26, v134
    v_dot2c_f32_bf16 v173, s27, v134
    v_dot2c_f32_bf16 v174, s26, v135
    v_dot2c_f32_bf16 v175, s27, v135
    s_waitcnt vmcnt(3)
    v_dot2c_f32_bf16 v156, s26, v136
    v_dot2c_f32_bf16 v157, s27, v136
    v_dot2c_f32_bf16 v158, s26, v137
    v_dot2c_f32_bf16 v159, s27, v137
    v_dot2c_f32_bf16 v160, s26, v138
    v_dot2c_f32_bf16 v161, s27, v138
    v_dot2c_f32_bf16 v162, s26, v139
    v_dot2c_f32_bf16 v163, s27, v139
    v_dot2c_f32_bf16 v164, s26, v140
    v_dot2c_f32_bf16 v165, s27, v140
    v_dot2c_f32_bf16 v166, s26, v141
    v_dot2c_f32_bf16 v167, s27, v141
    v_dot2c_f32_bf16 v168, s26, v142
    v_dot2c_f32_bf16 v169, s27, v142
    v_dot2c_f32_bf16 v170, s26, v143
    v_dot2c_f32_bf16 v171, s27, v143
    v_dot2c_f32_bf16 v172, s26, v144
    v_dot2c_f32_bf16 v173, s27, v144
    v_dot2c_f32_bf16 v174, s26, v145
    v_dot2c_f32_bf16 v175, s27, v145
    s_waitcnt vmcnt(0)
    v_dot2c_f32_bf16 v156, s26, v146
    v_dot2c_f32_bf16 v157, s27, v146
    v_dot2c_f32_bf16 v158, s26, v147
    v_dot2c_f32_bf16 v159, s27, v147
    v_dot2c_f32_bf16 v160, s26, v148
    v_dot2c_f32_bf16 v161, s27, v148
    v_dot2c_f32_bf16 v162, s26, v149
    v_dot2c_f32_bf16 v163, s27, v149
    v_dot2c_f32_bf16 v164, s26, v150
    v_dot2c_f32_bf16 v165, s27, v150
    v_dot2c_f32_bf16 v166, s26, v151
    v_dot2c_f32_bf16 v167, s27, v151
    v_dot2c_f32_bf16 v168, s26, v152
    v_dot2c_f32_bf16 v169, s27, v152
    v_dot2c_f32_bf16 v170, s26, v153
    v_dot2c_f32_bf16 v171, s27, v153
    v_dot2c_f32_bf16 v172, s26, v154
    v_dot2c_f32_bf16 v173, s27, v154
    v_dot2c_f32_bf16 v174, s26, v155
    v_dot2c_f32_bf16 v175, s27, v155
    ds_write_b128 v210, v[156:159] offset:0
    ds_write_b128 v210, v[160:163] offset:1024
    ds_write_b128 v210, v[164:167] offset:2048
    ds_write_b128 v210, v[168:171] offset:3072
    ds_write_b128 v210, v[172:175] offset:4096
    s_waitcnt lgkmcnt(0)
    s_barrier
    ds_read_b128 v[76:79], v211 offset:0
    ds_read_b128 v[80:83], v211 offset:1024
    ds_read_b128 v[84:87], v211 offset:2048
    ds_read_b128 v[88:91], v211 offset:3072
    ds_read_b128 v[92:95], v211 offset:4096
    s_cmp_lg_u32 s14, 0
    s_cbranch_scc1 L_sig_34
    s_lshl_b32 s4, s13, 8
    s_add_u32 s4, s4, 24576
    v_mov_b32 v4, s4
    v_mov_b32 v5, 1
    s_mov_b64 exec, 1
    buffer_atomic_add v5, v4, s[40:43], 0 offen sc1
    s_mov_b64 exec, -1
L_sig_34:
    s_cmp_lg_u32 s14, 0
    s_cbranch_scc1 L_sig_35
    s_lshl_b32 s4, s12, 8
    s_add_u32 s4, s4, 36864
    v_mov_b32 v4, s4
    v_mov_b32 v5, 1
    s_mov_b64 exec, 1
    buffer_atomic_add v5, v4, s[40:43], 0 offen sc1
    s_mov_b64 exec, -1
L_sig_35:
    s_waitcnt lgkmcnt(0)
    s_nop 0
    v_pk_add_f32 v[156:157], v[156:157], v[76:77]
    v_pk_add_f32 v[158:159], v[158:159], v[78:79]
    v_pk_add_f32 v[160:161], v[160:161], v[80:81]
    v_pk_add_f32 v[162:163], v[162:163], v[82:83]
    v_pk_add_f32 v[164:165], v[164:165], v[84:85]
    v_pk_add_f32 v[166:167], v[166:167], v[86:87]
    v_pk_add_f32 v[168:169], v[168:169], v[88:89]
    v_pk_add_f32 v[170:171], v[170:171], v[90:91]
    v_pk_add_f32 v[172:173], v[172:173], v[92:93]
    v_pk_add_f32 v[174:175], v[174:175], v[94:95]
    v_cvt_pk_bf16_f32 v176, v156, v157
    v_cvt_pk_bf16_f32 v177, v158, v159
    v_cvt_pk_bf16_f32 v178, v160, v161
    v_cvt_pk_bf16_f32 v179, v162, v163
    v_cvt_pk_bf16_f32 v180, v164, v165
    v_cvt_pk_bf16_f32 v181, v166, v167
    v_cvt_pk_bf16_f32 v182, v168, v169
    v_cvt_pk_bf16_f32 v183, v170, v171
    v_cvt_pk_bf16_f32 v184, v172, v173
    v_cvt_pk_bf16_f32 v185, v174, v175
    v_mfma_f32_32x32x16_bf16 v[108:123], v[176:179], v[28:31], 0
    v_mfma_f32_32x32x16_bf16 v[124:139], v[176:179], v[40:43], 0
    v_mfma_f32_32x32x16_bf16 v[108:123], v[180:183], v[32:35], v[108:123]
    v_mfma_f32_32x32x16_bf16 v[124:139], v[180:183], v[44:47], v[124:139]
    v_mfma_f32_32x32x16_bf16 v[108:123], v[184:187], v[36:39], v[108:123]
    v_mfma_f32_32x32x16_bf16 v[124:139], v[184:187], v[48:51], v[124:139]
    s_nop 10
    v_add_f32 v8, 0x358637bd, v120
    v_rcp_f32 v8, v8
    s_nop 0
    s_nop 0
    v_pk_mul_f32 v[108:109], v[108:109], v[8:9] op_sel_hi:[1,0]
    v_pk_mul_f32 v[110:111], v[110:111], v[8:9] op_sel_hi:[1,0]
    v_pk_mul_f32 v[112:113], v[112:113], v[8:9] op_sel_hi:[1,0]
    v_pk_mul_f32 v[114:115], v[114:115], v[8:9] op_sel_hi:[1,0]
    v_pk_mul_f32 v[116:117], v[116:117], v[8:9] op_sel_hi:[1,0]
    v_pk_mul_f32 v[118:119], v[118:119], v[8:9] op_sel_hi:[1,0]
    v_cvt_pk_bf16_f32 v188, v108, v109
    v_cvt_pk_bf16_f32 v189, v110, v111
    v_cvt_pk_bf16_f32 v190, v112, v113
    v_cvt_pk_bf16_f32 v191, v114, v115
    v_cvt_pk_bf16_f32 v192, v116, v117
    v_cvt_pk_bf16_f32 v193, v118, v119
    ds_write_b64 v212, v[188:189] offset:0
    ds_write_b64 v212, v[190:191] offset:16
    ds_write_b64 v213, v[192:193] offset:32
    v_add_f32 v8, 0x358637bd, v136
    v_rcp_f32 v8, v8
    s_nop 0
    v_pk_mul_f32 v[124:125], v[124:125], v[8:9] op_sel_hi:[1,0]
    v_pk_mul_f32 v[126:127], v[126:127], v[8:9] op_sel_hi:[1,0]
    v_pk_mul_f32 v[128:129], v[128:129], v[8:9] op_sel_hi:[1,0]
    v_pk_mul_f32 v[130:131], v[130:131], v[8:9] op_sel_hi:[1,0]
    v_pk_mul_f32 v[132:133], v[132:133], v[8:9] op_sel_hi:[1,0]
    v_pk_mul_f32 v[134:135], v[134:135], v[8:9] op_sel_hi:[1,0]
    v_cvt_pk_bf16_f32 v188, v124, v125
    v_cvt_pk_bf16_f32 v189, v126, v127
    v_cvt_pk_bf16_f32 v190, v128, v129
    v_cvt_pk_bf16_f32 v191, v130, v131
    v_cvt_pk_bf16_f32 v192, v132, v133
    v_cvt_pk_bf16_f32 v193, v134, v135
    ds_write_b64 v212, v[188:189] offset:2560
    ds_write_b64 v212, v[190:191] offset:2576
    ds_write_b64 v214, v[192:193] offset:32
    s_waitcnt lgkmcnt(0)
    s_barrier
    ds_read_b128 v[196:199], v215
    ds_read_b128 v[200:203], v216
    ds_read_b128 v[204:207], v217
    s_waitcnt lgkmcnt(2)
    buffer_store_dwordx4 v[196:199], v218, s[40:43], 0 offen sc1
    s_waitcnt lgkmcnt(1)
    buffer_store_dwordx4 v[200:203], v219, s[40:43], 0 offen sc1
    s_waitcnt lgkmcnt(0)
    buffer_store_dwordx4 v[204:207], v220, s[40:43], 0 offen sc1
    s_waitcnt vmcnt(0)
    s_barrier
    s_cmp_lg_u32 s14, 0
    s_cbranch_scc1 L_sig_36
    s_lshl_b32 s4, s12, 8
    s_add_u32 s4, s4, 12288
    v_mov_b32 v4, s4
    v_mov_b32 v5, 1
    s_mov_b64 exec, 1
    buffer_atomic_add v5, v4, s[40:43], 0 offen sc1
    s_mov_b64 exec, -1
L_sig_36:
    s_lshl_b32 s4, s15, 2
    s_add_u32 s4, s4, s14
    s_lshl_b32 s5, s4, 4
    v_and_b32 v4, 15, v1
    v_add_u32_e64 v4, s5, v4
    v_mul_u32_u24 v5, 1280, v4
    v_lshrrev_b32_e64 v6, 4, v1
    v_lshl_add_u32 v5, v6, 3, v5
    s_mul_i32 s6, s16, 160
    v_add_u32 v36, s6, v5
    v_lshrrev_b32 v4, 5, v1
    v_lshlrev_b32_e64 v4, 4, v4
    v_bfe_u32 v5, v1, 4, 1
    v_lshl_add_u32 v4, v5, 2, v4
    v_bfe_u32 v5, v1, 2, 2
    v_add_u32_e64 v4, v4, v5
    v_mul_u32_u24 v4, 160, v4
    v_and_b32_e64 v5, 3, v1
    v_lshl_add_u32 v37, v5, 3, v4
    v_add_u32 v38, 51200, v37
    s_lshl_b32 s4, s15, 2
    s_add_u32 s4, s4, s14
    s_mul_i32 s4, s4, 20480
    s_add_u32 s4, s4, 3145728
    v_add_u32 v39, s4, v12
    s_lshl_b32 s4, s15, 2
    s_add_u32 s4, s4, s14
    s_lshr_b32 s5, s4, 1
    s_mul_i32 s5, s5, 40
    s_mul_i32 s6, s16, 5
    s_add_u32 s5, s5, s6
    s_lshl_b32 s5, s5, 10
    s_and_b32 s6, s14, 1
    s_lshl_b32 s6, s6, 8
    s_add_u32 s5, s5, s6
    s_add_u32 s5, s5, 6291456
    v_bfe_u32 v4, v1, 4, 1
    v_lshlrev_b32 v4, 10, v4
    v_lshrrev_b32_e64 v5, 5, v1
    v_lshl_add_u32 v4, v5, 9, v4
    v_and_b32_e64 v5, 15, v1
    v_lshl_add_u32 v4, v5, 4, v4
    v_add_u32_e64 v40, s5, v4
    v_add_u32 v41, 2048, v40
    v_add_u32 v42, 4096, v40
    v_bfe_u32 v6, v1, 4, 1
    v_cmp_eq_u32 vcc, 0, v6
    v_mov_b32 v7, 0x7ffffff0
    s_nop 0
    v_cndmask_b32 v42, v7, v42, vcc
    s_lshl_b32 s4, s4, 3
    s_add_u32 s4, s4, s16
    s_lshl_b32 s4, s4, 7
    s_add_u32 s4, s4, 9437184
    v_and_b32 v4, 15, v1
    v_lshlrev_b32 v4, 3, v4
    v_add_u32 v4, s4, v4
    v_lshrrev_b32 v5, 5, v1
    v_lshl_add_u32 v4, v5, 2, v4
    v_cndmask_b32 v43, v7, v4, vcc
    v_mov_b32 v44, 0
    v_mov_b32 v45, 0
    v_mov_b32 v46, 0
    v_mov_b32 v47, 0
    v_mov_b32 v48, 0
    v_mov_b32 v49, 0
    v_mov_b32 v50, 0
    v_mov_b32 v51, 0
    v_mov_b32 v52, 0
    v_mov_b32 v53, 0
    v_mov_b32 v54, 0
    v_mov_b32 v55, 0
    v_mov_b32 v56, 0
    v_mov_b32 v57, 0
    v_mov_b32 v58, 0
    v_mov_b32 v59, 0
    v_mov_b32 v60, 0
    v_mov_b32 v61, 0
    v_mov_b32 v62, 0
    v_mov_b32 v63, 0
    s_cmp_lg_u32 s14, 0
    s_cbranch_scc1 L_pe_37
    s_lshl_b32 s4, s12, 8
    s_add_u32 s4, s4, 12288
    v_mov_b32 v4, s4
    v_subrev_u32 v6, 2, v1
    v_lshlrev_b32_e64 v7, 8, v6
    v_add_u32 v7, 36864, v7
    v_cmp_gt_u32 vcc, 16, v6
    s_nop 1
    v_cndmask_b32 v4, v4, v7, vcc
    s_lshl_b32 s4, s13, 8
    s_add_u32 s4, s4, 24576
    v_mov_b32 v6, s4
    v_cmp_eq_u32 vcc, 1, v1
    s_nop 1
    v_cndmask_b32 v4, v4, v6, vcc
    s_mov_b32 s19, 0
    s_mov_b64 exec, 0x3ffff
L_pl_38:
    buffer_load_dword v5, v4, s[40:43], 0 offen sc1
    s_waitcnt vmcnt(0)
    v_cmp_gt_u32 vcc, 16, v5
    s_add_u32 s19, s19, 1
    s_cmp_eq_u64 vcc, 0
    s_cbranch_scc1 L_pe_37x
    s_cmp_lt_u32 s19, 200000
    s_cbranch_scc1 L_pl_38
L_pe_37x:
    s_mov_b64 exec, -1
L_pe_37:
    s_barrier
    s_mov_b32 s17, 0
    buffer_load_dwordx4 a[0:3], v39, s[40:43], s17 offen offset:0 sc1
    buffer_load_dwordx4 a[4:7], v39, s[40:43], s17 offen offset:1024 sc1
    buffer_load_dwordx4 a[8:11], v39, s[40:43], s17 offen offset:2048 sc1
    buffer_load_dwordx4 a[12:15], v39, s[40:43], s17 offen offset:3072 sc1
    s_mov_b32 s17, 4096
    buffer_load_dwordx4 a[16:19], v39, s[40:43], s17 offen offset:0 sc1
    buffer_load_dwordx4 a[20:23], v39, s[40:43], s17 offen offset:1024 sc1
    buffer_load_dwordx4 a[24:27], v39, s[40:43], s17 offen offset:2048 sc1
    buffer_load_dwordx4 a[28:31], v39, s[40:43], s17 offen offset:3072 sc1
    s_mov_b32 s17, 8192
    buffer_load_dwordx4 a[32:35], v39, s[40:43], s17 offen offset:0 sc1
    buffer_load_dwordx4 a[36:39], v39, s[40:43], s17 offen offset:1024 sc1
    buffer_load_dwordx4 a[40:43], v39, s[40:43], s17 offen offset:2048 sc1
    buffer_load_dwordx4 a[44:47], v39, s[40:43], s17 offen offset:3072 sc1
    s_mov_b32 s17, 12288
    buffer_load_dwordx4 a[48:51], v39, s[40:43], s17 offen offset:0 sc1
    buffer_load_dwordx4 a[52:55], v39, s[40:43], s17 offen offset:1024 sc1
    buffer_load_dwordx4 a[56:59], v39, s[40:43], s17 offen offset:2048 sc1
    buffer_load_dwordx4 a[60:63], v39, s[40:43], s17 offen offset:3072 sc1
    s_mov_b32 s17, 16384
    buffer_load_dwordx4 a[64:67], v39, s[40:43], s17 offen offset:0 sc1
    buffer_load_dwordx4 a[68:71], v39, s[40:43], s17 offen offset:1024 sc1
    buffer_load_dwordx4 a[72:75], v39, s[40:43], s17 offen offset:2048 sc1
    buffer_load_dwordx4 a[76:79], v39, s[40:43], s17 offen offset:3072 sc1
    buffer_load_dwordx2 v[26:27], v36, s[32:35], 0 offen offset:0
    buffer_load_dwordx2 v[28:29], v36, s[32:35], 0 offen offset:32
    buffer_load_dwordx2 v[30:31], v36, s[32:35], 0 offen offset:64
    buffer_load_dwordx2 v[32:33], v36, s[32:35], 0 offen offset:96
    buffer_load_dwordx2 v[34:35], v36, s[32:35], 0 offen offset:128
    ds_read_b64_tr_b16 v[64:65], v37 offset:0
    ds_read_b64_tr_b16 v[66:67], v37 offset:1280
    ds_read_b64_tr_b16 v[68:69], v37 offset:32
    ds_read_b64_tr_b16 v[70:71], v37 offset:1312
    ds_read_b64_tr_b16 v[72:73], v37 offset:64
    ds_read_b64_tr_b16 v[74:75], v37 offset:1344
    ds_read_b64_tr_b16 v[76:77], v37 offset:96
    ds_read_b64_tr_b16 v[78:79], v37 offset:1376
    ds_read_b64_tr_b16 v[80:81], v37 offset:128
    ds_read_b64_tr_b16 v[82:83], v37 offset:1408
    ds_read_b64_tr_b16 v[84:85], v37 offset:5120
    ds_read_b64_tr_b16 v[86:87], v37 offset:6400
    ds_read_b64_tr_b16 v[88:89], v37 offset:5152
    ds_read_b64_tr_b16 v[90:91], v37 offset:6432
    ds_read_b64_tr_b16 v[92:93], v37 offset:5184
    ds_read_b64_tr_b16 v[94:95], v37 offset:6464
    ds_read_b64_tr_b16 v[96:97], v37 offset:5216
    ds_read_b64_tr_b16 v[98:99], v37 offset:6496
    ds_read_b64_tr_b16 v[100:101], v37 offset:5248
    ds_read_b64_tr_b16 v[102:103], v37 offset:6528
    s_waitcnt vmcnt(24) lgkmcnt(10)
    v_mfma_f32_16x16x32_bf16 v[44:47], v[64:67], a[0:3], v[44:47]
    ds_read_b64_tr_b16 v[104:105], v37 offset:10240
    ds_read_b64_tr_b16 v[106:107], v37 offset:11520
    v_mfma_f32_16x16x32_bf16 v[48:51], v[68:71], a[0:3], v[48:51]
    ds_read_b64_tr_b16 v[108:109], v37 offset:10272
    ds_read_b64_tr_b16 v[110:111], v37 offset:11552
    v_mfma_f32_16x16x32_bf16 v[52:55], v[72:75], a[0:3], v[52:55]
    ds_read_b64_tr_b16 v[112:113], v37 offset:10304
    ds_read_b64_tr_b16 v[114:115], v37 offset:11584
    v_mfma_f32_16x16x32_bf16 v[56:59], v[76:79], a[0:3], v[56:59]
    ds_read_b64_tr_b16 v[116:117], v37 offset:10336
    ds_read_b64_tr_b16 v[118:119], v37 offset:11616
    v_mfma_f32_16x16x32_bf16 v[60:63], v[80:83], a[0:3], v[60:63]
    ds_read_b64_tr_b16 v[120:121], v37 offset:10368
    ds_read_b64_tr_b16 v[122:123], v37 offset:11648
    s_waitcnt vmcnt(23) lgkmcnt(10)
    v_mfma_f32_16x16x32_bf16 v[44:47], v[84:87], a[4:7], v[44:47]
    ds_read_b64_tr_b16 v[64:65], v37 offset:15360
    ds_read_b64_tr_b16 v[66:67], v37 offset:16640
    v_mfma_f32_16x16x32_bf16 v[48:51], v[88:91], a[4:7], v[48:51]
    ds_read_b64_tr_b16 v[68:69], v37 offset:15392
    ds_read_b64_tr_b16 v[70:71], v37 offset:16672
    v_mfma_f32_16x16x32_bf16 v[52:55], v[92:95], a[4:7], v[52:55]
    ds_read_b64_tr_b16 v[72:73], v37 offset:15424
    ds_read_b64_tr_b16 v[74:75], v37 offset:16704
    v_mfma_f32_16x16x32_bf16 v[56:59], v[96:99], a[4:7], v[56:59]
    ds_read_b64_tr_b16 v[76:77], v37 offset:15456
    ds_read_b64_tr_b16 v[78:79], v37 offset:16736
    v_mfma_f32_16x16x32_bf16 v[60:63], v[100:103], a[4:7], v[60:63]
    ds_read_b64_tr_b16 v[80:81], v37 offset:15488
    ds_read_b64_tr_b16 v[82:83], v37 offset:16768
    s_waitcnt vmcnt(22) lgkmcnt(10)
    v_mfma_f32_16x16x32_bf16 v[44:47], v[104:107], a[8:11], v[44:47]
    ds_read_b64_tr_b16 v[84:85], v37 offset:20480
    ds_read_b64_tr_b16 v[86:87], v37 offset:21760
    v_mfma_f32_16x16x32_bf16 v[48:51], v[108:111], a[8:11], v[48:51]
    ds_read_b64_tr_b16 v[88:89], v37 offset:20512
    ds_read_b64_tr_b16 v[90:91], v37 offset:21792
    v_mfma_f32_16x16x32_bf16 v[52:55], v[112:115], a[8:11], v[52:55]
    ds_read_b64_tr_b16 v[92:93], v37 offset:20544
    ds_read_b64_tr_b16 v[94:95], v37 offset:21824
    v_mfma_f32_16x16x32_bf16 v[56:59], v[116:119], a[8:11], v[56:59]
    ds_read_b64_tr_b16 v[96:97], v37 offset:20576
    ds_read_b64_tr_b16 v[98:99], v37 offset:21856
    v_mfma_f32_16x16x32_bf16 v[60:63], v[120:123], a[8:11], v[60:63]
    ds_read_b64_tr_b16 v[100:101], v37 offset:20608
    ds_read_b64_tr_b16 v[102:103], v37 offset:21888
    s_waitcnt vmcnt(21) lgkmcnt(10)
    v_mfma_f32_16x16x32_bf16 v[44:47], v[64:67], a[12:15], v[44:47]
    ds_read_b64_tr_b16 v[104:105], v37 offset:25600
    ds_read_b64_tr_b16 v[106:107], v37 offset:26880
    v_mfma_f32_16x16x32_bf16 v[48:51], v[68:71], a[12:15], v[48:51]
    ds_read_b64_tr_b16 v[108:109], v37 offset:25632
    ds_read_b64_tr_b16 v[110:111], v37 offset:26912
    v_mfma_f32_16x16x32_bf16 v[52:55], v[72:75], a[12:15], v[52:55]
    ds_read_b64_tr_b16 v[112:113], v37 offset:25664
    ds_read_b64_tr_b16 v[114:115], v37 offset:26944
    v_mfma_f32_16x16x32_bf16 v[56:59], v[76:79], a[12:15], v[56:59]
    ds_read_b64_tr_b16 v[116:117], v37 offset:25696
    ds_read_b64_tr_b16 v[118:119], v37 offset:26976
    v_mfma_f32_16x16x32_bf16 v[60:63], v[80:83], a[12:15], v[60:63]
    ds_read_b64_tr_b16 v[120:121], v37 offset:25728
    ds_read_b64_tr_b16 v[122:123], v37 offset:27008
    s_waitcnt vmcnt(20) lgkmcnt(10)
    v_mfma_f32_16x16x32_bf16 v[44:47], v[84:87], a[16:19], v[44:47]
    ds_read_b64_tr_b16 v[64:65], v37 offset:30720
    ds_read_b64_tr_b16 v[66:67], v37 offset:32000
    v_mfma_f32_16x16x32_bf16 v[48:51], v[88:91], a[16:19], v[48:51]
    ds_read_b64_tr_b16 v[68:69], v37 offset:30752
    ds_read_b64_tr_b16 v[70:71], v37 offset:32032
    v_mfma_f32_16x16x32_bf16 v[52:55], v[92:95], a[16:19], v[52:55]
    ds_read_b64_tr_b16 v[72:73], v37 offset:30784
    ds_read_b64_tr_b16 v[74:75], v37 offset:32064
    v_mfma_f32_16x16x32_bf16 v[56:59], v[96:99], a[16:19], v[56:59]
    ds_read_b64_tr_b16 v[76:77], v37 offset:30816
    ds_read_b64_tr_b16 v[78:79], v37 offset:32096
    v_mfma_f32_16x16x32_bf16 v[60:63], v[100:103], a[16:19], v[60:63]
    ds_read_b64_tr_b16 v[80:81], v37 offset:30848
    ds_read_b64_tr_b16 v[82:83], v37 offset:32128
    s_waitcnt vmcnt(19) lgkmcnt(10)
    v_mfma_f32_16x16x32_bf16 v[44:47], v[104:107], a[20:23], v[44:47]
    ds_read_b64_tr_b16 v[84:85], v37 offset:35840
    ds_read_b64_tr_b16 v[86:87], v37 offset:37120
    v_mfma_f32_16x16x32_bf16 v[48:51], v[108:111], a[20:23], v[48:51]
    ds_read_b64_tr_b16 v[88:89], v37 offset:35872
    ds_read_b64_tr_b16 v[90:91], v37 offset:37152
    v_mfma_f32_16x16x32_bf16 v[52:55], v[112:115], a[20:23], v[52:55]
    ds_read_b64_tr_b16 v[92:93], v37 offset:35904
    ds_read_b64_tr_b16 v[94:95], v37 offset:37184
    v_mfma_f32_16x16x32_bf16 v[56:59], v[116:119], a[20:23], v[56:59]
    ds_read_b64_tr_b16 v[96:97], v37 offset:35936
    ds_read_b64_tr_b16 v[98:99], v37 offset:37216
    v_mfma_f32_16x16x32_bf16 v[60:63], v[120:123], a[20:23], v[60:63]
    ds_read_b64_tr_b16 v[100:101], v37 offset:35968
    ds_read_b64_tr_b16 v[102:103], v37 offset:37248
    s_waitcnt vmcnt(18) lgkmcnt(10)
    v_mfma_f32_16x16x32_bf16 v[44:47], v[64:67], a[24:27], v[44:47]
    ds_read_b64_tr_b16 v[104:105], v37 offset:40960
    ds_read_b64_tr_b16 v[106:107], v37 offset:42240
    v_mfma_f32_16x16x32_bf16 v[48:51], v[68:71], a[24:27], v[48:51]
    ds_read_b64_tr_b16 v[108:109], v37 offset:40992
    ds_read_b64_tr_b16 v[110:111], v37 offset:42272
    v_mfma_f32_16x16x32_bf16 v[52:55], v[72:75], a[24:27], v[52:55]
    ds_read_b64_tr_b16 v[112:113], v37 offset:41024
    ds_read_b64_tr_b16 v[114:115], v37 offset:42304
    v_mfma_f32_16x16x32_bf16 v[56:59], v[76:79], a[24:27], v[56:59]
    ds_read_b64_tr_b16 v[116:117], v37 offset:41056
    ds_read_b64_tr_b16 v[118:119], v37 offset:42336
    v_mfma_f32_16x16x32_bf16 v[60:63], v[80:83], a[24:27], v[60:63]
    ds_read_b64_tr_b16 v[120:121], v37 offset:41088
    ds_read_b64_tr_b16 v[122:123], v37 offset:42368
    s_waitcnt vmcnt(17) lgkmcnt(10)
    v_mfma_f32_16x16x32_bf16 v[44:47], v[84:87], a[28:31], v[44:47]
    ds_read_b64_tr_b16 v[64:65], v37 offset:46080
    ds_read_b64_tr_b16 v[66:67], v37 offset:47360
    v_mfma_f32_16x16x32_bf16 v[48:51], v[88:91], a[28:31], v[48:51]
    ds_read_b64_tr_b16 v[68:69], v37 offset:46112
    ds_read_b64_tr_b16 v[70:71], v37 offset:47392
    v_mfma_f32_16x16x32_bf16 v[52:55], v[92:95], a[28:31], v[52:55]
    ds_read_b64_tr_b16 v[72:73], v37 offset:46144
    ds_read_b64_tr_b16 v[74:75], v37 offset:47424
    v_mfma_f32_16x16x32_bf16 v[56:59], v[96:99], a[28:31], v[56:59]
    ds_read_b64_tr_b16 v[76:77], v37 offset:46176
    ds_read_b64_tr_b16 v[78:79], v37 offset:47456
    v_mfma_f32_16x16x32_bf16 v[60:63], v[100:103], a[28:31], v[60:63]
    ds_read_b64_tr_b16 v[80:81], v37 offset:46208
    ds_read_b64_tr_b16 v[82:83], v37 offset:47488
    s_waitcnt vmcnt(16) lgkmcnt(10)
    v_mfma_f32_16x16x32_bf16 v[44:47], v[104:107], a[32:35], v[44:47]
    ds_read_b64_tr_b16 v[84:85], v38 offset:0
    ds_read_b64_tr_b16 v[86:87], v38 offset:1280
    v_mfma_f32_16x16x32_bf16 v[48:51], v[108:111], a[32:35], v[48:51]
    ds_read_b64_tr_b16 v[88:89], v38 offset:32
    ds_read_b64_tr_b16 v[90:91], v38 offset:1312
    v_mfma_f32_16x16x32_bf16 v[52:55], v[112:115], a[32:35], v[52:55]
    ds_read_b64_tr_b16 v[92:93], v38 offset:64
    ds_read_b64_tr_b16 v[94:95], v38 offset:1344
    v_mfma_f32_16x16x32_bf16 v[56:59], v[116:119], a[32:35], v[56:59]
    ds_read_b64_tr_b16 v[96:97], v38 offset:96
    ds_read_b64_tr_b16 v[98:99], v38 offset:1376
    v_mfma_f32_16x16x32_bf16 v[60:63], v[120:123], a[32:35], v[60:63]
    ds_read_b64_tr_b16 v[100:101], v38 offset:128
    ds_read_b64_tr_b16 v[102:103], v38 offset:1408
    s_waitcnt vmcnt(15) lgkmcnt(10)
    v_mfma_f32_16x16x32_bf16 v[44:47], v[64:67], a[36:39], v[44:47]
    ds_read_b64_tr_b16 v[104:105], v38 offset:5120
    ds_read_b64_tr_b16 v[106:107], v38 offset:6400
    v_mfma_f32_16x16x32_bf16 v[48:51], v[68:71], a[36:39], v[48:51]
    ds_read_b64_tr_b16 v[108:109], v38 offset:5152
    ds_read_b64_tr_b16 v[110:111], v38 offset:6432
    v_mfma_f32_16x16x32_bf16 v[52:55], v[72:75], a[36:39], v[52:55]
    ds_read_b64_tr_b16 v[112:113], v38 offset:5184
    ds_read_b64_tr_b16 v[114:115], v38 offset:6464
    v_mfma_f32_16x16x32_bf16 v[56:59], v[76:79], a[36:39], v[56:59]
    ds_read_b64_tr_b16 v[116:117], v38 offset:5216
    ds_read_b64_tr_b16 v[118:119], v38 offset:6496
    v_mfma_f32_16x16x32_bf16 v[60:63], v[80:83], a[36:39], v[60:63]
    ds_read_b64_tr_b16 v[120:121], v38 offset:5248
    ds_read_b64_tr_b16 v[122:123], v38 offset:6528
    s_waitcnt vmcnt(14) lgkmcnt(10)
    v_mfma_f32_16x16x32_bf16 v[44:47], v[84:87], a[40:43], v[44:47]
    ds_read_b64_tr_b16 v[64:65], v38 offset:10240
    ds_read_b64_tr_b16 v[66:67], v38 offset:11520
    v_mfma_f32_16x16x32_bf16 v[48:51], v[88:91], a[40:43], v[48:51]
    ds_read_b64_tr_b16 v[68:69], v38 offset:10272
    ds_read_b64_tr_b16 v[70:71], v38 offset:11552
    v_mfma_f32_16x16x32_bf16 v[52:55], v[92:95], a[40:43], v[52:55]
    ds_read_b64_tr_b16 v[72:73], v38 offset:10304
    ds_read_b64_tr_b16 v[74:75], v38 offset:11584
    v_mfma_f32_16x16x32_bf16 v[56:59], v[96:99], a[40:43], v[56:59]
    ds_read_b64_tr_b16 v[76:77], v38 offset:10336
    ds_read_b64_tr_b16 v[78:79], v38 offset:11616
    v_mfma_f32_16x16x32_bf16 v[60:63], v[100:103], a[40:43], v[60:63]
    ds_read_b64_tr_b16 v[80:81], v38 offset:10368
    ds_read_b64_tr_b16 v[82:83], v38 offset:11648
    s_waitcnt vmcnt(13) lgkmcnt(10)
    v_mfma_f32_16x16x32_bf16 v[44:47], v[104:107], a[44:47], v[44:47]
    ds_read_b64_tr_b16 v[84:85], v38 offset:15360
    ds_read_b64_tr_b16 v[86:87], v38 offset:16640
    v_mfma_f32_16x16x32_bf16 v[48:51], v[108:111], a[44:47], v[48:51]
    ds_read_b64_tr_b16 v[88:89], v38 offset:15392
    ds_read_b64_tr_b16 v[90:91], v38 offset:16672
    v_mfma_f32_16x16x32_bf16 v[52:55], v[112:115], a[44:47], v[52:55]
    ds_read_b64_tr_b16 v[92:93], v38 offset:15424
    ds_read_b64_tr_b16 v[94:95], v38 offset:16704
    v_mfma_f32_16x16x32_bf16 v[56:59], v[116:119], a[44:47], v[56:59]
    ds_read_b64_tr_b16 v[96:97], v38 offset:15456
    ds_read_b64_tr_b16 v[98:99], v38 offset:16736
    v_mfma_f32_16x16x32_bf16 v[60:63], v[120:123], a[44:47], v[60:63]
    ds_read_b64_tr_b16 v[100:101], v38 offset:15488
    ds_read_b64_tr_b16 v[102:103], v38 offset:16768
    s_waitcnt vmcnt(12) lgkmcnt(10)
    v_mfma_f32_16x16x32_bf16 v[44:47], v[64:67], a[48:51], v[44:47]
    ds_read_b64_tr_b16 v[104:105], v38 offset:20480
    ds_read_b64_tr_b16 v[106:107], v38 offset:21760
    v_mfma_f32_16x16x32_bf16 v[48:51], v[68:71], a[48:51], v[48:51]
    ds_read_b64_tr_b16 v[108:109], v38 offset:20512
    ds_read_b64_tr_b16 v[110:111], v38 offset:21792
    v_mfma_f32_16x16x32_bf16 v[52:55], v[72:75], a[48:51], v[52:55]
    ds_read_b64_tr_b16 v[112:113], v38 offset:20544
    ds_read_b64_tr_b16 v[114:115], v38 offset:21824
    v_mfma_f32_16x16x32_bf16 v[56:59], v[76:79], a[48:51], v[56:59]
    ds_read_b64_tr_b16 v[116:117], v38 offset:20576
    ds_read_b64_tr_b16 v[118:119], v38 offset:21856
    v_mfma_f32_16x16x32_bf16 v[60:63], v[80:83], a[48:51], v[60:63]
    ds_read_b64_tr_b16 v[120:121], v38 offset:20608
    ds_read_b64_tr_b16 v[122:123], v38 offset:21888
    s_waitcnt vmcnt(11) lgkmcnt(10)
    v_mfma_f32_16x16x32_bf16 v[44:47], v[84:87], a[52:55], v[44:47]
    ds_read_b64_tr_b16 v[64:65], v38 offset:25600
    ds_read_b64_tr_b16 v[66:67], v38 offset:26880
    v_mfma_f32_16x16x32_bf16 v[48:51], v[88:91], a[52:55], v[48:51]
    ds_read_b64_tr_b16 v[68:69], v38 offset:25632
    ds_read_b64_tr_b16 v[70:71], v38 offset:26912
    v_mfma_f32_16x16x32_bf16 v[52:55], v[92:95], a[52:55], v[52:55]
    ds_read_b64_tr_b16 v[72:73], v38 offset:25664
    ds_read_b64_tr_b16 v[74:75], v38 offset:26944
    v_mfma_f32_16x16x32_bf16 v[56:59], v[96:99], a[52:55], v[56:59]
    ds_read_b64_tr_b16 v[76:77], v38 offset:25696
    ds_read_b64_tr_b16 v[78:79], v38 offset:26976
    v_mfma_f32_16x16x32_bf16 v[60:63], v[100:103], a[52:55], v[60:63]
    ds_read_b64_tr_b16 v[80:81], v38 offset:25728
    ds_read_b64_tr_b16 v[82:83], v38 offset:27008
    s_waitcnt vmcnt(10) lgkmcnt(10)
    v_mfma_f32_16x16x32_bf16 v[44:47], v[104:107], a[56:59], v[44:47]
    ds_read_b64_tr_b16 v[84:85], v38 offset:30720
    ds_read_b64_tr_b16 v[86:87], v38 offset:32000
    v_mfma_f32_16x16x32_bf16 v[48:51], v[108:111], a[56:59], v[48:51]
    ds_read_b64_tr_b16 v[88:89], v38 offset:30752
    ds_read_b64_tr_b16 v[90:91], v38 offset:32032
    v_mfma_f32_16x16x32_bf16 v[52:55], v[112:115], a[56:59], v[52:55]
    ds_read_b64_tr_b16 v[92:93], v38 offset:30784
    ds_read_b64_tr_b16 v[94:95], v38 offset:32064
    v_mfma_f32_16x16x32_bf16 v[56:59], v[116:119], a[56:59], v[56:59]
    ds_read_b64_tr_b16 v[96:97], v38 offset:30816
    ds_read_b64_tr_b16 v[98:99], v38 offset:32096
    v_mfma_f32_16x16x32_bf16 v[60:63], v[120:123], a[56:59], v[60:63]
    ds_read_b64_tr_b16 v[100:101], v38 offset:30848
    ds_read_b64_tr_b16 v[102:103], v38 offset:32128
    s_waitcnt vmcnt(9) lgkmcnt(10)
    v_mfma_f32_16x16x32_bf16 v[44:47], v[64:67], a[60:63], v[44:47]
    ds_read_b64_tr_b16 v[104:105], v38 offset:35840
    ds_read_b64_tr_b16 v[106:107], v38 offset:37120
    v_mfma_f32_16x16x32_bf16 v[48:51], v[68:71], a[60:63], v[48:51]
    ds_read_b64_tr_b16 v[108:109], v38 offset:35872
    ds_read_b64_tr_b16 v[110:111], v38 offset:37152
    v_mfma_f32_16x16x32_bf16 v[52:55], v[72:75], a[60:63], v[52:55]
    ds_read_b64_tr_b16 v[112:113], v38 offset:35904
    ds_read_b64_tr_b16 v[114:115], v38 offset:37184
    v_mfma_f32_16x16x32_bf16 v[56:59], v[76:79], a[60:63], v[56:59]
    ds_read_b64_tr_b16 v[116:117], v38 offset:35936
    ds_read_b64_tr_b16 v[118:119], v38 offset:37216
    v_mfma_f32_16x16x32_bf16 v[60:63], v[80:83], a[60:63], v[60:63]
    ds_read_b64_tr_b16 v[120:121], v38 offset:35968
    ds_read_b64_tr_b16 v[122:123], v38 offset:37248
    s_waitcnt vmcnt(8) lgkmcnt(10)
    v_mfma_f32_16x16x32_bf16 v[44:47], v[84:87], a[64:67], v[44:47]
    ds_read_b64_tr_b16 v[64:65], v38 offset:40960
    ds_read_b64_tr_b16 v[66:67], v38 offset:42240
    v_mfma_f32_16x16x32_bf16 v[48:51], v[88:91], a[64:67], v[48:51]
    ds_read_b64_tr_b16 v[68:69], v38 offset:40992
    ds_read_b64_tr_b16 v[70:71], v38 offset:42272
    v_mfma_f32_16x16x32_bf16 v[52:55], v[92:95], a[64:67], v[52:55]
    ds_read_b64_tr_b16 v[72:73], v38 offset:41024
    ds_read_b64_tr_b16 v[74:75], v38 offset:42304
    v_mfma_f32_16x16x32_bf16 v[56:59], v[96:99], a[64:67], v[56:59]
    ds_read_b64_tr_b16 v[76:77], v38 offset:41056
    ds_read_b64_tr_b16 v[78:79], v38 offset:42336
    v_mfma_f32_16x16x32_bf16 v[60:63], v[100:103], a[64:67], v[60:63]
    ds_read_b64_tr_b16 v[80:81], v38 offset:41088
    ds_read_b64_tr_b16 v[82:83], v38 offset:42368
    s_waitcnt vmcnt(7) lgkmcnt(10)
    v_mfma_f32_16x16x32_bf16 v[44:47], v[104:107], a[68:71], v[44:47]
    ds_read_b64_tr_b16 v[84:85], v38 offset:46080
    ds_read_b64_tr_b16 v[86:87], v38 offset:47360
    v_mfma_f32_16x16x32_bf16 v[48:51], v[108:111], a[68:71], v[48:51]
    ds_read_b64_tr_b16 v[88:89], v38 offset:46112
    ds_read_b64_tr_b16 v[90:91], v38 offset:47392
    v_mfma_f32_16x16x32_bf16 v[52:55], v[112:115], a[68:71], v[52:55]
    ds_read_b64_tr_b16 v[92:93], v38 offset:46144
    ds_read_b64_tr_b16 v[94:95], v38 offset:47424
    v_mfma_f32_16x16x32_bf16 v[56:59], v[116:119], a[68:71], v[56:59]
    ds_read_b64_tr_b16 v[96:97], v38 offset:46176
    ds_read_b64_tr_b16 v[98:99], v38 offset:47456
    v_mfma_f32_16x16x32_bf16 v[60:63], v[120:123], a[68:71], v[60:63]
    ds_read_b64_tr_b16 v[100:101], v38 offset:46208
    ds_read_b64_tr_b16 v[102:103], v38 offset:47488
    s_waitcnt vmcnt(6) lgkmcnt(10)
    v_mfma_f32_16x16x32_bf16 v[44:47], v[64:67], a[72:75], v[44:47]
    v_mfma_f32_16x16x32_bf16 v[48:51], v[68:71], a[72:75], v[48:51]
    v_mfma_f32_16x16x32_bf16 v[52:55], v[72:75], a[72:75], v[52:55]
    v_mfma_f32_16x16x32_bf16 v[56:59], v[76:79], a[72:75], v[56:59]
    v_mfma_f32_16x16x32_bf16 v[60:63], v[80:83], a[72:75], v[60:63]
    s_waitcnt vmcnt(5) lgkmcnt(0)
    v_mfma_f32_16x16x32_bf16 v[44:47], v[84:87], a[76:79], v[44:47]
    v_mfma_f32_16x16x32_bf16 v[48:51], v[88:91], a[76:79], v[48:51]
    v_mfma_f32_16x16x32_bf16 v[52:55], v[92:95], a[76:79], v[52:55]
    v_mfma_f32_16x16x32_bf16 v[56:59], v[96:99], a[76:79], v[56:59]
    v_mfma_f32_16x16x32_bf16 v[60:63], v[100:103], a[76:79], v[60:63]
    s_barrier
    s_waitcnt vmcnt(0)
    v_lshlrev_b32_e64 v64, 16, v26
    v_and_b32 v65, 0xffff0000, v26
    v_lshlrev_b32_e64 v66, 16, v27
    v_and_b32 v67, 0xffff0000, v27
    v_lshlrev_b32_e64 v68, 16, v28
    v_and_b32 v69, 0xffff0000, v28
    v_lshlrev_b32_e64 v70, 16, v29
    v_and_b32 v71, 0xffff0000, v29
    v_lshlrev_b32_e64 v72, 16, v30
    v_and_b32 v73, 0xffff0000, v30
    v_lshlrev_b32_e64 v74, 16, v31
    v_and_b32 v75, 0xffff0000, v31
    v_lshlrev_b32_e64 v76, 16, v32
    v_and_b32 v77, 0xffff0000, v32
    v_lshlrev_b32_e64 v78, 16, v33
    v_and_b32 v79, 0xffff0000, v33
    v_lshlrev_b32_e64 v80, 16, v34
    v_and_b32 v81, 0xffff0000, v34
    v_lshlrev_b32_e64 v82, 16, v35
    v_and_b32 v83, 0xffff0000, v35
    v_pk_add_f32 v[44:45], v[44:45], v[64:65]
    v_pk_add_f32 v[46:47], v[46:47], v[66:67]
    v_pk_add_f32 v[48:49], v[48:49], v[68:69]
    v_pk_add_f32 v[50:51], v[50:51], v[70:71]
    v_pk_add_f32 v[52:53], v[52:53], v[72:73]
    v_pk_add_f32 v[54:55], v[54:55], v[74:75]
    v_pk_add_f32 v[56:57], v[56:57], v[76:77]
    v_pk_add_f32 v[58:59], v[58:59], v[78:79]
    v_pk_add_f32 v[60:61], v[60:61], v[80:81]
    v_pk_add_f32 v[62:63], v[62:63], v[82:83]
    v_cvt_pk_bf16_f32 v14, v44, v45
    v_cvt_pk_bf16_f32 v15, v46, v47
    v_cvt_pk_bf16_f32 v16, v48, v49
    v_cvt_pk_bf16_f32 v17, v50, v51
    v_cvt_pk_bf16_f32 v18, v52, v53
    v_cvt_pk_bf16_f32 v19, v54, v55
    v_cvt_pk_bf16_f32 v20, v56, v57
    v_cvt_pk_bf16_f32 v21, v58, v59
    v_cvt_pk_bf16_f32 v22, v60, v61
    v_cvt_pk_bf16_f32 v23, v62, v63
    v_mov_b32 v84, v14
    v_mov_b32 v85, v15
    v_mov_b32 v86, v16
    v_mov_b32 v87, v17
    v_mov_b32 v88, v18
    v_mov_b32 v89, v19
    v_mov_b32 v90, v20
    v_mov_b32 v91, v21
    v_mov_b32 v92, v22
    v_mov_b32 v93, v23
    v_mov_b32 v94, v22
    v_mov_b32 v95, v23
    v_permlane16_swap_b32 v84, v86
    v_permlane16_swap_b32 v85, v87
    v_permlane16_swap_b32 v88, v90
    v_permlane16_swap_b32 v89, v91
    v_permlane16_swap_b32 v92, v94
    v_permlane16_swap_b32 v93, v95
    buffer_store_dwordx4 v[84:87], v40, s[40:43], 0 offen sc1
    buffer_store_dwordx4 v[88:91], v41, s[40:43], 0 offen sc1
    buffer_store_dwordx4 v[92:95], v42, s[40:43], 0 offen sc1
    s_mov_b32 s8, 0x3f803f80
    v_mov_b32 v64, 0
    v_mov_b32 v65, 0
    v_mov_b32 v66, 0
    v_mov_b32 v67, 0
    v_dot2c_f32_bf16 v64, s8, v14
    v_dot2c_f32_bf16 v66, v14, v14
    v_dot2c_f32_bf16 v65, s8, v15
    v_dot2c_f32_bf16 v67, v15, v15
    v_dot2c_f32_bf16 v64, s8, v16
    v_dot2c_f32_bf16 v66, v16, v16
    v_dot2c_f32_bf16 v65, s8, v17
    v_dot2c_f32_bf16 v67, v17, v17
    v_dot2c_f32_bf16 v64, s8, v18
    v_dot2c_f32_bf16 v66, v18, v18
    v_dot2c_f32_bf16 v65, s8, v19
    v_dot2c_f32_bf16 v67, v19, v19
    v_dot2c_f32_bf16 v64, s8, v20
    v_dot2c_f32_bf16 v66, v20, v20
    v_dot2c_f32_bf16 v65, s8, v21
    v_dot2c_f32_bf16 v67, v21, v21
    v_dot2c_f32_bf16 v64, s8, v22
    v_dot2c_f32_bf16 v66, v22, v22
    v_dot2c_f32_bf16 v65, s8, v23
    v_dot2c_f32_bf16 v67, v23, v23
    s_nop 1
    v_add_f32 v64, v64, v65
    v_add_f32 v66, v66, v67
    s_nop 1
    v_permlane32_swap_b32 v64, v66
    v_add_f32 v64, v64, v66
    v_mov_b32 v65, v64
    s_nop 1
    v_permlane16_swap_b32 v64, v65
    v_add_f32 v64, v64, v65
    buffer_store_dword v64, v43, s[40:43], 0 offen sc1
    s_mul_i32 s4, s13, 245760
    s_add_u32 s4, s4, 20971520
    v_add_u32 v24, s4, v12
    s_sub_u32 s6, s14, 1
    s_max_i32 s6, s6, 0
    s_lshl_b32 s6, s6, 12
    s_cmp_eq_u32 s14, 0
    s_cbranch_scc1 L_p4np_39
    s_add_u32 s18, s6, 0
    s_add_u32 m0, s6, 0
    s_nop 0
    buffer_load_dwordx4 v24, s[40:43], s18 offen sc1 lds
    buffer_load_dwordx4 v24, s[40:43], s18 offen offset:1024 sc1 lds
    buffer_load_dwordx4 v24, s[40:43], s18 offen offset:2048 sc1 lds
    buffer_load_dwordx4 v24, s[40:43], s18 offen offset:3072 sc1 lds
L_p4np_39:
    s_cmp_eq_u32 s14, 0
    s_cbranch_scc1 L_p3d_40
    s_waitcnt vmcnt(4)
    s_branch L_p3e_41
L_p3d_40:
    s_waitcnt vmcnt(0)
L_p3e_41:
    s_barrier
    s_cmp_lg_u32 s14, 0
    s_cbranch_scc1 L_sig_42
    s_lshl_b32 s4, s12, 8
    s_add_u32 s4, s4, 16384
    v_mov_b32 v4, s4
    v_mov_b32 v5, 1
    s_mov_b64 exec, 1
    buffer_atomic_add v5, v4, s[40:43], 0 offen sc1
    s_mov_b64 exec, -1
L_sig_42:
    s_mul_i32 s76, s14, 3072
    s_sub_u32 s6, s14, 1
    s_max_i32 s6, s6, 0
    s_lshl_b32 s6, s6, 12
    s_cmp_eq_u32 s14, 0
    s_cbranch_scc1 L_p4np_43
    s_add_u32 s18, s6, 12288
    s_add_u32 m0, s6, 12288
    s_nop 0
    buffer_load_dwordx4 v24, s[40:43], s18 offen sc1 lds
    buffer_load_dwordx4 v24, s[40:43], s18 offen offset:1024 sc1 lds
    buffer_load_dwordx4 v24, s[40:43], s18 offen offset:2048 sc1 lds
    buffer_load_dwordx4 v24, s[40:43], s18 offen offset:3072 sc1 lds
    s_add_u32 s18, s6, 24576
    s_add_u32 m0, s6, 24576
    s_nop 0
    buffer_load_dwordx4 v24, s[40:43], s18 offen sc1 lds
    buffer_load_dwordx4 v24, s[40:43], s18 offen offset:1024 sc1 lds
    buffer_load_dwordx4 v24, s[40:43], s18 offen offset:2048 sc1 lds
    buffer_load_dwordx4 v24, s[40:43], s18 offen offset:3072 sc1 lds
    s_add_u32 s18, s6, 36864
    s_add_u32 m0, s6, 36864
    s_nop 0
    buffer_load_dwordx4 v24, s[40:43], s18 offen sc1 lds
    buffer_load_dwordx4 v24, s[40:43], s18 offen offset:1024 sc1 lds
    buffer_load_dwordx4 v24, s[40:43], s18 offen offset:2048 sc1 lds
    buffer_load_dwordx4 v24, s[40:43], s18 offen offset:3072 sc1 lds
    s_add_u32 s18, s6, 49152
    s_add_u32 m0, s6, 49152
    s_nop 0
    buffer_load_dwordx4 v24, s[40:43], s18 offen sc1 lds
    buffer_load_dwordx4 v24, s[40:43], s18 offen offset:1024 sc1 lds
    buffer_load_dwordx4 v24, s[40:43], s18 offen offset:2048 sc1 lds
    buffer_load_dwordx4 v24, s[40:43], s18 offen offset:3072 sc1 lds
    s_add_u32 s18, s6, 61440
    s_add_u32 m0, s6, 61440
    s_nop 0
    buffer_load_dwordx4 v24, s[40:43], s18 offen sc1 lds
    buffer_load_dwordx4 v24, s[40:43], s18 offen offset:1024 sc1 lds
    buffer_load_dwordx4 v24, s[40:43], s18 offen offset:2048 sc1 lds
    buffer_load_dwordx4 v24, s[40:43], s18 offen offset:3072 sc1 lds
    s_add_u32 s18, s6, 73728
    s_add_u32 m0, s6, 73728
    s_nop 0
    buffer_load_dwordx4 v24, s[40:43], s18 offen sc1 lds
    buffer_load_dwordx4 v24, s[40:43], s18 offen offset:1024 sc1 lds
    buffer_load_dwordx4 v24, s[40:43], s18 offen offset:2048 sc1 lds
    buffer_load_dwordx4 v24, s[40:43], s18 offen offset:3072 sc1 lds
    s_add_u32 s18, s6, 86016
    s_add_u32 m0, s6, 86016
    s_nop 0
    buffer_load_dwordx4 v24, s[40:43], s18 offen sc1 lds
    buffer_load_dwordx4 v24, s[40:43], s18 offen offset:1024 sc1 lds
    buffer_load_dwordx4 v24, s[40:43], s18 offen offset:2048 sc1 lds
    buffer_load_dwordx4 v24, s[40:43], s18 offen offset:3072 sc1 lds
    s_add_u32 s18, s6, 98304
    s_add_u32 m0, s6, 98304
    s_nop 0
    buffer_load_dwordx4 v24, s[40:43], s18 offen sc1 lds
    buffer_load_dwordx4 v24, s[40:43], s18 offen offset:1024 sc1 lds
    buffer_load_dwordx4 v24, s[40:43], s18 offen offset:2048 sc1 lds
    buffer_load_dwordx4 v24, s[40:43], s18 offen offset:3072 sc1 lds
L_p4np_43:
    s_and_b32 s77, s14, 1
    s_lshr_b32 s78, s14, 1
    s_mul_i32 s79, s77, 10240
    s_mul_i32 s4, s78, 5120
    s_add_u32 s79, s79, s4
    s_mul_i32 s80, s77, 122880
    s_add_u32 s80, s80, s4
    s_mul_i32 s4, s16, 245760
    s_add_u32 s4, s4, 25165824
    v_add_u32 v25, s4, v12
    v_lshrrev_b32 v4, 5, v1
    v_lshlrev_b32 v4, 3, v4
    v_bfe_u32 v5, v1, 2, 2
    v_add_u32_e64 v4, v4, v5
    v_mul_u32_u24 v4, 96, v4
    v_and_b32_e64 v5, 3, v1
    v_lshl_add_u32 v4, v5, 3, v4
    v_bfe_u32 v5, v1, 4, 1
    v_mul_u32_u24 v6, 6528, v5
    v_add_u32_e64 v31, v4, v6
    v_add_u32 v32, 36864, v31
    v_add_u32 v33, 73728, v31
    v_mul_u32_u24 v6, 5760, v5
    v_add_u32_e64 v34, v4, v6
    v_add_u32 v35, 36864, v34
    v_add_u32 v36, 73728, v34
    s_lshl_b32 s4, s12, 2
    s_add_u32 s4, s4, s14
    s_mul_i32 s4, s4, 40960
    s_add_u32 s4, s4, 6291456
    v_add_u32 v37, s4, v12
    s_lshl_b32 s4, s13, 4
    s_lshl_b32 s5, s14, 2
    s_add_u32 s4, s4, s5
    s_lshl_b32 s4, s4, 10
    s_add_u32 s4, s4, 262144
    v_add_u32 v72, s4, v12
    s_lshl_b32 s4, s12, 3
    s_lshl_b32 s5, s14, 1
    s_add_u32 s4, s4, s5
    s_lshl_b32 s4, s4, 10
    s_add_u32 s4, s4, 9437184
    v_bfe_u32 v4, v1, 4, 1
    v_lshlrev_b32 v4, 10, v4
    v_lshrrev_b32 v5, 5, v1
    v_lshl_add_u32 v4, v5, 9, v4
    v_and_b32_e64 v5, 15, v1
    v_lshl_add_u32 v4, v5, 3, v4
    v_add_u32 v84, s4, v4
    v_mov_b32 v88, 0
    v_mov_b32 v89, 0
    v_mov_b32 v90, 0
    v_mov_b32 v91, 0
    v_mov_b32 v92, 0
    v_mov_b32 v93, 0
    v_mov_b32 v94, 0
    v_mov_b32 v95, 0
    v_mov_b32 v96, 0
    v_mov_b32 v97, 0
    v_mov_b32 v98, 0
    v_mov_b32 v99, 0
    v_mov_b32 v100, 0
    v_mov_b32 v101, 0
    v_mov_b32 v102, 0
    v_mov_b32 v103, 0
    v_mov_b32 v104, 0
    v_mov_b32 v105, 0
    v_mov_b32 v106, 0
    v_mov_b32 v107, 0
    v_mov_b32 v108, 0
    v_mov_b32 v109, 0
    v_mov_b32 v110, 0
    v_mov_b32 v111, 0
    v_mov_b32 v112, 0
    v_mov_b32 v113, 0
    v_mov_b32 v114, 0
    v_mov_b32 v115, 0
    v_mov_b32 v116, 0
    v_mov_b32 v117, 0
    v_mov_b32 v118, 0
    v_mov_b32 v119, 0
    v_mov_b32 v120, 0
    v_mov_b32 v121, 0
    v_mov_b32 v122, 0
    v_mov_b32 v123, 0
    v_mov_b32 v124, 0
    v_mov_b32 v125, 0
    v_mov_b32 v126, 0
    v_mov_b32 v127, 0
    v_mov_b32 v128, 0
    v_mov_b32 v129, 0
    v_mov_b32 v130, 0
    v_mov_b32 v131, 0
    v_mov_b32 v132, 0
    v_mov_b32 v133, 0
    v_mov_b32 v134, 0
    v_mov_b32 v135, 0
    v_mov_b32 v136, 0
    v_mov_b32 v137, 0
    v_mov_b32 v138, 0
    v_mov_b32 v139, 0
    v_mov_b32 v140, 0
    v_mov_b32 v141, 0
    v_mov_b32 v142, 0
    v_mov_b32 v143, 0
    v_mov_b32 v144, 0
    v_mov_b32 v145, 0
    v_mov_b32 v146, 0
    v_mov_b32 v147, 0
    v_mov_b32 v148, 0
    v_mov_b32 v149, 0
    v_mov_b32 v150, 0
    v_mov_b32 v151, 0
    v_mov_b32 v152, 0
    v_mov_b32 v153, 0
    v_mov_b32 v154, 0
    v_mov_b32 v155, 0
    v_mov_b32 v156, 0
    v_mov_b32 v157, 0
    v_mov_b32 v158, 0
    v_mov_b32 v159, 0
    v_mov_b32 v160, 0
    v_mov_b32 v161, 0
    v_mov_b32 v162, 0
    v_mov_b32 v163, 0
    v_mov_b32 v164, 0
    v_mov_b32 v165, 0
    v_mov_b32 v166, 0
    v_mov_b32 v167, 0
    v_mov_b32 v168, 0
    v_mov_b32 v169, 0
    v_mov_b32 v170, 0
    v_mov_b32 v171, 0
    v_mov_b32 v172, 0
    v_mov_b32 v173, 0
    v_mov_b32 v174, 0
    v_mov_b32 v175, 0
    v_mov_b32 v176, 0
    v_mov_b32 v177, 0
    v_mov_b32 v178, 0
    v_mov_b32 v179, 0
    v_mov_b32 v180, 0
    v_mov_b32 v181, 0
    v_mov_b32 v182, 0
    v_mov_b32 v183, 0
    s_lshl_b32 s4, s14, 10
    s_add_u32 s4, s4, 159744
    v_lshrrev_b32_e64 v4, 5, v1
    v_lshl_add_u32 v220, v4, 4, s4
    s_lshl_b32 s4, s12, 3
    s_lshl_b32 s5, s14, 1
    s_add_u32 s4, s4, s5
    s_mul_i32 s4, s4, 48
    s_lshr_b32 s5, s13, 1
    s_mul_i32 s5, s5, 3
    s_add_u32 s4, s4, s5
    s_lshl_b32 s4, s4, 10
    s_add_u32 s4, s4, 10485760
    v_bfe_u32 v5, v1, 4, 1
    v_mul_u32_u24 v5, 49152, v5
    v_lshl_add_u32 v5, v4, 8, v5
    v_and_b32_e64 v6, 15, v1
    v_lshl_add_u32 v5, v6, 4, v5
    v_add_u32 v221, s4, v5
    s_and_b32 s81, s13, 1
    s_mul_i32 s4, s77, 10240
    v_lshrrev_b32 v4, 5, v1
    v_lshlrev_b32 v4, 4, v4
    v_bfe_u32 v5, v1, 4, 1
    v_lshl_add_u32 v4, v5, 2, v4
    v_bfe_u32 v5, v1, 2, 2
    v_add_u32_e64 v4, v4, v5
    v_mul_u32_u24 v4, 160, v4
    v_and_b32_e64 v5, 3, v1
    v_lshl_add_u32 v28, v5, 3, v4
    v_add_u32_e64 v28, s4, v28
    v_add_u32 v29, 61440, v28
    v_add_u32 v30, 114688, v28
    s_lshl_b32 s4, s15, 2
    s_lshl_b32 s5, s78, 1
    s_add_u32 s4, s4, s5
    s_mul_i32 s4, s4, 48
    s_mul_i32 s5, s77, 12
    s_add_u32 s4, s4, s5
    s_lshl_b32 s4, s4, 10
    s_add_u32 s4, s4, 10485760
    v_add_u32 v26, s4, v12
    v_add_u32 v27, 49152, v26
    s_cmp_lg_u32 s14, 0
    s_cbranch_scc1 L_pe_44
    s_lshl_b32 s4, s12, 8
    s_add_u32 s4, s4, 16384
    v_mov_b32 v4, s4
    s_mov_b32 s19, 0
    s_mov_b64 exec, 1
L_pl_45:
    buffer_load_dword v5, v4, s[40:43], 0 offen sc1
    s_waitcnt vmcnt(0)
    v_cmp_gt_u32 vcc, 16, v5
    s_add_u32 s19, s19, 1
    s_cmp_eq_u64 vcc, 0
    s_cbranch_scc1 L_pe_44x
    s_cmp_lt_u32 s19, 200000
    s_cbranch_scc1 L_pl_45
L_pe_44x:
    s_mov_b64 exec, -1
L_pe_44:
    s_barrier
    s_mov_b32 s17, 0
    buffer_load_dwordx4 a[0:3], v37, s[40:43], s17 offen offset:0 sc1
    buffer_load_dwordx4 a[4:7], v37, s[40:43], s17 offen offset:1024 sc1
    buffer_load_dwordx4 a[8:11], v37, s[40:43], s17 offen offset:2048 sc1
    buffer_load_dwordx4 a[12:15], v37, s[40:43], s17 offen offset:3072 sc1
    s_mov_b32 s17, 4096
    buffer_load_dwordx4 a[16:19], v37, s[40:43], s17 offen offset:0 sc1
    buffer_load_dwordx4 a[20:23], v37, s[40:43], s17 offen offset:1024 sc1
    buffer_load_dwordx4 a[24:27], v37, s[40:43], s17 offen offset:2048 sc1
    buffer_load_dwordx4 a[28:31], v37, s[40:43], s17 offen offset:3072 sc1
    s_waitcnt vmcnt(8)
    s_barrier
    ds_read_b64_tr_b16 v[184:185], v31 offset:0
    ds_read_b64_tr_b16 v[186:187], v34 offset:384
    ds_read_b64_tr_b16 v[188:189], v31 offset:32
    ds_read_b64_tr_b16 v[190:191], v34 offset:416
    ds_read_b64_tr_b16 v[192:193], v31 offset:64
    ds_read_b64_tr_b16 v[194:195], v34 offset:448
    ds_read_b64_tr_b16 v[196:197], v31 offset:1536
    ds_read_b64_tr_b16 v[198:199], v34 offset:1920
    ds_read_b64_tr_b16 v[200:201], v31 offset:1568
    ds_read_b64_tr_b16 v[202:203], v34 offset:1952
    ds_read_b64_tr_b16 v[204:205], v31 offset:1600
    ds_read_b64_tr_b16 v[206:207], v34 offset:1984
    s_waitcnt vmcnt(7) lgkmcnt(6)
    v_mfma_f32_32x32x16_bf16 v[88:103], v[184:187], a[0:3], v[88:103]
    ds_read_b64_tr_b16 v[208:209], v31 offset:3072
    ds_read_b64_tr_b16 v[210:211], v34 offset:3456
    s_mov_b32 s17, 8192
    buffer_load_dwordx4 a[32:35], v37, s[40:43], s17 offen offset:0 sc1
    v_mfma_f32_32x32x16_bf16 v[104:119], v[188:191], a[0:3], v[104:119]
    ds_read_b64_tr_b16 v[212:213], v31 offset:3104
    ds_read_b64_tr_b16 v[214:215], v34 offset:3488
    v_mfma_f32_32x32x16_bf16 v[120:135], v[192:195], a[0:3], v[120:135]
    ds_read_b64_tr_b16 v[216:217], v31 offset:3136
    ds_read_b64_tr_b16 v[218:219], v34 offset:3520
    s_waitcnt vmcnt(7) lgkmcnt(6)
    s_barrier
    v_mfma_f32_32x32x16_bf16 v[88:103], v[196:199], a[4:7], v[88:103]
    ds_read_b64_tr_b16 v[184:185], v31 offset:4608
    ds_read_b64_tr_b16 v[186:187], v34 offset:4992
    buffer_load_dwordx4 a[36:39], v37, s[40:43], s17 offen offset:1024 sc1
    v_mfma_f32_32x32x16_bf16 v[104:119], v[200:203], a[4:7], v[104:119]
    ds_read_b64_tr_b16 v[188:189], v31 offset:4640
    ds_read_b64_tr_b16 v[190:191], v34 offset:5024
    v_mfma_f32_32x32x16_bf16 v[120:135], v[204:207], a[4:7], v[120:135]
    ds_read_b64_tr_b16 v[192:193], v31 offset:4672
    ds_read_b64_tr_b16 v[194:195], v34 offset:5056
    s_waitcnt vmcnt(7) lgkmcnt(6)
    v_mfma_f32_32x32x16_bf16 v[88:103], v[208:211], a[8:11], v[88:103]
    ds_read_b64_tr_b16 v[196:197], v31 offset:12288
    ds_read_b64_tr_b16 v[198:199], v34 offset:12672
    buffer_load_dwordx4 a[40:43], v37, s[40:43], s17 offen offset:2048 sc1
    v_mfma_f32_32x32x16_bf16 v[104:119], v[212:215], a[8:11], v[104:119]
    ds_read_b64_tr_b16 v[200:201], v31 offset:12320
    ds_read_b64_tr_b16 v[202:203], v34 offset:12704
    buffer_load_dwordx4 v[40:43], v72, s[40:43], 0 offen offset:0 sc1
    v_mfma_f32_32x32x16_bf16 v[120:135], v[216:219], a[8:11], v[120:135]
    ds_read_b64_tr_b16 v[204:205], v31 offset:12352
    ds_read_b64_tr_b16 v[206:207], v34 offset:12736
    s_waitcnt vmcnt(8) lgkmcnt(6)
    v_mfma_f32_32x32x16_bf16 v[88:103], v[184:187], a[12:15], v[88:103]
    ds_read_b64_tr_b16 v[208:209], v31 offset:13824
    ds_read_b64_tr_b16 v[210:211], v34 offset:14208
    buffer_load_dwordx4 a[44:47], v37, s[40:43], s17 offen offset:3072 sc1
    v_mfma_f32_32x32x16_bf16 v[104:119], v[188:191], a[12:15], v[104:119]
    ds_read_b64_tr_b16 v[212:213], v31 offset:13856
    ds_read_b64_tr_b16 v[214:215], v34 offset:14240
    buffer_load_dwordx4 v[44:47], v72, s[40:43], 0 offen offset:1024 sc1
    v_mfma_f32_32x32x16_bf16 v[120:135], v[192:195], a[12:15], v[120:135]
    ds_read_b64_tr_b16 v[216:217], v31 offset:13888
    ds_read_b64_tr_b16 v[218:219], v34 offset:14272
    s_waitcnt vmcnt(9) lgkmcnt(6)
    v_mfma_f32_32x32x16_bf16 v[88:103], v[196:199], a[16:19], v[88:103]
    ds_read_b64_tr_b16 v[184:185], v31 offset:15360
    ds_read_b64_tr_b16 v[186:187], v34 offset:15744
    s_mov_b32 s17, 12288
    buffer_load_dwordx4 a[48:51], v37, s[40:43], s17 offen offset:0 sc1
    v_mfma_f32_32x32x16_bf16 v[104:119], v[200:203], a[16:19], v[104:119]
    ds_read_b64_tr_b16 v[188:189], v31 offset:15392
    ds_read_b64_tr_b16 v[190:191], v34 offset:15776
    buffer_load_dwordx4 v[48:51], v72, s[40:43], 0 offen offset:2048 sc1
    v_mfma_f32_32x32x16_bf16 v[120:135], v[204:207], a[16:19], v[120:135]
    ds_read_b64_tr_b16 v[192:193], v31 offset:15424
    ds_read_b64_tr_b16 v[194:195], v34 offset:15808
    s_waitcnt vmcnt(10) lgkmcnt(6)
    s_barrier
    v_mfma_f32_32x32x16_bf16 v[88:103], v[208:211], a[20:23], v[88:103]
    ds_read_b64_tr_b16 v[196:197], v31 offset:16896
    ds_read_b64_tr_b16 v[198:199], v34 offset:17280
    buffer_load_dwordx4 a[52:55], v37, s[40:43], s17 offen offset:1024 sc1
    v_mfma_f32_32x32x16_bf16 v[104:119], v[212:215], a[20:23], v[104:119]
    ds_read_b64_tr_b16 v[200:201], v31 offset:16928
    ds_read_b64_tr_b16 v[202:203], v34 offset:17312
    buffer_load_dwordx4 v[52:55], v72, s[40:43], 0 offen offset:3072 sc1
    v_mfma_f32_32x32x16_bf16 v[120:135], v[216:219], a[20:23], v[120:135]
    ds_read_b64_tr_b16 v[204:205], v31 offset:16960
    ds_read_b64_tr_b16 v[206:207], v34 offset:17344
    s_waitcnt vmcnt(11) lgkmcnt(6)
    v_mfma_f32_32x32x16_bf16 v[88:103], v[184:187], a[24:27], v[88:103]
    ds_read_b64_tr_b16 v[208:209], v31 offset:24576
    ds_read_b64_tr_b16 v[210:211], v34 offset:24960
    buffer_load_dwordx4 a[56:59], v37, s[40:43], s17 offen offset:2048 sc1
    v_mfma_f32_32x32x16_bf16 v[104:119], v[188:191], a[24:27], v[104:119]
    ds_read_b64_tr_b16 v[212:213], v31 offset:24608
    ds_read_b64_tr_b16 v[214:215], v34 offset:24992
    buffer_load_dwordx2 v[76:77], v84, s[40:43], 0 offen offset:0 sc1
    v_mfma_f32_32x32x16_bf16 v[120:135], v[192:195], a[24:27], v[120:135]
    ds_read_b64_tr_b16 v[216:217], v31 offset:24640
    ds_read_b64_tr_b16 v[218:219], v34 offset:25024
    s_waitcnt vmcnt(12) lgkmcnt(6)
    v_mfma_f32_32x32x16_bf16 v[88:103], v[196:199], a[28:31], v[88:103]
    ds_read_b64_tr_b16 v[184:185], v31 offset:26112
    ds_read_b64_tr_b16 v[186:187], v34 offset:26496
    buffer_load_dwordx4 a[60:63], v37, s[40:43], s17 offen offset:3072 sc1
    v_mfma_f32_32x32x16_bf16 v[104:119], v[200:203], a[28:31], v[104:119]
    ds_read_b64_tr_b16 v[188:189], v31 offset:26144
    ds_read_b64_tr_b16 v[190:191], v34 offset:26528
    buffer_load_dwordx2 v[78:79], v84, s[40:43], 0 offen offset:128 sc1
    v_mfma_f32_32x32x16_bf16 v[120:135], v[204:207], a[28:31], v[120:135]
    ds_read_b64_tr_b16 v[192:193], v31 offset:26176
    ds_read_b64_tr_b16 v[194:195], v34 offset:26560
    s_waitcnt vmcnt(13) lgkmcnt(6)
    v_mfma_f32_32x32x16_bf16 v[88:103], v[208:211], a[32:35], v[88:103]
    ds_read_b64_tr_b16 v[196:197], v31 offset:27648
    ds_read_b64_tr_b16 v[198:199], v34 offset:28032
    s_mov_b32 s17, 16384
    buffer_load_dwordx4 a[64:67], v37, s[40:43], s17 offen offset:0 sc1
    v_mfma_f32_32x32x16_bf16 v[104:119], v[212:215], a[32:35], v[104:119]
    ds_read_b64_tr_b16 v[200:201], v31 offset:27680
    ds_read_b64_tr_b16 v[202:203], v34 offset:28064
    buffer_load_dwordx2 v[80:81], v84, s[40:43], 0 offen offset:256 sc1
    v_mfma_f32_32x32x16_bf16 v[120:135], v[216:219], a[32:35], v[120:135]
    ds_read_b64_tr_b16 v[204:205], v31 offset:27712
    ds_read_b64_tr_b16 v[206:207], v34 offset:28096
    s_waitcnt vmcnt(14) lgkmcnt(6)
    s_barrier
    v_mfma_f32_32x32x16_bf16 v[88:103], v[184:187], a[36:39], v[88:103]
    ds_read_b64_tr_b16 v[208:209], v31 offset:29184
    ds_read_b64_tr_b16 v[210:211], v34 offset:29568
    buffer_load_dwordx4 a[68:71], v37, s[40:43], s17 offen offset:1024 sc1
    v_mfma_f32_32x32x16_bf16 v[104:119], v[188:191], a[36:39], v[104:119]
    ds_read_b64_tr_b16 v[212:213], v31 offset:29216
    ds_read_b64_tr_b16 v[214:215], v34 offset:29600
    buffer_load_dwordx2 v[82:83], v84, s[40:43], 0 offen offset:384 sc1
    v_mfma_f32_32x32x16_bf16 v[120:135], v[192:195], a[36:39], v[120:135]
    ds_read_b64_tr_b16 v[216:217], v31 offset:29248
    ds_read_b64_tr_b16 v[218:219], v34 offset:29632
    s_waitcnt vmcnt(15) lgkmcnt(6)
    v_mfma_f32_32x32x16_bf16 v[88:103], v[196:199], a[40:43], v[88:103]
    ds_read_b64_tr_b16 v[184:185], v32 offset:0
    ds_read_b64_tr_b16 v[186:187], v35 offset:384
    buffer_load_dwordx4 a[72:75], v37, s[40:43], s17 offen offset:2048 sc1
    v_mfma_f32_32x32x16_bf16 v[104:119], v[200:203], a[40:43], v[104:119]
    ds_read_b64_tr_b16 v[188:189], v32 offset:32
    ds_read_b64_tr_b16 v[190:191], v35 offset:416
    v_mfma_f32_32x32x16_bf16 v[120:135], v[204:207], a[40:43], v[120:135]
    ds_read_b64_tr_b16 v[192:193], v32 offset:64
    ds_read_b64_tr_b16 v[194:195], v35 offset:448
    s_waitcnt vmcnt(14) lgkmcnt(6)
    v_mfma_f32_32x32x16_bf16 v[88:103], v[208:211], a[44:47], v[88:103]
    ds_read_b64_tr_b16 v[196:197], v32 offset:1536
    ds_read_b64_tr_b16 v[198:199], v35 offset:1920
    buffer_load_dwordx4 a[76:79], v37, s[40:43], s17 offen offset:3072 sc1
    v_mfma_f32_32x32x16_bf16 v[104:119], v[212:215], a[44:47], v[104:119]
    ds_read_b64_tr_b16 v[200:201], v32 offset:1568
    ds_read_b64_tr_b16 v[202:203], v35 offset:1952
    v_mfma_f32_32x32x16_bf16 v[120:135], v[216:219], a[44:47], v[120:135]
    ds_read_b64_tr_b16 v[204:205], v32 offset:1600
    ds_read_b64_tr_b16 v[206:207], v35 offset:1984
    s_waitcnt vmcnt(13) lgkmcnt(6)
    v_mfma_f32_32x32x16_bf16 v[88:103], v[184:187], a[48:51], v[88:103]
    ds_read_b64_tr_b16 v[208:209], v32 offset:3072
    ds_read_b64_tr_b16 v[210:211], v35 offset:3456
    s_mov_b32 s17, 20480
    buffer_load_dwordx4 a[80:83], v37, s[40:43], s17 offen offset:0 sc1
    v_mfma_f32_32x32x16_bf16 v[104:119], v[188:191], a[48:51], v[104:119]
    ds_read_b64_tr_b16 v[212:213], v32 offset:3104
    ds_read_b64_tr_b16 v[214:215], v35 offset:3488
    v_mfma_f32_32x32x16_bf16 v[120:135], v[192:195], a[48:51], v[120:135]
    ds_read_b64_tr_b16 v[216:217], v32 offset:3136
    ds_read_b64_tr_b16 v[218:219], v35 offset:3520
    s_waitcnt vmcnt(12) lgkmcnt(6)
    s_barrier
    v_mfma_f32_32x32x16_bf16 v[88:103], v[196:199], a[52:55], v[88:103]
    ds_read_b64_tr_b16 v[184:185], v32 offset:4608
    ds_read_b64_tr_b16 v[186:187], v35 offset:4992
    buffer_load_dwordx4 a[84:87], v37, s[40:43], s17 offen offset:1024 sc1
    v_mfma_f32_32x32x16_bf16 v[104:119], v[200:203], a[52:55], v[104:119]
    ds_read_b64_tr_b16 v[188:189], v32 offset:4640
    ds_read_b64_tr_b16 v[190:191], v35 offset:5024
    v_mfma_f32_32x32x16_bf16 v[120:135], v[204:207], a[52:55], v[120:135]
    ds_read_b64_tr_b16 v[192:193], v32 offset:4672
    ds_read_b64_tr_b16 v[194:195], v35 offset:5056
    s_waitcnt vmcnt(11) lgkmcnt(6)
    v_mfma_f32_32x32x16_bf16 v[88:103], v[208:211], a[56:59], v[88:103]
    ds_read_b64_tr_b16 v[196:197], v32 offset:12288
    ds_read_b64_tr_b16 v[198:199], v35 offset:12672
    buffer_load_dwordx4 a[88:91], v37, s[40:43], s17 offen offset:2048 sc1
    v_mfma_f32_32x32x16_bf16 v[104:119], v[212:215], a[56:59], v[104:119]
    ds_read_b64_tr_b16 v[200:201], v32 offset:12320
    ds_read_b64_tr_b16 v[202:203], v35 offset:12704
    v_mfma_f32_32x32x16_bf16 v[120:135], v[216:219], a[56:59], v[120:135]
    ds_read_b64_tr_b16 v[204:205], v32 offset:12352
    ds_read_b64_tr_b16 v[206:207], v35 offset:12736
    s_waitcnt vmcnt(10) lgkmcnt(6)
    v_mfma_f32_32x32x16_bf16 v[88:103], v[184:187], a[60:63], v[88:103]
    ds_read_b64_tr_b16 v[208:209], v32 offset:13824
    ds_read_b64_tr_b16 v[210:211], v35 offset:14208
    buffer_load_dwordx4 a[92:95], v37, s[40:43], s17 offen offset:3072 sc1
    v_mfma_f32_32x32x16_bf16 v[104:119], v[188:191], a[60:63], v[104:119]
    ds_read_b64_tr_b16 v[212:213], v32 offset:13856
    ds_read_b64_tr_b16 v[214:215], v35 offset:14240
    v_mfma_f32_32x32x16_bf16 v[120:135], v[192:195], a[60:63], v[120:135]
    ds_read_b64_tr_b16 v[216:217], v32 offset:13888
    ds_read_b64_tr_b16 v[218:219], v35 offset:14272
    s_waitcnt vmcnt(9) lgkmcnt(6)
    v_mfma_f32_32x32x16_bf16 v[88:103], v[196:199], a[64:67], v[88:103]
    ds_read_b64_tr_b16 v[184:185], v32 offset:15360
    ds_read_b64_tr_b16 v[186:187], v35 offset:15744
    s_mov_b32 s17, 24576
    buffer_load_dwordx4 a[96:99], v37, s[40:43], s17 offen offset:0 sc1
    v_mfma_f32_32x32x16_bf16 v[104:119], v[200:203], a[64:67], v[104:119]
    ds_read_b64_tr_b16 v[188:189], v32 offset:15392
    ds_read_b64_tr_b16 v[190:191], v35 offset:15776
    v_mfma_f32_32x32x16_bf16 v[120:135], v[204:207], a[64:67], v[120:135]
    ds_read_b64_tr_b16 v[192:193], v32 offset:15424
    ds_read_b64_tr_b16 v[194:195], v35 offset:15808
    s_waitcnt vmcnt(8) lgkmcnt(6)
    s_barrier
    v_mfma_f32_32x32x16_bf16 v[88:103], v[208:211], a[68:71], v[88:103]
    ds_read_b64_tr_b16 v[196:197], v32 offset:16896
    ds_read_b64_tr_b16 v[198:199], v35 offset:17280
    buffer_load_dwordx4 a[100:103], v37, s[40:43], s17 offen offset:1024 sc1
    v_mfma_f32_32x32x16_bf16 v[104:119], v[212:215], a[68:71], v[104:119]
    ds_read_b64_tr_b16 v[200:201], v32 offset:16928
    ds_read_b64_tr_b16 v[202:203], v35 offset:17312
    v_mfma_f32_32x32x16_bf16 v[120:135], v[216:219], a[68:71], v[120:135]
    ds_read_b64_tr_b16 v[204:205], v32 offset:16960
    ds_read_b64_tr_b16 v[206:207], v35 offset:17344
    s_waitcnt vmcnt(7) lgkmcnt(6)
    v_mfma_f32_32x32x16_bf16 v[88:103], v[184:187], a[72:75], v[88:103]
    ds_read_b64_tr_b16 v[208:209], v32 offset:24576
    ds_read_b64_tr_b16 v[210:211], v35 offset:24960
    buffer_load_dwordx4 a[104:107], v37, s[40:43], s17 offen offset:2048 sc1
    v_mfma_f32_32x32x16_bf16 v[104:119], v[188:191], a[72:75], v[104:119]
    ds_read_b64_tr_b16 v[212:213], v32 offset:24608
    ds_read_b64_tr_b16 v[214:215], v35 offset:24992
    v_mfma_f32_32x32x16_bf16 v[120:135], v[192:195], a[72:75], v[120:135]
    ds_read_b64_tr_b16 v[216:217], v32 offset:24640
    ds_read_b64_tr_b16 v[218:219], v35 offset:25024
    s_waitcnt vmcnt(7) lgkmcnt(6)
    v_mfma_f32_32x32x16_bf16 v[88:103], v[196:199], a[76:79], v[88:103]
    ds_read_b64_tr_b16 v[184:185], v32 offset:26112
    ds_read_b64_tr_b16 v[186:187], v35 offset:26496
    buffer_load_dwordx4 a[108:111], v37, s[40:43], s17 offen offset:3072 sc1
    v_mfma_f32_32x32x16_bf16 v[104:119], v[200:203], a[76:79], v[104:119]
    ds_read_b64_tr_b16 v[188:189], v32 offset:26144
    ds_read_b64_tr_b16 v[190:191], v35 offset:26528
    v_mfma_f32_32x32x16_bf16 v[120:135], v[204:207], a[76:79], v[120:135]
    ds_read_b64_tr_b16 v[192:193], v32 offset:26176
    ds_read_b64_tr_b16 v[194:195], v35 offset:26560
    s_waitcnt vmcnt(7) lgkmcnt(6)
    v_mfma_f32_32x32x16_bf16 v[88:103], v[208:211], a[80:83], v[88:103]
    ds_read_b64_tr_b16 v[196:197], v32 offset:27648
    ds_read_b64_tr_b16 v[198:199], v35 offset:28032
    s_mov_b32 s17, 28672
    buffer_load_dwordx4 a[112:115], v37, s[40:43], s17 offen offset:0 sc1
    v_mfma_f32_32x32x16_bf16 v[104:119], v[212:215], a[80:83], v[104:119]
    ds_read_b64_tr_b16 v[200:201], v32 offset:27680
    ds_read_b64_tr_b16 v[202:203], v35 offset:28064
    v_mfma_f32_32x32x16_bf16 v[120:135], v[216:219], a[80:83], v[120:135]
    s_nop 0
    ds_read_b64_tr_b16 v[204:205], v32 offset:27712
    ds_read_b64_tr_b16 v[206:207], v35 offset:28096
    v_pk_add_f32 v[40:41], v[40:41], v[44:45]
    v_pk_add_f32 v[42:43], v[42:43], v[46:47]
    v_pk_add_f32 v[40:41], v[40:41], v[48:49]
    v_pk_add_f32 v[42:43], v[42:43], v[50:51]
    v_pk_add_f32 v[40:41], v[40:41], v[52:53]
    v_pk_add_f32 v[42:43], v[42:43], v[54:55]
    s_lshl_b32 s4, s14, 10
    s_add_u32 s4, s4, 155648
    v_add_u32 v4, s4, v12
    ds_write_b128 v4, v[40:43]
    s_waitcnt vmcnt(7) lgkmcnt(6)
    s_barrier
    v_mfma_f32_32x32x16_bf16 v[88:103], v[184:187], a[84:87], v[88:103]
    ds_read_b64_tr_b16 v[208:209], v32 offset:29184
    ds_read_b64_tr_b16 v[210:211], v35 offset:29568
    buffer_load_dwordx4 a[116:119], v37, s[40:43], s17 offen offset:1024 sc1
    v_mfma_f32_32x32x16_bf16 v[104:119], v[188:191], a[84:87], v[104:119]
    ds_read_b64_tr_b16 v[212:213], v32 offset:29216
    ds_read_b64_tr_b16 v[214:215], v35 offset:29600
    v_mfma_f32_32x32x16_bf16 v[120:135], v[192:195], a[84:87], v[120:135]
    ds_read_b64_tr_b16 v[216:217], v32 offset:29248
    ds_read_b64_tr_b16 v[218:219], v35 offset:29632
    s_waitcnt vmcnt(7) lgkmcnt(6)
    v_mfma_f32_32x32x16_bf16 v[88:103], v[196:199], a[88:91], v[88:103]
    ds_read_b64_tr_b16 v[184:185], v33 offset:0
    ds_read_b64_tr_b16 v[186:187], v36 offset:384
    buffer_load_dwordx4 a[120:123], v37, s[40:43], s17 offen offset:2048 sc1
    v_mfma_f32_32x32x16_bf16 v[104:119], v[200:203], a[88:91], v[104:119]
    ds_read_b64_tr_b16 v[188:189], v33 offset:32
    ds_read_b64_tr_b16 v[190:191], v36 offset:416
    v_mfma_f32_32x32x16_bf16 v[120:135], v[204:207], a[88:91], v[120:135]
    ds_read_b64_tr_b16 v[192:193], v33 offset:64
    ds_read_b64_tr_b16 v[194:195], v36 offset:448
    s_waitcnt vmcnt(7) lgkmcnt(6)
    v_mfma_f32_32x32x16_bf16 v[88:103], v[208:211], a[92:95], v[88:103]
    ds_read_b64_tr_b16 v[196:197], v33 offset:1536
    ds_read_b64_tr_b16 v[198:199], v36 offset:1920
    buffer_load_dwordx4 a[124:127], v37, s[40:43], s17 offen offset:3072 sc1
    v_mfma_f32_32x32x16_bf16 v[104:119], v[212:215], a[92:95], v[104:119]
    ds_read_b64_tr_b16 v[200:201], v33 offset:1568
    ds_read_b64_tr_b16 v[202:203], v36 offset:1952
    s_add_u32 s18, s76, 110592
    s_add_u32 m0, s76, 0
    s_nop 0
    buffer_load_dwordx4 v24, s[40:43], s18 offen sc1 lds
    v_mfma_f32_32x32x16_bf16 v[120:135], v[216:219], a[92:95], v[120:135]
    ds_read_b64_tr_b16 v[204:205], v33 offset:1600
    ds_read_b64_tr_b16 v[206:207], v36 offset:1984
    s_waitcnt vmcnt(8) lgkmcnt(6)
    v_mfma_f32_32x32x16_bf16 v[88:103], v[184:187], a[96:99], v[88:103]
    ds_read_b64_tr_b16 v[208:209], v33 offset:3072
    ds_read_b64_tr_b16 v[210:211], v36 offset:3456
    s_mov_b32 s17, 32768
    buffer_load_dwordx4 a[128:131], v37, s[40:43], s17 offen offset:0 sc1
    v_mfma_f32_32x32x16_bf16 v[104:119], v[188:191], a[96:99], v[104:119]
    ds_read_b64_tr_b16 v[212:213], v33 offset:3104
    ds_read_b64_tr_b16 v[214:215], v36 offset:3488
    buffer_load_dwordx4 v24, s[40:43], s18 offen offset:1024 sc1 lds
    v_mfma_f32_32x32x16_bf16 v[120:135], v[192:195], a[96:99], v[120:135]
    ds_read_b64_tr_b16 v[216:217], v33 offset:3136
    ds_read_b64_tr_b16 v[218:219], v36 offset:3520
    s_waitcnt vmcnt(9) lgkmcnt(6)
    s_barrier
    v_mfma_f32_32x32x16_bf16 v[88:103], v[196:199], a[100:103], v[88:103]
    ds_read_b64_tr_b16 v[184:185], v33 offset:4608
    ds_read_b64_tr_b16 v[186:187], v36 offset:4992
    buffer_load_dwordx4 a[132:135], v37, s[40:43], s17 offen offset:1024 sc1
    v_mfma_f32_32x32x16_bf16 v[104:119], v[200:203], a[100:103], v[104:119]
    ds_read_b64_tr_b16 v[188:189], v33 offset:4640
    ds_read_b64_tr_b16 v[190:191], v36 offset:5024
    buffer_load_dwordx4 v24, s[40:43], s18 offen offset:2048 sc1 lds
    v_mfma_f32_32x32x16_bf16 v[120:135], v[204:207], a[100:103], v[120:135]
    ds_read_b64_tr_b16 v[192:193], v33 offset:4672
    ds_read_b64_tr_b16 v[194:195], v36 offset:5056
    s_waitcnt vmcnt(10) lgkmcnt(6)
    v_mfma_f32_32x32x16_bf16 v[88:103], v[208:211], a[104:107], v[88:103]
    ds_read_b64_tr_b16 v[196:197], v33 offset:12288
    ds_read_b64_tr_b16 v[198:199], v36 offset:12672
    buffer_load_dwordx4 a[136:139], v37, s[40:43], s17 offen offset:2048 sc1
    v_mfma_f32_32x32x16_bf16 v[104:119], v[212:215], a[104:107], v[104:119]
    ds_read_b64_tr_b16 v[200:201], v33 offset:12320
    ds_read_b64_tr_b16 v[202:203], v36 offset:12704
    v_mfma_f32_32x32x16_bf16 v[120:135], v[216:219], a[104:107], v[120:135]
    ds_read_b64_tr_b16 v[204:205], v33 offset:12352
    ds_read_b64_tr_b16 v[206:207], v36 offset:12736
    v_add_u32 v4, 155648, v12
    ds_read_b128 v[40:43], v4 offset:0
    ds_read_b128 v[44:47], v4 offset:1024
    ds_read_b128 v[48:51], v4 offset:2048
    ds_read_b128 v[52:55], v4 offset:3072
    s_waitcnt lgkmcnt(0)
    s_nop 0
    v_pk_add_f32 v[40:41], v[40:41], v[44:45]
    v_pk_add_f32 v[42:43], v[42:43], v[46:47]
    v_pk_add_f32 v[40:41], v[40:41], v[48:49]
    v_pk_add_f32 v[42:43], v[42:43], v[50:51]
    v_pk_add_f32 v[40:41], v[40:41], v[52:53]
    v_pk_add_f32 v[42:43], v[42:43], v[54:55]
    s_lshl_b32 s4, s14, 10
    s_add_u32 s4, s4, 159744
    v_add_u32 v4, s4, v12
    ds_write_b128 v4, v[40:43]
    s_waitcnt vmcnt(10) lgkmcnt(6)
    v_mfma_f32_32x32x16_bf16 v[88:103], v[184:187], a[108:111], v[88:103]
    ds_read_b64_tr_b16 v[208:209], v33 offset:13824
    ds_read_b64_tr_b16 v[210:211], v36 offset:14208
    buffer_load_dwordx4 a[140:143], v37, s[40:43], s17 offen offset:3072 sc1
    v_mfma_f32_32x32x16_bf16 v[104:119], v[188:191], a[108:111], v[104:119]
    ds_read_b64_tr_b16 v[212:213], v33 offset:13856
    ds_read_b64_tr_b16 v[214:215], v36 offset:14240
    s_add_u32 s18, s76, 122880
    s_add_u32 m0, s76, 61440
    s_nop 0
    buffer_load_dwordx4 v24, s[40:43], s18 offen sc1 lds
    v_mfma_f32_32x32x16_bf16 v[120:135], v[192:195], a[108:111], v[120:135]
    ds_read_b64_tr_b16 v[216:217], v33 offset:13888
    ds_read_b64_tr_b16 v[218:219], v36 offset:14272
    s_waitcnt vmcnt(11) lgkmcnt(6)
    v_mfma_f32_32x32x16_bf16 v[88:103], v[196:199], a[112:115], v[88:103]
    ds_read_b64_tr_b16 v[184:185], v33 offset:15360
    ds_read_b64_tr_b16 v[186:187], v36 offset:15744
    s_mov_b32 s17, 36864
    buffer_load_dwordx4 a[144:147], v37, s[40:43], s17 offen offset:0 sc1
    v_mfma_f32_32x32x16_bf16 v[104:119], v[200:203], a[112:115], v[104:119]
    ds_read_b64_tr_b16 v[188:189], v33 offset:15392
    ds_read_b64_tr_b16 v[190:191], v36 offset:15776
    buffer_load_dwordx4 v24, s[40:43], s18 offen offset:1024 sc1 lds
    v_mfma_f32_32x32x16_bf16 v[120:135], v[204:207], a[112:115], v[120:135]
    ds_read_b64_tr_b16 v[192:193], v33 offset:15424
    ds_read_b64_tr_b16 v[194:195], v36 offset:15808
    s_waitcnt vmcnt(12) lgkmcnt(6)
    s_barrier
    v_mfma_f32_32x32x16_bf16 v[88:103], v[208:211], a[116:119], v[88:103]
    ds_read_b64_tr_b16 v[196:197], v33 offset:16896
    ds_read_b64_tr_b16 v[198:199], v36 offset:17280
    buffer_load_dwordx4 a[148:151], v37, s[40:43], s17 offen offset:1024 sc1
    v_mfma_f32_32x32x16_bf16 v[104:119], v[212:215], a[116:119], v[104:119]
    ds_read_b64_tr_b16 v[200:201], v33 offset:16928
    ds_read_b64_tr_b16 v[202:203], v36 offset:17312
    buffer_load_dwordx4 v24, s[40:43], s18 offen offset:2048 sc1 lds
    v_mfma_f32_32x32x16_bf16 v[120:135], v[216:219], a[116:119], v[120:135]
    ds_read_b64_tr_b16 v[204:205], v33 offset:16960
    ds_read_b64_tr_b16 v[206:207], v36 offset:17344
    s_waitcnt vmcnt(13) lgkmcnt(6)
    v_mfma_f32_32x32x16_bf16 v[88:103], v[184:187], a[120:123], v[88:103]
    ds_read_b64_tr_b16 v[208:209], v33 offset:24576
    ds_read_b64_tr_b16 v[210:211], v36 offset:24960
    buffer_load_dwordx4 a[152:155], v37, s[40:43], s17 offen offset:2048 sc1
    v_mfma_f32_32x32x16_bf16 v[104:119], v[188:191], a[120:123], v[104:119]
    ds_read_b64_tr_b16 v[212:213], v33 offset:24608
    ds_read_b64_tr_b16 v[214:215], v36 offset:24992
    v_mfma_f32_32x32x16_bf16 v[120:135], v[192:195], a[120:123], v[120:135]
    ds_read_b64_tr_b16 v[216:217], v33 offset:24640
    ds_read_b64_tr_b16 v[218:219], v36 offset:25024
    s_waitcnt vmcnt(13) lgkmcnt(6)
    v_mfma_f32_32x32x16_bf16 v[88:103], v[196:199], a[124:127], v[88:103]
    ds_read_b64_tr_b16 v[184:185], v33 offset:26112
    ds_read_b64_tr_b16 v[186:187], v36 offset:26496
    buffer_load_dwordx4 a[156:159], v37, s[40:43], s17 offen offset:3072 sc1
    v_mfma_f32_32x32x16_bf16 v[104:119], v[200:203], a[124:127], v[104:119]
    ds_read_b64_tr_b16 v[188:189], v33 offset:26144
    ds_read_b64_tr_b16 v[190:191], v36 offset:26528
    s_add_u32 s18, s76, 135168
    s_add_u32 m0, s76, 73728
    s_nop 0
    buffer_load_dwordx4 v24, s[40:43], s18 offen sc1 lds
    v_mfma_f32_32x32x16_bf16 v[120:135], v[204:207], a[124:127], v[120:135]
    ds_read_b64_tr_b16 v[192:193], v33 offset:26176
    ds_read_b64_tr_b16 v[194:195], v36 offset:26560
    s_waitcnt vmcnt(13) lgkmcnt(6)
    v_mfma_f32_32x32x16_bf16 v[88:103], v[208:211], a[128:131], v[88:103]
    ds_read_b64_tr_b16 v[196:197], v33 offset:27648
    ds_read_b64_tr_b16 v[198:199], v36 offset:28032
    v_mfma_f32_32x32x16_bf16 v[104:119], v[212:215], a[128:131], v[104:119]
    ds_read_b64_tr_b16 v[200:201], v33 offset:27680
    ds_read_b64_tr_b16 v[202:203], v36 offset:28064
    buffer_load_dwordx4 v24, s[40:43], s18 offen offset:1024 sc1 lds
    v_mfma_f32_32x32x16_bf16 v[120:135], v[216:219], a[128:131], v[120:135]
    ds_read_b64_tr_b16 v[204:205], v33 offset:27712
    ds_read_b64_tr_b16 v[206:207], v36 offset:28096
    v_pk_add_f32 v[76:77], v[76:77], v[78:79]
    v_pk_add_f32 v[76:77], v[76:77], v[80:81]
    v_pk_add_f32 v[76:77], v[76:77], v[82:83]
    v_mov_b32 v78, v76
    v_mov_b32 v79, v77
    s_nop 0
    v_permlane32_swap_b32 v76, v78
    v_permlane32_swap_b32 v77, v79
    v_pk_add_f32 v[76:77], v[76:77], v[78:79]
    v_mul_f32 v80, 0xbacccccd, v76
    v_mul_f32 v77, 0x3acccccd, v77
    v_fma_f32 v77, -v80, v80, v77
    v_max_f32_e64 v77, 0, v77
    v_add_f32 v77, 0x3727c5ac, v77
    v_rcp_f32 v82, v77
    s_waitcnt vmcnt(11) lgkmcnt(6)
    s_barrier
    v_mfma_f32_32x32x16_bf16 v[88:103], v[184:187], a[132:135], v[88:103]
    ds_read_b64_tr_b16 v[208:209], v33 offset:29184
    ds_read_b64_tr_b16 v[210:211], v36 offset:29568
    v_mfma_f32_32x32x16_bf16 v[104:119], v[188:191], a[132:135], v[104:119]
    ds_read_b64_tr_b16 v[212:213], v33 offset:29216
    ds_read_b64_tr_b16 v[214:215], v36 offset:29600
    buffer_load_dwordx4 v24, s[40:43], s18 offen offset:2048 sc1 lds
    v_mfma_f32_32x32x16_bf16 v[120:135], v[192:195], a[132:135], v[120:135]
    ds_read_b64_tr_b16 v[216:217], v33 offset:29248
    ds_read_b64_tr_b16 v[218:219], v36 offset:29632
    s_waitcnt vmcnt(11) lgkmcnt(6)
    v_mfma_f32_32x32x16_bf16 v[88:103], v[196:199], a[136:139], v[88:103]
    ds_read_b64_tr_b16 v[184:185], v31 offset:0
    ds_read_b64_tr_b16 v[186:187], v34 offset:384
    v_mfma_f32_32x32x16_bf16 v[104:119], v[200:203], a[136:139], v[104:119]
    ds_read_b64_tr_b16 v[188:189], v31 offset:32
    ds_read_b64_tr_b16 v[190:191], v34 offset:416
    v_mfma_f32_32x32x16_bf16 v[120:135], v[204:207], a[136:139], v[120:135]
    ds_read_b64_tr_b16 v[192:193], v31 offset:64
    ds_read_b64_tr_b16 v[194:195], v34 offset:448
    s_waitcnt vmcnt(10) lgkmcnt(6)
    v_mfma_f32_32x32x16_bf16 v[88:103], v[208:211], a[140:143], v[88:103]
    ds_read_b64_tr_b16 v[196:197], v31 offset:1536
    ds_read_b64_tr_b16 v[198:199], v34 offset:1920
    v_mfma_f32_32x32x16_bf16 v[104:119], v[212:215], a[140:143], v[104:119]
    ds_read_b64_tr_b16 v[200:201], v31 offset:1568
    ds_read_b64_tr_b16 v[202:203], v34 offset:1952
    s_add_u32 s18, s76, 147456
    s_add_u32 m0, s76, 86016
    s_nop 0
    buffer_load_dwordx4 v24, s[40:43], s18 offen sc1 lds
    v_mfma_f32_32x32x16_bf16 v[120:135], v[216:219], a[140:143], v[120:135]
    ds_read_b64_tr_b16 v[204:205], v31 offset:1600
    ds_read_b64_tr_b16 v[206:207], v34 offset:1984
    s_waitcnt vmcnt(9) lgkmcnt(6)
    v_mfma_f32_32x32x16_bf16 v[88:103], v[184:187], a[144:147], v[88:103]
    ds_read_b64_tr_b16 v[208:209], v31 offset:3072
    ds_read_b64_tr_b16 v[210:211], v34 offset:3456
    v_mfma_f32_32x32x16_bf16 v[104:119], v[188:191], a[144:147], v[104:119]
    ds_read_b64_tr_b16 v[212:213], v31 offset:3104
    ds_read_b64_tr_b16 v[214:215], v34 offset:3488
    buffer_load_dwordx4 v24, s[40:43], s18 offen offset:1024 sc1 lds
    v_mfma_f32_32x32x16_bf16 v[120:135], v[192:195], a[144:147], v[120:135]
    ds_read_b64_tr_b16 v[216:217], v31 offset:3136
    ds_read_b64_tr_b16 v[218:219], v34 offset:3520
    s_waitcnt vmcnt(7) lgkmcnt(6)
    s_barrier
    v_mfma_f32_32x32x16_bf16 v[88:103], v[196:199], a[148:151], v[88:103]
    ds_read_b64_tr_b16 v[184:185], v31 offset:4608
    ds_read_b64_tr_b16 v[186:187], v34 offset:4992
    v_mfma_f32_32x32x16_bf16 v[104:119], v[200:203], a[148:151], v[104:119]
    ds_read_b64_tr_b16 v[188:189], v31 offset:4640
    ds_read_b64_tr_b16 v[190:191], v34 offset:5024
    buffer_load_dwordx4 v24, s[40:43], s18 offen offset:2048 sc1 lds
    v_mfma_f32_32x32x16_bf16 v[120:135], v[204:207], a[148:151], v[120:135]
    ds_read_b64_tr_b16 v[192:193], v31 offset:4672
    ds_read_b64_tr_b16 v[194:195], v34 offset:5056
    s_waitcnt vmcnt(7) lgkmcnt(6)
    v_mfma_f32_32x32x16_bf16 v[88:103], v[208:211], a[152:155], v[88:103]
    ds_read_b64_tr_b16 v[196:197], v32 offset:24576
    ds_read_b64_tr_b16 v[198:199], v35 offset:24960
    v_mfma_f32_32x32x16_bf16 v[104:119], v[212:215], a[152:155], v[104:119]
    ds_read_b64_tr_b16 v[200:201], v32 offset:24608
    ds_read_b64_tr_b16 v[202:203], v35 offset:24992
    v_mfma_f32_32x32x16_bf16 v[120:135], v[216:219], a[152:155], v[120:135]
    ds_read_b64_tr_b16 v[204:205], v32 offset:24640
    ds_read_b64_tr_b16 v[206:207], v35 offset:25024
    s_waitcnt vmcnt(6) lgkmcnt(6)
    v_mfma_f32_32x32x16_bf16 v[88:103], v[184:187], a[156:159], v[88:103]
    ds_read_b64_tr_b16 v[208:209], v32 offset:26112
    ds_read_b64_tr_b16 v[210:211], v35 offset:26496
    v_mfma_f32_32x32x16_bf16 v[104:119], v[188:191], a[156:159], v[104:119]
    ds_read_b64_tr_b16 v[212:213], v32 offset:26144
    ds_read_b64_tr_b16 v[214:215], v35 offset:26528
    s_add_u32 s18, s76, 159744
    s_add_u32 m0, s76, 98304
    s_nop 0
    buffer_load_dwordx4 v24, s[40:43], s18 offen sc1 lds
    v_mfma_f32_32x32x16_bf16 v[120:135], v[192:195], a[156:159], v[120:135]
    ds_read_b64_tr_b16 v[216:217], v32 offset:26176
    ds_read_b64_tr_b16 v[218:219], v35 offset:26560
    ds_read_b128 v[40:43], v220 offset:0
    ds_read_b128 v[48:51], v220 offset:512
    ds_read_b128 v[44:47], v220 offset:32
    ds_read_b128 v[52:55], v220 offset:544
    ds_read_b128 v[56:59], v220 offset:64
    ds_read_b128 v[64:67], v220 offset:576
    ds_read_b128 v[60:63], v220 offset:96
    ds_read_b128 v[68:71], v220 offset:608
    s_waitcnt lgkmcnt(4)
    s_nop 0
    v_pk_fma_f32 v[88:89], v[40:41], v[80:81], v[88:89] op_sel_hi:[1,0,1]
    v_pk_fma_f32 v[90:91], v[42:43], v[80:81], v[90:91] op_sel_hi:[1,0,1]
    v_pk_fma_f32 v[92:93], v[44:45], v[80:81], v[92:93] op_sel_hi:[1,0,1]
    v_pk_fma_f32 v[94:95], v[46:47], v[80:81], v[94:95] op_sel_hi:[1,0,1]
    v_pk_fma_f32 v[96:97], v[48:49], v[80:81], v[96:97] op_sel_hi:[1,0,1]
    v_pk_fma_f32 v[98:99], v[50:51], v[80:81], v[98:99] op_sel_hi:[1,0,1]
    v_pk_fma_f32 v[100:101], v[52:53], v[80:81], v[100:101] op_sel_hi:[1,0,1]
    v_pk_fma_f32 v[102:103], v[54:55], v[80:81], v[102:103] op_sel_hi:[1,0,1]
    v_max_f32 v88, 0, v88
    v_max_f32 v89, 0, v89
    v_max_f32 v90, 0, v90
    v_max_f32 v91, 0, v91
    v_max_f32 v92, 0, v92
    v_max_f32 v93, 0, v93
    v_max_f32 v94, 0, v94
    v_max_f32 v95, 0, v95
    v_pk_mul_f32 v[96:97], v[96:97], v[82:83] op_sel_hi:[1,0]
    v_pk_mul_f32 v[98:99], v[98:99], v[82:83] op_sel_hi:[1,0]
    v_pk_mul_f32 v[100:101], v[100:101], v[82:83] op_sel_hi:[1,0]
    v_pk_mul_f32 v[102:103], v[102:103], v[82:83] op_sel_hi:[1,0]
    v_pk_mul_f32 v[88:89], v[88:89], v[96:97]
    v_pk_mul_f32 v[90:91], v[90:91], v[98:99]
    v_pk_mul_f32 v[92:93], v[92:93], v[100:101]
    v_pk_mul_f32 v[94:95], v[94:95], v[102:103]
    v_cvt_pk_bf16_f32 v96, v88, v89
    v_cvt_pk_bf16_f32 v97, v90, v91
    v_cvt_pk_bf16_f32 v98, v92, v93
    v_cvt_pk_bf16_f32 v99, v94, v95
    s_lshl_b32 s4, s81, 10
    s_add_u32 s5, s4, 0
    buffer_store_dwordx4 v[96:99], v221, s[40:43], s5 offen sc1
    ds_read_b128 v[40:43], v220 offset:128
    ds_read_b128 v[48:51], v220 offset:640
    ds_read_b128 v[44:47], v220 offset:160
    ds_read_b128 v[52:55], v220 offset:672
    s_waitcnt lgkmcnt(4)
    s_nop 0
    v_pk_fma_f32 v[104:105], v[56:57], v[80:81], v[104:105] op_sel_hi:[1,0,1]
    v_pk_fma_f32 v[106:107], v[58:59], v[80:81], v[106:107] op_sel_hi:[1,0,1]
    v_pk_fma_f32 v[108:109], v[60:61], v[80:81], v[108:109] op_sel_hi:[1,0,1]
    v_pk_fma_f32 v[110:111], v[62:63], v[80:81], v[110:111] op_sel_hi:[1,0,1]
    v_pk_fma_f32 v[112:113], v[64:65], v[80:81], v[112:113] op_sel_hi:[1,0,1]
    v_pk_fma_f32 v[114:115], v[66:67], v[80:81], v[114:115] op_sel_hi:[1,0,1]
    v_pk_fma_f32 v[116:117], v[68:69], v[80:81], v[116:117] op_sel_hi:[1,0,1]
    v_pk_fma_f32 v[118:119], v[70:71], v[80:81], v[118:119] op_sel_hi:[1,0,1]
    v_max_f32 v104, 0, v104
    v_max_f32 v105, 0, v105
    v_max_f32 v106, 0, v106
    v_max_f32 v107, 0, v107
    v_max_f32 v108, 0, v108
    v_max_f32 v109, 0, v109
    v_max_f32 v110, 0, v110
    v_max_f32 v111, 0, v111
    v_pk_mul_f32 v[112:113], v[112:113], v[82:83] op_sel_hi:[1,0]
    v_pk_mul_f32 v[114:115], v[114:115], v[82:83] op_sel_hi:[1,0]
    v_pk_mul_f32 v[116:117], v[116:117], v[82:83] op_sel_hi:[1,0]
    v_pk_mul_f32 v[118:119], v[118:119], v[82:83] op_sel_hi:[1,0]
    v_pk_mul_f32 v[104:105], v[104:105], v[112:113]
    v_pk_mul_f32 v[106:107], v[106:107], v[114:115]
    v_pk_mul_f32 v[108:109], v[108:109], v[116:117]
    v_pk_mul_f32 v[110:111], v[110:111], v[118:119]
    v_cvt_pk_bf16_f32 v112, v104, v105
    v_cvt_pk_bf16_f32 v113, v106, v107
    v_cvt_pk_bf16_f32 v114, v108, v109
    v_cvt_pk_bf16_f32 v115, v110, v111
    s_lshl_b32 s4, s81, 10
    s_add_u32 s5, s4, 512
    buffer_store_dwordx4 v[112:115], v221, s[40:43], s5 offen sc1
    s_waitcnt lgkmcnt(0)
    v_pk_fma_f32 v[120:121], v[40:41], v[80:81], v[120:121] op_sel_hi:[1,0,1]
    v_pk_fma_f32 v[122:123], v[42:43], v[80:81], v[122:123] op_sel_hi:[1,0,1]
    v_pk_fma_f32 v[124:125], v[44:45], v[80:81], v[124:125] op_sel_hi:[1,0,1]
    v_pk_fma_f32 v[126:127], v[46:47], v[80:81], v[126:127] op_sel_hi:[1,0,1]
    v_pk_fma_f32 v[128:129], v[48:49], v[80:81], v[128:129] op_sel_hi:[1,0,1]
    v_pk_fma_f32 v[130:131], v[50:51], v[80:81], v[130:131] op_sel_hi:[1,0,1]
    v_pk_fma_f32 v[132:133], v[52:53], v[80:81], v[132:133] op_sel_hi:[1,0,1]
    v_pk_fma_f32 v[134:135], v[54:55], v[80:81], v[134:135] op_sel_hi:[1,0,1]
    v_max_f32 v120, 0, v120
    v_max_f32 v121, 0, v121
    v_max_f32 v122, 0, v122
    v_max_f32 v123, 0, v123
    v_max_f32 v124, 0, v124
    v_max_f32 v125, 0, v125
    v_max_f32 v126, 0, v126
    v_max_f32 v127, 0, v127
    v_pk_mul_f32 v[128:129], v[128:129], v[82:83] op_sel_hi:[1,0]
    v_pk_mul_f32 v[130:131], v[130:131], v[82:83] op_sel_hi:[1,0]
    v_pk_mul_f32 v[132:133], v[132:133], v[82:83] op_sel_hi:[1,0]
    v_pk_mul_f32 v[134:135], v[134:135], v[82:83] op_sel_hi:[1,0]
    v_pk_mul_f32 v[120:121], v[120:121], v[128:129]
    v_pk_mul_f32 v[122:123], v[122:123], v[130:131]
    v_pk_mul_f32 v[124:125], v[124:125], v[132:133]
    v_pk_mul_f32 v[126:127], v[126:127], v[134:135]
    v_cvt_pk_bf16_f32 v128, v120, v121
    v_cvt_pk_bf16_f32 v129, v122, v123
    v_cvt_pk_bf16_f32 v130, v124, v125
    v_cvt_pk_bf16_f32 v131, v126, v127
    s_lshl_b32 s4, s81, 9
    s_add_u32 s5, s4, 2048
    buffer_store_dwordx4 v[128:131], v221, s[40:43], s5 offen sc1
    s_waitcnt lgkmcnt(6)
    v_mfma_f32_32x32x16_bf16 v[136:151], v[196:199], a[0:3], v[136:151]
    ds_read_b64_tr_b16 v[184:185], v32 offset:27648
    ds_read_b64_tr_b16 v[186:187], v35 offset:28032
    v_mfma_f32_32x32x16_bf16 v[152:167], v[200:203], a[0:3], v[152:167]
    ds_read_b64_tr_b16 v[188:189], v32 offset:27680
    ds_read_b64_tr_b16 v[190:191], v35 offset:28064
    buffer_load_dwordx4 v24, s[40:43], s18 offen offset:1024 sc1 lds
    v_mfma_f32_32x32x16_bf16 v[168:183], v[204:207], a[0:3], v[168:183]
    ds_read_b64_tr_b16 v[192:193], v32 offset:27712
    ds_read_b64_tr_b16 v[194:195], v35 offset:28096
    s_waitcnt vmcnt(8) lgkmcnt(6)
    s_barrier
    v_mfma_f32_32x32x16_bf16 v[136:151], v[208:211], a[4:7], v[136:151]
    ds_read_b64_tr_b16 v[196:197], v32 offset:29184
    ds_read_b64_tr_b16 v[198:199], v35 offset:29568
    v_mfma_f32_32x32x16_bf16 v[152:167], v[212:215], a[4:7], v[152:167]
    ds_read_b64_tr_b16 v[200:201], v32 offset:29216
    ds_read_b64_tr_b16 v[202:203], v35 offset:29600
    buffer_load_dwordx4 v24, s[40:43], s18 offen offset:2048 sc1 lds
    v_mfma_f32_32x32x16_bf16 v[168:183], v[216:219], a[4:7], v[168:183]
    ds_read_b64_tr_b16 v[204:205], v32 offset:29248
    ds_read_b64_tr_b16 v[206:207], v35 offset:29632
    s_add_u32 s29, s80, 0
    s_add_u32 m0, s79, 114688
    s_nop 0
    buffer_load_dwordx4 v25, s[40:43], s29 offen sc1 lds
    s_waitcnt lgkmcnt(6)
    v_mfma_f32_32x32x16_bf16 v[136:151], v[184:187], a[8:11], v[136:151]
    ds_read_b64_tr_b16 v[208:209], v33 offset:0
    ds_read_b64_tr_b16 v[210:211], v36 offset:384
    buffer_load_dwordx4 v25, s[40:43], s29 offen offset:1024 sc1 lds
    v_mfma_f32_32x32x16_bf16 v[152:167], v[188:191], a[8:11], v[152:167]
    ds_read_b64_tr_b16 v[212:213], v33 offset:32
    ds_read_b64_tr_b16 v[214:215], v36 offset:416
    buffer_load_dwordx4 v25, s[40:43], s29 offen offset:2048 sc1 lds
    v_mfma_f32_32x32x16_bf16 v[168:183], v[192:195], a[8:11], v[168:183]
    ds_read_b64_tr_b16 v[216:217], v33 offset:64
    ds_read_b64_tr_b16 v[218:219], v36 offset:448
    buffer_load_dwordx4 v25, s[40:43], s29 offen offset:3072 sc1 lds
    s_waitcnt lgkmcnt(6)
    v_mfma_f32_32x32x16_bf16 v[136:151], v[196:199], a[12:15], v[136:151]
    ds_read_b64_tr_b16 v[184:185], v33 offset:1536
    ds_read_b64_tr_b16 v[186:187], v36 offset:1920
    s_add_u32 s28, s29, 4096
    s_add_u32 m0, s79, 118784
    s_nop 0
    buffer_load_dwordx4 v25, s[40:43], s28 offen sc1 lds
    v_mfma_f32_32x32x16_bf16 v[152:167], v[200:203], a[12:15], v[152:167]
    ds_read_b64_tr_b16 v[188:189], v33 offset:1568
    ds_read_b64_tr_b16 v[190:191], v36 offset:1952
    s_add_u32 s29, s80, 10240
    s_add_u32 m0, s79, 135168
    s_nop 0
    buffer_load_dwordx4 v25, s[40:43], s29 offen sc1 lds
    v_mfma_f32_32x32x16_bf16 v[168:183], v[204:207], a[12:15], v[168:183]
    ds_read_b64_tr_b16 v[192:193], v33 offset:1600
    ds_read_b64_tr_b16 v[194:195], v36 offset:1984
    buffer_load_dwordx4 v25, s[40:43], s29 offen offset:1024 sc1 lds
    s_waitcnt lgkmcnt(6)
    v_mfma_f32_32x32x16_bf16 v[136:151], v[208:211], a[16:19], v[136:151]
    ds_read_b64_tr_b16 v[196:197], v33 offset:3072
    ds_read_b64_tr_b16 v[198:199], v36 offset:3456
    buffer_load_dwordx4 v25, s[40:43], s29 offen offset:2048 sc1 lds
    v_mfma_f32_32x32x16_bf16 v[152:167], v[212:215], a[16:19], v[152:167]
    ds_read_b64_tr_b16 v[200:201], v33 offset:3104
    ds_read_b64_tr_b16 v[202:203], v36 offset:3488
    buffer_load_dwordx4 v25, s[40:43], s29 offen offset:3072 sc1 lds
    v_mfma_f32_32x32x16_bf16 v[168:183], v[216:219], a[16:19], v[168:183]
    ds_read_b64_tr_b16 v[204:205], v33 offset:3136
    ds_read_b64_tr_b16 v[206:207], v36 offset:3520
    s_add_u32 s28, s29, 4096
    s_add_u32 m0, s79, 139264
    s_nop 0
    buffer_load_dwordx4 v25, s[40:43], s28 offen sc1 lds
    s_waitcnt vmcnt(16) lgkmcnt(6)
    s_barrier
    v_mfma_f32_32x32x16_bf16 v[136:151], v[184:187], a[20:23], v[136:151]
    ds_read_b64_tr_b16 v[208:209], v33 offset:4608
    ds_read_b64_tr_b16 v[210:211], v36 offset:4992
    s_add_u32 s29, s80, 20480
    s_add_u32 m0, s79, 0
    s_nop 0
    buffer_load_dwordx4 v25, s[40:43], s29 offen sc1 lds
    v_mfma_f32_32x32x16_bf16 v[152:167], v[188:191], a[20:23], v[152:167]
    ds_read_b64_tr_b16 v[212:213], v33 offset:4640
    ds_read_b64_tr_b16 v[214:215], v36 offset:5024
    buffer_load_dwordx4 v25, s[40:43], s29 offen offset:1024 sc1 lds
    v_mfma_f32_32x32x16_bf16 v[168:183], v[192:195], a[20:23], v[168:183]
    ds_read_b64_tr_b16 v[216:217], v33 offset:4672
    ds_read_b64_tr_b16 v[218:219], v36 offset:5056
    buffer_load_dwordx4 v25, s[40:43], s29 offen offset:2048 sc1 lds
    s_waitcnt lgkmcnt(6)
    v_mfma_f32_32x32x16_bf16 v[136:151], v[196:199], a[24:27], v[136:151]
    ds_read_b64_tr_b16 v[184:185], v33 offset:12288
    ds_read_b64_tr_b16 v[186:187], v36 offset:12672
    buffer_load_dwordx4 v25, s[40:43], s29 offen offset:3072 sc1 lds
    v_mfma_f32_32x32x16_bf16 v[152:167], v[200:203], a[24:27], v[152:167]
    ds_read_b64_tr_b16 v[188:189], v33 offset:12320
    ds_read_b64_tr_b16 v[190:191], v36 offset:12704
    s_add_u32 s28, s29, 4096
    s_add_u32 m0, s79, 4096
    s_nop 0
    buffer_load_dwordx4 v25, s[40:43], s28 offen sc1 lds
    v_mfma_f32_32x32x16_bf16 v[168:183], v[204:207], a[24:27], v[168:183]
    ds_read_b64_tr_b16 v[192:193], v33 offset:12352
    ds_read_b64_tr_b16 v[194:195], v36 offset:12736
    s_add_u32 s29, s80, 30720
    s_add_u32 m0, s79, 20480
    s_nop 0
    buffer_load_dwordx4 v25, s[40:43], s29 offen sc1 lds
    s_waitcnt lgkmcnt(6)
    v_mfma_f32_32x32x16_bf16 v[136:151], v[208:211], a[28:31], v[136:151]
    ds_read_b64_tr_b16 v[196:197], v33 offset:13824
    ds_read_b64_tr_b16 v[198:199], v36 offset:14208
    buffer_load_dwordx4 v25, s[40:43], s29 offen offset:1024 sc1 lds
    v_mfma_f32_32x32x16_bf16 v[152:167], v[212:215], a[28:31], v[152:167]
    ds_read_b64_tr_b16 v[200:201], v33 offset:13856
    ds_read_b64_tr_b16 v[202:203], v36 offset:14240
    buffer_load_dwordx4 v25, s[40:43], s29 offen offset:2048 sc1 lds
    v_mfma_f32_32x32x16_bf16 v[168:183], v[216:219], a[28:31], v[168:183]
    ds_read_b64_tr_b16 v[204:205], v33 offset:13888
    ds_read_b64_tr_b16 v[206:207], v36 offset:14272
    buffer_load_dwordx4 v25, s[40:43], s29 offen offset:3072 sc1 lds
    s_waitcnt lgkmcnt(6)
    v_mfma_f32_32x32x16_bf16 v[136:151], v[184:187], a[32:35], v[136:151]
    ds_read_b64_tr_b16 v[208:209], v33 offset:15360
    ds_read_b64_tr_b16 v[210:211], v36 offset:15744
    s_add_u32 s28, s29, 4096
    s_add_u32 m0, s79, 24576
    s_nop 0
    buffer_load_dwordx4 v25, s[40:43], s28 offen sc1 lds
    v_mfma_f32_32x32x16_bf16 v[152:167], v[188:191], a[32:35], v[152:167]
    ds_read_b64_tr_b16 v[212:213], v33 offset:15392
    ds_read_b64_tr_b16 v[214:215], v36 offset:15776
    s_add_u32 s18, s76, 172032
    s_add_u32 m0, s76, 61440
    s_nop 0
    buffer_load_dwordx4 v24, s[40:43], s18 offen sc1 lds
    v_mfma_f32_32x32x16_bf16 v[168:183], v[192:195], a[32:35], v[168:183]
    ds_read_b64_tr_b16 v[216:217], v33 offset:15424
    ds_read_b64_tr_b16 v[218:219], v36 offset:15808
    s_waitcnt vmcnt(21) lgkmcnt(6)
    s_barrier
    s_cmp_lg_u32 s14, 0
    s_cbranch_scc1 L_sig_46
    s_lshl_b32 s4, s12, 8
    s_add_u32 s4, s4, 20480
    v_mov_b32 v4, s4
    v_mov_b32 v5, 1
    s_mov_b64 exec, 1
    buffer_atomic_add v5, v4, s[40:43], 0 offen sc1
    s_mov_b64 exec, -1
L_sig_46:
    v_mfma_f32_32x32x16_bf16 v[136:151], v[196:199], a[36:39], v[136:151]
    ds_read_b64_tr_b16 v[184:185], v33 offset:16896
    ds_read_b64_tr_b16 v[186:187], v36 offset:17280
    v_mfma_f32_32x32x16_bf16 v[152:167], v[200:203], a[36:39], v[152:167]
    ds_read_b64_tr_b16 v[188:189], v33 offset:16928
    ds_read_b64_tr_b16 v[190:191], v36 offset:17312
    buffer_load_dwordx4 v24, s[40:43], s18 offen offset:1024 sc1 lds
    v_mfma_f32_32x32x16_bf16 v[168:183], v[204:207], a[36:39], v[168:183]
    ds_read_b64_tr_b16 v[192:193], v33 offset:16960
    ds_read_b64_tr_b16 v[194:195], v36 offset:17344
    s_waitcnt lgkmcnt(6)
    v_mfma_f32_32x32x16_bf16 v[136:151], v[208:211], a[40:43], v[136:151]
    ds_read_b64_tr_b16 v[196:197], v33 offset:24576
    ds_read_b64_tr_b16 v[198:199], v36 offset:24960
    v_mfma_f32_32x32x16_bf16 v[152:167], v[212:215], a[40:43], v[152:167]
    ds_read_b64_tr_b16 v[200:201], v33 offset:24608
    ds_read_b64_tr_b16 v[202:203], v36 offset:24992
    buffer_load_dwordx4 v24, s[40:43], s18 offen offset:2048 sc1 lds
    v_mfma_f32_32x32x16_bf16 v[168:183], v[216:219], a[40:43], v[168:183]
    ds_read_b64_tr_b16 v[204:205], v33 offset:24640
    ds_read_b64_tr_b16 v[206:207], v36 offset:25024
    s_waitcnt lgkmcnt(6)
    v_mfma_f32_32x32x16_bf16 v[136:151], v[184:187], a[44:47], v[136:151]
    ds_read_b64_tr_b16 v[208:209], v33 offset:26112
    ds_read_b64_tr_b16 v[210:211], v36 offset:26496
    v_mfma_f32_32x32x16_bf16 v[152:167], v[188:191], a[44:47], v[152:167]
    ds_read_b64_tr_b16 v[212:213], v33 offset:26144
    ds_read_b64_tr_b16 v[214:215], v36 offset:26528
    s_add_u32 s18, s76, 184320
    s_add_u32 m0, s76, 73728
    s_nop 0
    buffer_load_dwordx4 v24, s[40:43], s18 offen sc1 lds
    v_mfma_f32_32x32x16_bf16 v[168:183], v[192:195], a[44:47], v[168:183]
    ds_read_b64_tr_b16 v[216:217], v33 offset:26176
    ds_read_b64_tr_b16 v[218:219], v36 offset:26560
    s_waitcnt lgkmcnt(6)
    v_mfma_f32_32x32x16_bf16 v[136:151], v[196:199], a[48:51], v[136:151]
    ds_read_b64_tr_b16 v[184:185], v33 offset:27648
    ds_read_b64_tr_b16 v[186:187], v36 offset:28032
    v_mfma_f32_32x32x16_bf16 v[152:167], v[200:203], a[48:51], v[152:167]
    ds_read_b64_tr_b16 v[188:189], v33 offset:27680
    ds_read_b64_tr_b16 v[190:191], v36 offset:28064
    buffer_load_dwordx4 v24, s[40:43], s18 offen offset:1024 sc1 lds
    v_mfma_f32_32x32x16_bf16 v[168:183], v[204:207], a[48:51], v[168:183]
    ds_read_b64_tr_b16 v[192:193], v33 offset:27712
    ds_read_b64_tr_b16 v[194:195], v36 offset:28096
    s_waitcnt vmcnt(2) lgkmcnt(6)
    s_barrier
    v_mfma_f32_32x32x16_bf16 v[136:151], v[208:211], a[52:55], v[136:151]
    ds_read_b64_tr_b16 v[196:197], v33 offset:29184
    ds_read_b64_tr_b16 v[198:199], v36 offset:29568
    v_mfma_f32_32x32x16_bf16 v[152:167], v[212:215], a[52:55], v[152:167]
    ds_read_b64_tr_b16 v[200:201], v33 offset:29216
    ds_read_b64_tr_b16 v[202:203], v36 offset:29600
    buffer_load_dwordx4 v24, s[40:43], s18 offen offset:2048 sc1 lds
    v_mfma_f32_32x32x16_bf16 v[168:183], v[216:219], a[52:55], v[168:183]
    ds_read_b64_tr_b16 v[204:205], v33 offset:29248
    ds_read_b64_tr_b16 v[206:207], v36 offset:29632
    s_waitcnt lgkmcnt(6)
    v_mfma_f32_32x32x16_bf16 v[136:151], v[184:187], a[56:59], v[136:151]
    ds_read_b64_tr_b16 v[208:209], v32 offset:24576
    ds_read_b64_tr_b16 v[210:211], v35 offset:24960
    v_mfma_f32_32x32x16_bf16 v[152:167], v[188:191], a[56:59], v[152:167]
    ds_read_b64_tr_b16 v[212:213], v32 offset:24608
    ds_read_b64_tr_b16 v[214:215], v35 offset:24992
    s_add_u32 s18, s76, 196608
    s_add_u32 m0, s76, 86016
    s_nop 0
    buffer_load_dwordx4 v24, s[40:43], s18 offen sc1 lds
    v_mfma_f32_32x32x16_bf16 v[168:183], v[192:195], a[56:59], v[168:183]
    ds_read_b64_tr_b16 v[216:217], v32 offset:24640
    ds_read_b64_tr_b16 v[218:219], v35 offset:25024
    s_waitcnt lgkmcnt(6)
    v_mfma_f32_32x32x16_bf16 v[136:151], v[196:199], a[60:63], v[136:151]
    ds_read_b64_tr_b16 v[184:185], v32 offset:26112
    ds_read_b64_tr_b16 v[186:187], v35 offset:26496
    v_mfma_f32_32x32x16_bf16 v[152:167], v[200:203], a[60:63], v[152:167]
    ds_read_b64_tr_b16 v[188:189], v32 offset:26144
    ds_read_b64_tr_b16 v[190:191], v35 offset:26528
    buffer_load_dwordx4 v24, s[40:43], s18 offen offset:1024 sc1 lds
    v_mfma_f32_32x32x16_bf16 v[168:183], v[204:207], a[60:63], v[168:183]
    ds_read_b64_tr_b16 v[192:193], v32 offset:26176
    ds_read_b64_tr_b16 v[194:195], v35 offset:26560
    s_waitcnt lgkmcnt(6)
    v_mfma_f32_32x32x16_bf16 v[136:151], v[208:211], a[64:67], v[136:151]
    ds_read_b64_tr_b16 v[196:197], v32 offset:27648
    ds_read_b64_tr_b16 v[198:199], v35 offset:28032
    v_mfma_f32_32x32x16_bf16 v[152:167], v[212:215], a[64:67], v[152:167]
    ds_read_b64_tr_b16 v[200:201], v32 offset:27680
    ds_read_b64_tr_b16 v[202:203], v35 offset:28064
    buffer_load_dwordx4 v24, s[40:43], s18 offen offset:2048 sc1 lds
    v_mfma_f32_32x32x16_bf16 v[168:183], v[216:219], a[64:67], v[168:183]
    ds_read_b64_tr_b16 v[204:205], v32 offset:27712
    ds_read_b64_tr_b16 v[206:207], v35 offset:28096
    s_waitcnt vmcnt(3) lgkmcnt(6)
    s_barrier
    v_mfma_f32_32x32x16_bf16 v[136:151], v[184:187], a[68:71], v[136:151]
    ds_read_b64_tr_b16 v[208:209], v32 offset:29184
    ds_read_b64_tr_b16 v[210:211], v35 offset:29568
    v_mfma_f32_32x32x16_bf16 v[152:167], v[188:191], a[68:71], v[152:167]
    ds_read_b64_tr_b16 v[212:213], v32 offset:29216
    ds_read_b64_tr_b16 v[214:215], v35 offset:29600
    s_add_u32 s18, s76, 208896
    s_add_u32 m0, s76, 98304
    s_nop 0
    buffer_load_dwordx4 v24, s[40:43], s18 offen sc1 lds
    v_mfma_f32_32x32x16_bf16 v[168:183], v[192:195], a[68:71], v[168:183]
    ds_read_b64_tr_b16 v[216:217], v32 offset:29248
    ds_read_b64_tr_b16 v[218:219], v35 offset:29632
    s_waitcnt lgkmcnt(6)
    v_mfma_f32_32x32x16_bf16 v[136:151], v[196:199], a[72:75], v[136:151]
    ds_read_b64_tr_b16 v[184:185], v33 offset:0
    ds_read_b64_tr_b16 v[186:187], v36 offset:384
    v_mfma_f32_32x32x16_bf16 v[152:167], v[200:203], a[72:75], v[152:167]
    ds_read_b64_tr_b16 v[188:189], v33 offset:32
    ds_read_b64_tr_b16 v[190:191], v36 offset:416
    buffer_load_dwordx4 v24, s[40:43], s18 offen offset:1024 sc1 lds
    v_mfma_f32_32x32x16_bf16 v[168:183], v[204:207], a[72:75], v[168:183]
    ds_read_b64_tr_b16 v[192:193], v33 offset:64
    ds_read_b64_tr_b16 v[194:195], v36 offset:448
    s_waitcnt lgkmcnt(6)
    v_mfma_f32_32x32x16_bf16 v[136:151], v[208:211], a[76:79], v[136:151]
    ds_read_b64_tr_b16 v[196:197], v33 offset:1536
    ds_read_b64_tr_b16 v[198:199], v36 offset:1920
    v_mfma_f32_32x32x16_bf16 v[152:167], v[212:215], a[76:79], v[152:167]
    ds_read_b64_tr_b16 v[200:201], v33 offset:1568
    ds_read_b64_tr_b16 v[202:203], v36 offset:1952
    buffer_load_dwordx4 v24, s[40:43], s18 offen offset:2048 sc1 lds
    v_mfma_f32_32x32x16_bf16 v[168:183], v[216:219], a[76:79], v[168:183]
    ds_read_b64_tr_b16 v[204:205], v33 offset:1600
    ds_read_b64_tr_b16 v[206:207], v36 offset:1984
    s_waitcnt lgkmcnt(6)
    v_mfma_f32_32x32x16_bf16 v[136:151], v[184:187], a[80:83], v[136:151]
    ds_read_b64_tr_b16 v[208:209], v33 offset:3072
    ds_read_b64_tr_b16 v[210:211], v36 offset:3456
    v_mfma_f32_32x32x16_bf16 v[152:167], v[188:191], a[80:83], v[152:167]
    ds_read_b64_tr_b16 v[212:213], v33 offset:3104
    ds_read_b64_tr_b16 v[214:215], v36 offset:3488
    v_mfma_f32_32x32x16_bf16 v[168:183], v[192:195], a[80:83], v[168:183]
    ds_read_b64_tr_b16 v[216:217], v33 offset:3136
    ds_read_b64_tr_b16 v[218:219], v36 offset:3520
    s_waitcnt vmcnt(3) lgkmcnt(6)
    s_barrier
    v_mfma_f32_32x32x16_bf16 v[136:151], v[196:199], a[84:87], v[136:151]
    ds_read_b64_tr_b16 v[184:185], v33 offset:4608
    ds_read_b64_tr_b16 v[186:187], v36 offset:4992
    v_mfma_f32_32x32x16_bf16 v[152:167], v[200:203], a[84:87], v[152:167]
    ds_read_b64_tr_b16 v[188:189], v33 offset:4640
    ds_read_b64_tr_b16 v[190:191], v36 offset:5024
    s_add_u32 s18, s76, 221184
    s_add_u32 m0, s76, 61440
    s_nop 0
    buffer_load_dwordx4 v24, s[40:43], s18 offen sc1 lds
    v_mfma_f32_32x32x16_bf16 v[168:183], v[204:207], a[84:87], v[168:183]
    ds_read_b64_tr_b16 v[192:193], v33 offset:4672
    ds_read_b64_tr_b16 v[194:195], v36 offset:5056
    s_waitcnt lgkmcnt(6)
    v_mfma_f32_32x32x16_bf16 v[136:151], v[208:211], a[88:91], v[136:151]
    ds_read_b64_tr_b16 v[196:197], v33 offset:12288
    ds_read_b64_tr_b16 v[198:199], v36 offset:12672
    v_mfma_f32_32x32x16_bf16 v[152:167], v[212:215], a[88:91], v[152:167]
    ds_read_b64_tr_b16 v[200:201], v33 offset:12320
    ds_read_b64_tr_b16 v[202:203], v36 offset:12704
    buffer_load_dwordx4 v24, s[40:43], s18 offen offset:1024 sc1 lds
    v_mfma_f32_32x32x16_bf16 v[168:183], v[216:219], a[88:91], v[168:183]
    ds_read_b64_tr_b16 v[204:205], v33 offset:12352
    ds_read_b64_tr_b16 v[206:207], v36 offset:12736
    s_waitcnt lgkmcnt(6)
    v_mfma_f32_32x32x16_bf16 v[136:151], v[184:187], a[92:95], v[136:151]
    ds_read_b64_tr_b16 v[208:209], v33 offset:13824
    ds_read_b64_tr_b16 v[210:211], v36 offset:14208
    v_mfma_f32_32x32x16_bf16 v[152:167], v[188:191], a[92:95], v[152:167]
    ds_read_b64_tr_b16 v[212:213], v33 offset:13856
    ds_read_b64_tr_b16 v[214:215], v36 offset:14240
    buffer_load_dwordx4 v24, s[40:43], s18 offen offset:2048 sc1 lds
    v_mfma_f32_32x32x16_bf16 v[168:183], v[192:195], a[92:95], v[168:183]
    ds_read_b64_tr_b16 v[216:217], v33 offset:13888
    ds_read_b64_tr_b16 v[218:219], v36 offset:14272
    s_waitcnt lgkmcnt(6)
    v_mfma_f32_32x32x16_bf16 v[136:151], v[196:199], a[96:99], v[136:151]
    ds_read_b64_tr_b16 v[184:185], v33 offset:15360
    ds_read_b64_tr_b16 v[186:187], v36 offset:15744
    v_mfma_f32_32x32x16_bf16 v[152:167], v[200:203], a[96:99], v[152:167]
    ds_read_b64_tr_b16 v[188:189], v33 offset:15392
    ds_read_b64_tr_b16 v[190:191], v36 offset:15776
    v_mfma_f32_32x32x16_bf16 v[168:183], v[204:207], a[96:99], v[168:183]
    ds_read_b64_tr_b16 v[192:193], v33 offset:15424
    ds_read_b64_tr_b16 v[194:195], v36 offset:15808
    s_lshl_b32 s4, s12, 8
    s_add_u32 s4, s4, 20480
    v_mov_b32 v227, s4
    buffer_load_dword v226, v227, s[40:43], 0 offen sc1
    s_waitcnt vmcnt(4) lgkmcnt(6)
    s_barrier
    v_mfma_f32_32x32x16_bf16 v[136:151], v[208:211], a[100:103], v[136:151]
    ds_read_b64_tr_b16 v[196:197], v33 offset:16896
    ds_read_b64_tr_b16 v[198:199], v36 offset:17280
    v_mfma_f32_32x32x16_bf16 v[152:167], v[212:215], a[100:103], v[152:167]
    ds_read_b64_tr_b16 v[200:201], v33 offset:16928
    ds_read_b64_tr_b16 v[202:203], v36 offset:17312
    s_add_u32 s18, s76, 233472
    s_add_u32 m0, s76, 73728
    s_nop 0
    buffer_load_dwordx4 v24, s[40:43], s18 offen sc1 lds
    v_mfma_f32_32x32x16_bf16 v[168:183], v[216:219], a[100:103], v[168:183]
    ds_read_b64_tr_b16 v[204:205], v33 offset:16960
    ds_read_b64_tr_b16 v[206:207], v36 offset:17344
    s_waitcnt lgkmcnt(6)
    v_mfma_f32_32x32x16_bf16 v[136:151], v[184:187], a[104:107], v[136:151]
    ds_read_b64_tr_b16 v[208:209], v33 offset:24576
    ds_read_b64_tr_b16 v[210:211], v36 offset:24960
    v_mfma_f32_32x32x16_bf16 v[152:167], v[188:191], a[104:107], v[152:167]
    ds_read_b64_tr_b16 v[212:213], v33 offset:24608
    ds_read_b64_tr_b16 v[214:215], v36 offset:24992
    buffer_load_dwordx4 v24, s[40:43], s18 offen offset:1024 sc1 lds
    v_mfma_f32_32x32x16_bf16 v[168:183], v[192:195], a[104:107], v[168:183]
    ds_read_b64_tr_b16 v[216:217], v33 offset:24640
    ds_read_b64_tr_b16 v[218:219], v36 offset:25024
    s_waitcnt lgkmcnt(6)
    v_mfma_f32_32x32x16_bf16 v[136:151], v[196:199], a[108:111], v[136:151]
    ds_read_b64_tr_b16 v[184:185], v33 offset:26112
    ds_read_b64_tr_b16 v[186:187], v36 offset:26496
    v_mfma_f32_32x32x16_bf16 v[152:167], v[200:203], a[108:111], v[152:167]
    ds_read_b64_tr_b16 v[188:189], v33 offset:26144
    ds_read_b64_tr_b16 v[190:191], v36 offset:26528
    buffer_load_dwordx4 v24, s[40:43], s18 offen offset:2048 sc1 lds
    v_mfma_f32_32x32x16_bf16 v[168:183], v[204:207], a[108:111], v[168:183]
    ds_read_b64_tr_b16 v[192:193], v33 offset:26176
    ds_read_b64_tr_b16 v[194:195], v36 offset:26560
    s_waitcnt lgkmcnt(6)
    v_mfma_f32_32x32x16_bf16 v[136:151], v[208:211], a[112:115], v[136:151]
    ds_read_b64_tr_b16 v[196:197], v33 offset:27648
    ds_read_b64_tr_b16 v[198:199], v36 offset:28032
    v_mfma_f32_32x32x16_bf16 v[152:167], v[212:215], a[112:115], v[152:167]
    ds_read_b64_tr_b16 v[200:201], v33 offset:27680
    ds_read_b64_tr_b16 v[202:203], v36 offset:28064
    v_mfma_f32_32x32x16_bf16 v[168:183], v[216:219], a[112:115], v[168:183]
    ds_read_b64_tr_b16 v[204:205], v33 offset:27712
    ds_read_b64_tr_b16 v[206:207], v36 offset:28096
    s_waitcnt vmcnt(4) lgkmcnt(6)
    s_barrier
    v_mfma_f32_32x32x16_bf16 v[136:151], v[184:187], a[116:119], v[136:151]
    ds_read_b64_tr_b16 v[208:209], v33 offset:29184
    ds_read_b64_tr_b16 v[210:211], v36 offset:29568
    v_mfma_f32_32x32x16_bf16 v[152:167], v[188:191], a[116:119], v[152:167]
    ds_read_b64_tr_b16 v[212:213], v33 offset:29216
    ds_read_b64_tr_b16 v[214:215], v36 offset:29600
    v_mfma_f32_32x32x16_bf16 v[168:183], v[192:195], a[116:119], v[168:183]
    ds_read_b64_tr_b16 v[216:217], v33 offset:29248
    ds_read_b64_tr_b16 v[218:219], v36 offset:29632
    s_waitcnt vmcnt(3)
    s_mov_b32 s19, 0
L_c4_47:
    v_readfirstlane_b32 s4, v226
    s_add_u32 s19, s19, 1
    s_cmp_ge_u32 s4, 16
    s_cbranch_scc1 L_c4d_48
    buffer_load_dword v226, v227, s[40:43], 0 offen sc1
    s_waitcnt vmcnt(0)
    s_cmp_lt_u32 s19, 200000
    s_cbranch_scc1 L_c4_47
L_c4d_48:
    s_waitcnt lgkmcnt(6)
    v_mfma_f32_32x32x16_bf16 v[136:151], v[196:199], a[120:123], v[136:151]
    ds_read_b64_tr_b16 v[184:185], v32 offset:24576
    ds_read_b64_tr_b16 v[186:187], v35 offset:24960
    s_mov_b32 s17, 0
    buffer_load_dwordx4 a[160:163], v26, s[40:43], s17 offen sc1
    v_mfma_f32_32x32x16_bf16 v[152:167], v[200:203], a[120:123], v[152:167]
    ds_read_b64_tr_b16 v[188:189], v32 offset:24608
    ds_read_b64_tr_b16 v[190:191], v35 offset:24992
    buffer_load_dwordx4 a[164:167], v27, s[40:43], s17 offen sc1
    v_mfma_f32_32x32x16_bf16 v[168:183], v[204:207], a[120:123], v[168:183]
    ds_read_b64_tr_b16 v[192:193], v32 offset:24640
    ds_read_b64_tr_b16 v[194:195], v35 offset:25024
    s_mov_b32 s17, 1024
    buffer_load_dwordx4 a[168:171], v26, s[40:43], s17 offen sc1
    s_waitcnt lgkmcnt(6)
    v_mfma_f32_32x32x16_bf16 v[136:151], v[208:211], a[124:127], v[136:151]
    ds_read_b64_tr_b16 v[196:197], v32 offset:26112
    ds_read_b64_tr_b16 v[198:199], v35 offset:26496
    buffer_load_dwordx4 a[172:175], v27, s[40:43], s17 offen sc1
    v_mfma_f32_32x32x16_bf16 v[152:167], v[212:215], a[124:127], v[152:167]
    ds_read_b64_tr_b16 v[200:201], v32 offset:26144
    ds_read_b64_tr_b16 v[202:203], v35 offset:26528
    s_mov_b32 s17, 2048
    buffer_load_dwordx4 a[176:179], v26, s[40:43], s17 offen sc1
    v_mfma_f32_32x32x16_bf16 v[168:183], v[216:219], a[124:127], v[168:183]
    ds_read_b64_tr_b16 v[204:205], v32 offset:26176
    ds_read_b64_tr_b16 v[206:207], v35 offset:26560
    buffer_load_dwordx4 a[180:183], v27, s[40:43], s17 offen sc1
    s_waitcnt lgkmcnt(6)
    v_mfma_f32_32x32x16_bf16 v[136:151], v[184:187], a[128:131], v[136:151]
    ds_read_b64_tr_b16 v[208:209], v32 offset:27648
    ds_read_b64_tr_b16 v[210:211], v35 offset:28032
    s_mov_b32 s17, 3072
    buffer_load_dwordx4 a[184:187], v26, s[40:43], s17 offen sc1
    v_mfma_f32_32x32x16_bf16 v[152:167], v[188:191], a[128:131], v[152:167]
    ds_read_b64_tr_b16 v[212:213], v32 offset:27680
    ds_read_b64_tr_b16 v[214:215], v35 offset:28064
    buffer_load_dwordx4 a[188:191], v27, s[40:43], s17 offen sc1
    v_mfma_f32_32x32x16_bf16 v[168:183], v[192:195], a[128:131], v[168:183]
    ds_read_b64_tr_b16 v[216:217], v32 offset:27712
    ds_read_b64_tr_b16 v[218:219], v35 offset:28096
    s_mov_b32 s17, 4096
    buffer_load_dwordx4 a[192:195], v26, s[40:43], s17 offen sc1
    s_waitcnt vmcnt(9) lgkmcnt(6)
    s_barrier
    v_mfma_f32_32x32x16_bf16 v[136:151], v[196:199], a[132:135], v[136:151]
    ds_read_b64_tr_b16 v[184:185], v32 offset:29184
    ds_read_b64_tr_b16 v[186:187], v35 offset:29568
    buffer_load_dwordx4 a[196:199], v27, s[40:43], s17 offen sc1
    v_mfma_f32_32x32x16_bf16 v[152:167], v[200:203], a[132:135], v[152:167]
    ds_read_b64_tr_b16 v[188:189], v32 offset:29216
    ds_read_b64_tr_b16 v[190:191], v35 offset:29600
    s_mov_b32 s17, 5120
    buffer_load_dwordx4 a[200:203], v26, s[40:43], s17 offen sc1
    v_mfma_f32_32x32x16_bf16 v[168:183], v[204:207], a[132:135], v[168:183]
    ds_read_b64_tr_b16 v[192:193], v32 offset:29248
    ds_read_b64_tr_b16 v[194:195], v35 offset:29632
    buffer_load_dwordx4 a[204:207], v27, s[40:43], s17 offen sc1
    s_waitcnt lgkmcnt(6)
    v_mfma_f32_32x32x16_bf16 v[136:151], v[208:211], a[136:139], v[136:151]
    ds_read_b64_tr_b16 v[196:197], v33 offset:0
    ds_read_b64_tr_b16 v[198:199], v36 offset:384
    s_mov_b32 s17, 6144
    buffer_load_dwordx4 a[208:211], v26, s[40:43], s17 offen sc1
    v_mfma_f32_32x32x16_bf16 v[152:167], v[212:215], a[136:139], v[152:167]
    ds_read_b64_tr_b16 v[200:201], v33 offset:32
    ds_read_b64_tr_b16 v[202:203], v36 offset:416
    buffer_load_dwordx4 a[212:215], v27, s[40:43], s17 offen sc1
    v_mfma_f32_32x32x16_bf16 v[168:183], v[216:219], a[136:139], v[168:183]
    ds_read_b64_tr_b16 v[204:205], v33 offset:64
    ds_read_b64_tr_b16 v[206:207], v36 offset:448
    s_mov_b32 s17, 7168
    buffer_load_dwordx4 a[216:219], v26, s[40:43], s17 offen sc1
    s_waitcnt lgkmcnt(6)
    v_mfma_f32_32x32x16_bf16 v[136:151], v[184:187], a[140:143], v[136:151]
    ds_read_b64_tr_b16 v[208:209], v33 offset:1536
    ds_read_b64_tr_b16 v[210:211], v36 offset:1920
    buffer_load_dwordx4 a[220:223], v27, s[40:43], s17 offen sc1
    v_mfma_f32_32x32x16_bf16 v[152:167], v[188:191], a[140:143], v[152:167]
    ds_read_b64_tr_b16 v[212:213], v33 offset:1568
    ds_read_b64_tr_b16 v[214:215], v36 offset:1952
    s_mov_b32 s17, 8192
    buffer_load_dwordx4 a[224:227], v26, s[40:43], s17 offen sc1
    v_mfma_f32_32x32x16_bf16 v[168:183], v[192:195], a[140:143], v[168:183]
    ds_read_b64_tr_b16 v[216:217], v33 offset:1600
    ds_read_b64_tr_b16 v[218:219], v36 offset:1984
    buffer_load_dwordx4 a[228:231], v27, s[40:43], s17 offen sc1
    s_waitcnt lgkmcnt(6)
    v_mfma_f32_32x32x16_bf16 v[136:151], v[196:199], a[144:147], v[136:151]
    ds_read_b64_tr_b16 v[184:185], v33 offset:3072
    ds_read_b64_tr_b16 v[186:187], v36 offset:3456
    s_mov_b32 s17, 9216
    buffer_load_dwordx4 a[232:235], v26, s[40:43], s17 offen sc1
    v_mfma_f32_32x32x16_bf16 v[152:167], v[200:203], a[144:147], v[152:167]
    ds_read_b64_tr_b16 v[188:189], v33 offset:3104
    ds_read_b64_tr_b16 v[190:191], v36 offset:3488
    buffer_load_dwordx4 a[236:239], v27, s[40:43], s17 offen sc1
    v_mfma_f32_32x32x16_bf16 v[168:183], v[204:207], a[144:147], v[168:183]
    ds_read_b64_tr_b16 v[192:193], v33 offset:3136
    ds_read_b64_tr_b16 v[194:195], v36 offset:3520
    s_mov_b32 s17, 10240
    buffer_load_dwordx4 a[240:243], v26, s[40:43], s17 offen sc1
    s_waitcnt lgkmcnt(6)
    v_mfma_f32_32x32x16_bf16 v[136:151], v[208:211], a[148:151], v[136:151]
    ds_read_b64_tr_b16 v[196:197], v33 offset:4608
    ds_read_b64_tr_b16 v[198:199], v36 offset:4992
    buffer_load_dwordx4 a[244:247], v27, s[40:43], s17 offen sc1
    v_mfma_f32_32x32x16_bf16 v[152:167], v[212:215], a[148:151], v[152:167]
    ds_read_b64_tr_b16 v[200:201], v33 offset:4640
    ds_read_b64_tr_b16 v[202:203], v36 offset:5024
    s_mov_b32 s17, 11264
    buffer_load_dwordx4 a[248:251], v26, s[40:43], s17 offen sc1
    v_mfma_f32_32x32x16_bf16 v[168:183], v[216:219], a[148:151], v[168:183]
    ds_read_b64_tr_b16 v[204:205], v33 offset:4672
    ds_read_b64_tr_b16 v[206:207], v36 offset:5056
    buffer_load_dwordx4 a[252:255], v27, s[40:43], s17 offen sc1
    s_waitcnt lgkmcnt(6)
    v_mfma_f32_32x32x16_bf16 v[136:151], v[184:187], a[152:155], v[136:151]
    v_mfma_f32_32x32x16_bf16 v[152:167], v[188:191], a[152:155], v[152:167]
    v_mfma_f32_32x32x16_bf16 v[168:183], v[192:195], a[152:155], v[168:183]
    s_waitcnt lgkmcnt(0)
    v_mfma_f32_32x32x16_bf16 v[136:151], v[196:199], a[156:159], v[136:151]
    v_mfma_f32_32x32x16_bf16 v[152:167], v[200:203], a[156:159], v[152:167]
    v_mfma_f32_32x32x16_bf16 v[168:183], v[204:207], a[156:159], v[168:183]
    ds_read_b128 v[40:43], v220 offset:192
    ds_read_b128 v[48:51], v220 offset:704
    ds_read_b128 v[44:47], v220 offset:224
    ds_read_b128 v[52:55], v220 offset:736
    ds_read_b128 v[56:59], v220 offset:256
    ds_read_b128 v[64:67], v220 offset:768
    ds_read_b128 v[60:63], v220 offset:288
    ds_read_b128 v[68:71], v220 offset:800
    s_waitcnt lgkmcnt(4)
    s_nop 0
    v_pk_fma_f32 v[136:137], v[40:41], v[80:81], v[136:137] op_sel_hi:[1,0,1]
    v_pk_fma_f32 v[138:139], v[42:43], v[80:81], v[138:139] op_sel_hi:[1,0,1]
    v_pk_fma_f32 v[140:141], v[44:45], v[80:81], v[140:141] op_sel_hi:[1,0,1]
    v_pk_fma_f32 v[142:143], v[46:47], v[80:81], v[142:143] op_sel_hi:[1,0,1]
    v_pk_fma_f32 v[144:145], v[48:49], v[80:81], v[144:145] op_sel_hi:[1,0,1]
    v_pk_fma_f32 v[146:147], v[50:51], v[80:81], v[146:147] op_sel_hi:[1,0,1]
    v_pk_fma_f32 v[148:149], v[52:53], v[80:81], v[148:149] op_sel_hi:[1,0,1]
    v_pk_fma_f32 v[150:151], v[54:55], v[80:81], v[150:151] op_sel_hi:[1,0,1]
    v_max_f32 v136, 0, v136
    v_max_f32 v137, 0, v137
    v_max_f32 v138, 0, v138
    v_max_f32 v139, 0, v139
    v_max_f32 v140, 0, v140
    v_max_f32 v141, 0, v141
    v_max_f32 v142, 0, v142
    v_max_f32 v143, 0, v143
    v_pk_mul_f32 v[144:145], v[144:145], v[82:83] op_sel_hi:[1,0]
    v_pk_mul_f32 v[146:147], v[146:147], v[82:83] op_sel_hi:[1,0]
    v_pk_mul_f32 v[148:149], v[148:149], v[82:83] op_sel_hi:[1,0]
    v_pk_mul_f32 v[150:151], v[150:151], v[82:83] op_sel_hi:[1,0]
    v_pk_mul_f32 v[136:137], v[136:137], v[144:145]
    v_pk_mul_f32 v[138:139], v[138:139], v[146:147]
    v_pk_mul_f32 v[140:141], v[140:141], v[148:149]
    v_pk_mul_f32 v[142:143], v[142:143], v[150:151]
    v_cvt_pk_bf16_f32 v144, v136, v137
    v_cvt_pk_bf16_f32 v145, v138, v139
    v_cvt_pk_bf16_f32 v146, v140, v141
    v_cvt_pk_bf16_f32 v147, v142, v143
    s_lshl_b32 s4, s81, 10
    s_add_u32 s5, s4, 24576
    buffer_store_dwordx4 v[144:147], v221, s[40:43], s5 offen sc1
    ds_read_b128 v[40:43], v220 offset:320
    ds_read_b128 v[48:51], v220 offset:832
    ds_read_b128 v[44:47], v220 offset:352
    ds_read_b128 v[52:55], v220 offset:864
    s_waitcnt lgkmcnt(4)
    v_pk_fma_f32 v[152:153], v[56:57], v[80:81], v[152:153] op_sel_hi:[1,0,1]
    v_pk_fma_f32 v[154:155], v[58:59], v[80:81], v[154:155] op_sel_hi:[1,0,1]
    v_pk_fma_f32 v[156:157], v[60:61], v[80:81], v[156:157] op_sel_hi:[1,0,1]
    v_pk_fma_f32 v[158:159], v[62:63], v[80:81], v[158:159] op_sel_hi:[1,0,1]
    v_pk_fma_f32 v[160:161], v[64:65], v[80:81], v[160:161] op_sel_hi:[1,0,1]
    v_pk_fma_f32 v[162:163], v[66:67], v[80:81], v[162:163] op_sel_hi:[1,0,1]
    v_pk_fma_f32 v[164:165], v[68:69], v[80:81], v[164:165] op_sel_hi:[1,0,1]
    v_pk_fma_f32 v[166:167], v[70:71], v[80:81], v[166:167] op_sel_hi:[1,0,1]
    v_max_f32 v152, 0, v152
    v_max_f32 v153, 0, v153
    v_max_f32 v154, 0, v154
    v_max_f32 v155, 0, v155
    v_max_f32 v156, 0, v156
    v_max_f32 v157, 0, v157
    v_max_f32 v158, 0, v158
    v_max_f32 v159, 0, v159
    v_pk_mul_f32 v[160:161], v[160:161], v[82:83] op_sel_hi:[1,0]
    v_pk_mul_f32 v[162:163], v[162:163], v[82:83] op_sel_hi:[1,0]
    v_pk_mul_f32 v[164:165], v[164:165], v[82:83] op_sel_hi:[1,0]
    v_pk_mul_f32 v[166:167], v[166:167], v[82:83] op_sel_hi:[1,0]
    v_pk_mul_f32 v[152:153], v[152:153], v[160:161]
    v_pk_mul_f32 v[154:155], v[154:155], v[162:163]
    v_pk_mul_f32 v[156:157], v[156:157], v[164:165]
    v_pk_mul_f32 v[158:159], v[158:159], v[166:167]
    v_cvt_pk_bf16_f32 v160, v152, v153
    v_cvt_pk_bf16_f32 v161, v154, v155
    v_cvt_pk_bf16_f32 v162, v156, v157
    v_cvt_pk_bf16_f32 v163, v158, v159
    s_lshl_b32 s4, s81, 10
    s_add_u32 s5, s4, 25088
    buffer_store_dwordx4 v[160:163], v221, s[40:43], s5 offen sc1
    s_waitcnt lgkmcnt(0)
    v_pk_fma_f32 v[168:169], v[40:41], v[80:81], v[168:169] op_sel_hi:[1,0,1]
    v_pk_fma_f32 v[170:171], v[42:43], v[80:81], v[170:171] op_sel_hi:[1,0,1]
    v_pk_fma_f32 v[172:173], v[44:45], v[80:81], v[172:173] op_sel_hi:[1,0,1]
    v_pk_fma_f32 v[174:175], v[46:47], v[80:81], v[174:175] op_sel_hi:[1,0,1]
    v_pk_fma_f32 v[176:177], v[48:49], v[80:81], v[176:177] op_sel_hi:[1,0,1]
    v_pk_fma_f32 v[178:179], v[50:51], v[80:81], v[178:179] op_sel_hi:[1,0,1]
    v_pk_fma_f32 v[180:181], v[52:53], v[80:81], v[180:181] op_sel_hi:[1,0,1]
    v_pk_fma_f32 v[182:183], v[54:55], v[80:81], v[182:183] op_sel_hi:[1,0,1]
    v_max_f32 v168, 0, v168
    v_max_f32 v169, 0, v169
    v_max_f32 v170, 0, v170
    v_max_f32 v171, 0, v171
    v_max_f32 v172, 0, v172
    v_max_f32 v173, 0, v173
    v_max_f32 v174, 0, v174
    v_max_f32 v175, 0, v175
    v_pk_mul_f32 v[176:177], v[176:177], v[82:83] op_sel_hi:[1,0]
    v_pk_mul_f32 v[178:179], v[178:179], v[82:83] op_sel_hi:[1,0]
    v_pk_mul_f32 v[180:181], v[180:181], v[82:83] op_sel_hi:[1,0]
    v_pk_mul_f32 v[182:183], v[182:183], v[82:83] op_sel_hi:[1,0]
    v_pk_mul_f32 v[168:169], v[168:169], v[176:177]
    v_pk_mul_f32 v[170:171], v[170:171], v[178:179]
    v_pk_mul_f32 v[172:173], v[172:173], v[180:181]
    v_pk_mul_f32 v[174:175], v[174:175], v[182:183]
    v_cvt_pk_bf16_f32 v176, v168, v169
    v_cvt_pk_bf16_f32 v177, v170, v171
    v_cvt_pk_bf16_f32 v178, v172, v173
    v_cvt_pk_bf16_f32 v179, v174, v175
    s_lshl_b32 s4, s81, 9
    s_add_u32 s5, s4, 26624
    buffer_store_dwordx4 v[176:179], v221, s[40:43], s5 offen sc1
    s_barrier
    v_mov_b32 v88, 0
    v_mov_b32 v89, 0
    v_mov_b32 v90, 0
    v_mov_b32 v91, 0
    v_mov_b32 v92, 0
    v_mov_b32 v93, 0
    v_mov_b32 v94, 0
    v_mov_b32 v95, 0
    v_mov_b32 v96, 0
    v_mov_b32 v97, 0
    v_mov_b32 v98, 0
    v_mov_b32 v99, 0
    v_mov_b32 v100, 0
    v_mov_b32 v101, 0
    v_mov_b32 v102, 0
    v_mov_b32 v103, 0
    v_mov_b32 v104, 0
    v_mov_b32 v105, 0
    v_mov_b32 v106, 0
    v_mov_b32 v107, 0
    v_mov_b32 v108, 0
    v_mov_b32 v109, 0
    v_mov_b32 v110, 0
    v_mov_b32 v111, 0
    v_mov_b32 v112, 0
    v_mov_b32 v113, 0
    v_mov_b32 v114, 0
    v_mov_b32 v115, 0
    v_mov_b32 v116, 0
    v_mov_b32 v117, 0
    v_mov_b32 v118, 0
    v_mov_b32 v119, 0
    v_mov_b32 v120, 0
    v_mov_b32 v121, 0
    v_mov_b32 v122, 0
    v_mov_b32 v123, 0
    v_mov_b32 v124, 0
    v_mov_b32 v125, 0
    v_mov_b32 v126, 0
    v_mov_b32 v127, 0
    s_barrier
    ds_read_b64_tr_b16 v[128:129], v30 offset:0
    ds_read_b64_tr_b16 v[130:131], v30 offset:1280
    ds_read_b64_tr_b16 v[132:133], v30 offset:32
    ds_read_b64_tr_b16 v[134:135], v30 offset:1312
    ds_read_b64_tr_b16 v[136:137], v30 offset:64
    ds_read_b64_tr_b16 v[138:139], v30 offset:1344
    ds_read_b64_tr_b16 v[140:141], v30 offset:96
    ds_read_b64_tr_b16 v[142:143], v30 offset:1376
    ds_read_b64_tr_b16 v[144:145], v30 offset:128
    ds_read_b64_tr_b16 v[146:147], v30 offset:1408
    ds_read_b64_tr_b16 v[148:149], v30 offset:5120
    ds_read_b64_tr_b16 v[150:151], v30 offset:6400
    ds_read_b64_tr_b16 v[152:153], v30 offset:5152
    ds_read_b64_tr_b16 v[154:155], v30 offset:6432
    ds_read_b64_tr_b16 v[156:157], v30 offset:5184
    ds_read_b64_tr_b16 v[158:159], v30 offset:6464
    ds_read_b64_tr_b16 v[160:161], v30 offset:5216
    ds_read_b64_tr_b16 v[162:163], v30 offset:6496
    ds_read_b64_tr_b16 v[164:165], v30 offset:5248
    ds_read_b64_tr_b16 v[166:167], v30 offset:6528
    s_waitcnt vmcnt(25) lgkmcnt(10)
    s_barrier
    v_mfma_f32_16x16x32_bf16 v[88:91], v[128:131], a[160:163], v[88:91]
    ds_read_b64_tr_b16 v[40:41], v30 offset:20480
    v_mfma_f32_16x16x32_bf16 v[108:111], v[128:131], a[164:167], v[108:111]
    ds_read_b64_tr_b16 v[42:43], v30 offset:21760
    v_mfma_f32_16x16x32_bf16 v[92:95], v[132:135], a[160:163], v[92:95]
    ds_read_b64_tr_b16 v[44:45], v30 offset:20512
    v_mfma_f32_16x16x32_bf16 v[112:115], v[132:135], a[164:167], v[112:115]
    ds_read_b64_tr_b16 v[46:47], v30 offset:21792
    v_mfma_f32_16x16x32_bf16 v[96:99], v[136:139], a[160:163], v[96:99]
    ds_read_b64_tr_b16 v[48:49], v30 offset:20544
    v_mfma_f32_16x16x32_bf16 v[116:119], v[136:139], a[164:167], v[116:119]
    ds_read_b64_tr_b16 v[50:51], v30 offset:21824
    s_add_u32 s29, s80, 40960
    s_add_u32 m0, s79, 40960
    s_nop 0
    buffer_load_dwordx4 v25, s[40:43], s29 offen sc1 lds
    v_mfma_f32_16x16x32_bf16 v[100:103], v[140:143], a[160:163], v[100:103]
    ds_read_b64_tr_b16 v[52:53], v30 offset:20576
    v_mfma_f32_16x16x32_bf16 v[120:123], v[140:143], a[164:167], v[120:123]
    ds_read_b64_tr_b16 v[54:55], v30 offset:21856
    buffer_load_dwordx4 v25, s[40:43], s29 offen offset:1024 sc1 lds
    v_mfma_f32_16x16x32_bf16 v[104:107], v[144:147], a[160:163], v[104:107]
    ds_read_b64_tr_b16 v[56:57], v30 offset:20608
    v_mfma_f32_16x16x32_bf16 v[124:127], v[144:147], a[164:167], v[124:127]
    ds_read_b64_tr_b16 v[58:59], v30 offset:21888
    buffer_load_dwordx4 v25, s[40:43], s29 offen offset:2048 sc1 lds
    s_waitcnt vmcnt(26) lgkmcnt(10)
    v_mfma_f32_16x16x32_bf16 v[88:91], v[148:151], a[168:171], v[88:91]
    ds_read_b64_tr_b16 v[128:129], v30 offset:25600
    v_mfma_f32_16x16x32_bf16 v[108:111], v[148:151], a[172:175], v[108:111]
    ds_read_b64_tr_b16 v[130:131], v30 offset:26880
    v_mfma_f32_16x16x32_bf16 v[92:95], v[152:155], a[168:171], v[92:95]
    ds_read_b64_tr_b16 v[132:133], v30 offset:25632
    v_mfma_f32_16x16x32_bf16 v[112:115], v[152:155], a[172:175], v[112:115]
    ds_read_b64_tr_b16 v[134:135], v30 offset:26912
    v_mfma_f32_16x16x32_bf16 v[96:99], v[156:159], a[168:171], v[96:99]
    ds_read_b64_tr_b16 v[136:137], v30 offset:25664
    v_mfma_f32_16x16x32_bf16 v[116:119], v[156:159], a[172:175], v[116:119]
    ds_read_b64_tr_b16 v[138:139], v30 offset:26944
    buffer_load_dwordx4 v25, s[40:43], s29 offen offset:3072 sc1 lds
    v_mfma_f32_16x16x32_bf16 v[100:103], v[160:163], a[168:171], v[100:103]
    ds_read_b64_tr_b16 v[140:141], v30 offset:25696
    v_mfma_f32_16x16x32_bf16 v[120:123], v[160:163], a[172:175], v[120:123]
    ds_read_b64_tr_b16 v[142:143], v30 offset:26976
    s_add_u32 s28, s29, 4096
    s_add_u32 m0, s79, 45056
    s_nop 0
    buffer_load_dwordx4 v25, s[40:43], s28 offen sc1 lds
    v_mfma_f32_16x16x32_bf16 v[104:107], v[164:167], a[168:171], v[104:107]
    ds_read_b64_tr_b16 v[144:145], v30 offset:25728
    v_mfma_f32_16x16x32_bf16 v[124:127], v[164:167], a[172:175], v[124:127]
    ds_read_b64_tr_b16 v[146:147], v30 offset:27008
    s_add_u32 s29, s80, 51200
    s_add_u32 m0, s79, 61440
    s_nop 0
    buffer_load_dwordx4 v25, s[40:43], s29 offen sc1 lds
    s_waitcnt vmcnt(6) lgkmcnt(10)
    s_barrier
    s_cmp_lg_u32 s14, 0
    s_cbranch_scc1 L_sig_49
    s_lshl_b32 s4, s12, 8
    s_add_u32 s4, s4, 40960
    v_mov_b32 v4, s4
    v_mov_b32 v5, 1
    s_mov_b64 exec, 1
    buffer_atomic_add v5, v4, s[40:43], 0 offen sc1
    s_mov_b64 exec, -1
L_sig_49:
    v_mfma_f32_16x16x32_bf16 v[88:91], v[40:43], a[176:179], v[88:91]
    ds_read_b64_tr_b16 v[148:149], v28 offset:0
    v_mfma_f32_16x16x32_bf16 v[108:111], v[40:43], a[180:183], v[108:111]
    ds_read_b64_tr_b16 v[150:151], v28 offset:1280
    v_mfma_f32_16x16x32_bf16 v[92:95], v[44:47], a[176:179], v[92:95]
    ds_read_b64_tr_b16 v[152:153], v28 offset:32
    v_mfma_f32_16x16x32_bf16 v[112:115], v[44:47], a[180:183], v[112:115]
    ds_read_b64_tr_b16 v[154:155], v28 offset:1312
    v_mfma_f32_16x16x32_bf16 v[96:99], v[48:51], a[176:179], v[96:99]
    ds_read_b64_tr_b16 v[156:157], v28 offset:64
    v_mfma_f32_16x16x32_bf16 v[116:119], v[48:51], a[180:183], v[116:119]
    ds_read_b64_tr_b16 v[158:159], v28 offset:1344
    buffer_load_dwordx4 v25, s[40:43], s29 offen offset:1024 sc1 lds
    v_mfma_f32_16x16x32_bf16 v[100:103], v[52:55], a[176:179], v[100:103]
    ds_read_b64_tr_b16 v[160:161], v28 offset:96
    v_mfma_f32_16x16x32_bf16 v[120:123], v[52:55], a[180:183], v[120:123]
    ds_read_b64_tr_b16 v[162:163], v28 offset:1376
    buffer_load_dwordx4 v25, s[40:43], s29 offen offset:2048 sc1 lds
    v_mfma_f32_16x16x32_bf16 v[104:107], v[56:59], a[176:179], v[104:107]
    ds_read_b64_tr_b16 v[164:165], v28 offset:128
    v_mfma_f32_16x16x32_bf16 v[124:127], v[56:59], a[180:183], v[124:127]
    ds_read_b64_tr_b16 v[166:167], v28 offset:1408
    buffer_load_dwordx4 v25, s[40:43], s29 offen offset:3072 sc1 lds
    s_waitcnt lgkmcnt(10)
    v_mfma_f32_16x16x32_bf16 v[88:91], v[128:131], a[184:187], v[88:91]
    ds_read_b64_tr_b16 v[40:41], v28 offset:5120
    v_mfma_f32_16x16x32_bf16 v[108:111], v[128:131], a[188:191], v[108:111]
    ds_read_b64_tr_b16 v[42:43], v28 offset:6400
    v_mfma_f32_16x16x32_bf16 v[92:95], v[132:135], a[184:187], v[92:95]
    ds_read_b64_tr_b16 v[44:45], v28 offset:5152
    v_mfma_f32_16x16x32_bf16 v[112:115], v[132:135], a[188:191], v[112:115]
    ds_read_b64_tr_b16 v[46:47], v28 offset:6432
    v_mfma_f32_16x16x32_bf16 v[96:99], v[136:139], a[184:187], v[96:99]
    ds_read_b64_tr_b16 v[48:49], v28 offset:5184
    v_mfma_f32_16x16x32_bf16 v[116:119], v[136:139], a[188:191], v[116:119]
    ds_read_b64_tr_b16 v[50:51], v28 offset:6464
    s_add_u32 s28, s29, 4096
    s_add_u32 m0, s79, 65536
    s_nop 0
    buffer_load_dwordx4 v25, s[40:43], s28 offen sc1 lds
    v_mfma_f32_16x16x32_bf16 v[100:103], v[140:143], a[184:187], v[100:103]
    ds_read_b64_tr_b16 v[52:53], v28 offset:5216
    v_mfma_f32_16x16x32_bf16 v[120:123], v[140:143], a[188:191], v[120:123]
    ds_read_b64_tr_b16 v[54:55], v28 offset:6496
    s_add_u32 s29, s80, 61440
    s_add_u32 m0, s79, 81920
    s_nop 0
    buffer_load_dwordx4 v25, s[40:43], s29 offen sc1 lds
    v_mfma_f32_16x16x32_bf16 v[104:107], v[144:147], a[184:187], v[104:107]
    ds_read_b64_tr_b16 v[56:57], v28 offset:5248
    v_mfma_f32_16x16x32_bf16 v[124:127], v[144:147], a[188:191], v[124:127]
    ds_read_b64_tr_b16 v[58:59], v28 offset:6528
    buffer_load_dwordx4 v25, s[40:43], s29 offen offset:1024 sc1 lds
    s_waitcnt lgkmcnt(10)
    s_barrier
    v_mfma_f32_16x16x32_bf16 v[88:91], v[148:151], a[192:195], v[88:91]
    ds_read_b64_tr_b16 v[128:129], v28 offset:20480
    v_mfma_f32_16x16x32_bf16 v[108:111], v[148:151], a[196:199], v[108:111]
    ds_read_b64_tr_b16 v[130:131], v28 offset:21760
    v_mfma_f32_16x16x32_bf16 v[92:95], v[152:155], a[192:195], v[92:95]
    ds_read_b64_tr_b16 v[132:133], v28 offset:20512
    v_mfma_f32_16x16x32_bf16 v[112:115], v[152:155], a[196:199], v[112:115]
    ds_read_b64_tr_b16 v[134:135], v28 offset:21792
    v_mfma_f32_16x16x32_bf16 v[96:99], v[156:159], a[192:195], v[96:99]
    ds_read_b64_tr_b16 v[136:137], v28 offset:20544
    v_mfma_f32_16x16x32_bf16 v[116:119], v[156:159], a[196:199], v[116:119]
    ds_read_b64_tr_b16 v[138:139], v28 offset:21824
    buffer_load_dwordx4 v25, s[40:43], s29 offen offset:2048 sc1 lds
    v_mfma_f32_16x16x32_bf16 v[100:103], v[160:163], a[192:195], v[100:103]
    ds_read_b64_tr_b16 v[140:141], v28 offset:20576
    v_mfma_f32_16x16x32_bf16 v[120:123], v[160:163], a[196:199], v[120:123]
    ds_read_b64_tr_b16 v[142:143], v28 offset:21856
    buffer_load_dwordx4 v25, s[40:43], s29 offen offset:3072 sc1 lds
    v_mfma_f32_16x16x32_bf16 v[104:107], v[164:167], a[192:195], v[104:107]
    ds_read_b64_tr_b16 v[144:145], v28 offset:20608
    v_mfma_f32_16x16x32_bf16 v[124:127], v[164:167], a[196:199], v[124:127]
    ds_read_b64_tr_b16 v[146:147], v28 offset:21888
    s_add_u32 s28, s29, 4096
    s_add_u32 m0, s79, 86016
    s_nop 0
    buffer_load_dwordx4 v25, s[40:43], s28 offen sc1 lds
    s_lshl_b32 s4, s12, 8
    s_add_u32 s4, s4, 40960
    v_mov_b32 v227, s4
    buffer_load_dword v226, v227, s[40:43], 0 offen sc1
    s_waitcnt lgkmcnt(10)
    v_mfma_f32_16x16x32_bf16 v[88:91], v[40:43], a[200:203], v[88:91]
    ds_read_b64_tr_b16 v[148:149], v28 offset:25600
    v_mfma_f32_16x16x32_bf16 v[108:111], v[40:43], a[204:207], v[108:111]
    ds_read_b64_tr_b16 v[150:151], v28 offset:26880
    v_mfma_f32_16x16x32_bf16 v[92:95], v[44:47], a[200:203], v[92:95]
    ds_read_b64_tr_b16 v[152:153], v28 offset:25632
    v_mfma_f32_16x16x32_bf16 v[112:115], v[44:47], a[204:207], v[112:115]
    ds_read_b64_tr_b16 v[154:155], v28 offset:26912
    v_mfma_f32_16x16x32_bf16 v[96:99], v[48:51], a[200:203], v[96:99]
    ds_read_b64_tr_b16 v[156:157], v28 offset:25664
    v_mfma_f32_16x16x32_bf16 v[116:119], v[48:51], a[204:207], v[116:119]
    ds_read_b64_tr_b16 v[158:159], v28 offset:26944
    s_add_u32 s29, s80, 71680
    s_add_u32 m0, s79, 114688
    s_nop 0
    buffer_load_dwordx4 v25, s[40:43], s29 offen sc1 lds
    v_mfma_f32_16x16x32_bf16 v[100:103], v[52:55], a[200:203], v[100:103]
    ds_read_b64_tr_b16 v[160:161], v28 offset:25696
    v_mfma_f32_16x16x32_bf16 v[120:123], v[52:55], a[204:207], v[120:123]
    ds_read_b64_tr_b16 v[162:163], v28 offset:26976
    buffer_load_dwordx4 v25, s[40:43], s29 offen offset:1024 sc1 lds
    v_mfma_f32_16x16x32_bf16 v[104:107], v[56:59], a[200:203], v[104:107]
    ds_read_b64_tr_b16 v[164:165], v28 offset:25728
    v_mfma_f32_16x16x32_bf16 v[124:127], v[56:59], a[204:207], v[124:127]
    ds_read_b64_tr_b16 v[166:167], v28 offset:27008
    buffer_load_dwordx4 v25, s[40:43], s29 offen offset:2048 sc1 lds
    s_waitcnt vmcnt(14) lgkmcnt(10)
    s_barrier
    v_mfma_f32_16x16x32_bf16 v[88:91], v[128:131], a[208:211], v[88:91]
    ds_read_b64_tr_b16 v[40:41], v28 offset:40960
    v_mfma_f32_16x16x32_bf16 v[108:111], v[128:131], a[212:215], v[108:111]
    ds_read_b64_tr_b16 v[42:43], v28 offset:42240
    v_mfma_f32_16x16x32_bf16 v[92:95], v[132:135], a[208:211], v[92:95]
    ds_read_b64_tr_b16 v[44:45], v28 offset:40992
    v_mfma_f32_16x16x32_bf16 v[112:115], v[132:135], a[212:215], v[112:115]
    ds_read_b64_tr_b16 v[46:47], v28 offset:42272
    v_mfma_f32_16x16x32_bf16 v[96:99], v[136:139], a[208:211], v[96:99]
    ds_read_b64_tr_b16 v[48:49], v28 offset:41024
    v_mfma_f32_16x16x32_bf16 v[116:119], v[136:139], a[212:215], v[116:119]
    ds_read_b64_tr_b16 v[50:51], v28 offset:42304
    buffer_load_dwordx4 v25, s[40:43], s29 offen offset:3072 sc1 lds
    v_mfma_f32_16x16x32_bf16 v[100:103], v[140:143], a[208:211], v[100:103]
    ds_read_b64_tr_b16 v[52:53], v28 offset:41056
    v_mfma_f32_16x16x32_bf16 v[120:123], v[140:143], a[212:215], v[120:123]
    ds_read_b64_tr_b16 v[54:55], v28 offset:42336
    s_add_u32 s28, s29, 4096
    s_add_u32 m0, s79, 118784
    s_nop 0
    buffer_load_dwordx4 v25, s[40:43], s28 offen sc1 lds
    v_mfma_f32_16x16x32_bf16 v[104:107], v[144:147], a[208:211], v[104:107]
    ds_read_b64_tr_b16 v[56:57], v28 offset:41088
    v_mfma_f32_16x16x32_bf16 v[124:127], v[144:147], a[212:215], v[124:127]
    ds_read_b64_tr_b16 v[58:59], v28 offset:42368
    s_add_u32 s29, s80, 81920
    s_add_u32 m0, s79, 135168
    s_nop 0
    buffer_load_dwordx4 v25, s[40:43], s29 offen sc1 lds
    s_waitcnt lgkmcnt(10)
    v_mfma_f32_16x16x32_bf16 v[88:91], v[148:151], a[216:219], v[88:91]
    ds_read_b64_tr_b16 v[128:129], v28 offset:46080
    v_mfma_f32_16x16x32_bf16 v[108:111], v[148:151], a[220:223], v[108:111]
    ds_read_b64_tr_b16 v[130:131], v28 offset:47360
    v_mfma_f32_16x16x32_bf16 v[92:95], v[152:155], a[216:219], v[92:95]
    ds_read_b64_tr_b16 v[132:133], v28 offset:46112
    v_mfma_f32_16x16x32_bf16 v[112:115], v[152:155], a[220:223], v[112:115]
    ds_read_b64_tr_b16 v[134:135], v28 offset:47392
    v_mfma_f32_16x16x32_bf16 v[96:99], v[156:159], a[216:219], v[96:99]
    ds_read_b64_tr_b16 v[136:137], v28 offset:46144
    v_mfma_f32_16x16x32_bf16 v[116:119], v[156:159], a[220:223], v[116:119]
    ds_read_b64_tr_b16 v[138:139], v28 offset:47424
    buffer_load_dwordx4 v25, s[40:43], s29 offen offset:1024 sc1 lds
    v_mfma_f32_16x16x32_bf16 v[100:103], v[160:163], a[216:219], v[100:103]
    ds_read_b64_tr_b16 v[140:141], v28 offset:46176
    v_mfma_f32_16x16x32_bf16 v[120:123], v[160:163], a[220:223], v[120:123]
    ds_read_b64_tr_b16 v[142:143], v28 offset:47456
    buffer_load_dwordx4 v25, s[40:43], s29 offen offset:2048 sc1 lds
    v_mfma_f32_16x16x32_bf16 v[104:107], v[164:167], a[216:219], v[104:107]
    ds_read_b64_tr_b16 v[144:145], v28 offset:46208
    v_mfma_f32_16x16x32_bf16 v[124:127], v[164:167], a[220:223], v[124:127]
    ds_read_b64_tr_b16 v[146:147], v28 offset:47488
    buffer_load_dwordx4 v25, s[40:43], s29 offen offset:3072 sc1 lds
    s_waitcnt vmcnt(9)
    s_mov_b32 s19, 0
L_c4_50:
    v_readfirstlane_b32 s4, v226
    s_add_u32 s19, s19, 1
    s_cmp_ge_u32 s4, 16
    s_cbranch_scc1 L_c4d_51
    buffer_load_dword v226, v227, s[40:43], 0 offen sc1
    s_waitcnt vmcnt(0)
    s_cmp_lt_u32 s19, 200000
    s_cbranch_scc1 L_c4_50
L_c4d_51:
    s_waitcnt lgkmcnt(10)
    s_barrier
    v_mfma_f32_16x16x32_bf16 v[88:91], v[40:43], a[224:227], v[88:91]
    ds_read_b64_tr_b16 v[148:149], v29 offset:0
    v_mfma_f32_16x16x32_bf16 v[108:111], v[40:43], a[228:231], v[108:111]
    ds_read_b64_tr_b16 v[150:151], v29 offset:1280
    s_mov_b32 s17, 24576
    buffer_load_dwordx4 a[0:3], v26, s[40:43], s17 offen sc1
    v_mfma_f32_16x16x32_bf16 v[92:95], v[44:47], a[224:227], v[92:95]
    ds_read_b64_tr_b16 v[152:153], v29 offset:32
    v_mfma_f32_16x16x32_bf16 v[112:115], v[44:47], a[228:231], v[112:115]
    ds_read_b64_tr_b16 v[154:155], v29 offset:1312
    buffer_load_dwordx4 a[4:7], v27, s[40:43], s17 offen sc1
    v_mfma_f32_16x16x32_bf16 v[96:99], v[48:51], a[224:227], v[96:99]
    ds_read_b64_tr_b16 v[156:157], v29 offset:64
    v_mfma_f32_16x16x32_bf16 v[116:119], v[48:51], a[228:231], v[116:119]
    ds_read_b64_tr_b16 v[158:159], v29 offset:1344
    s_add_u32 s28, s29, 4096
    s_add_u32 m0, s79, 139264
    s_nop 0
    buffer_load_dwordx4 v25, s[40:43], s28 offen sc1 lds
    v_mfma_f32_16x16x32_bf16 v[100:103], v[52:55], a[224:227], v[100:103]
    ds_read_b64_tr_b16 v[160:161], v29 offset:96
    v_mfma_f32_16x16x32_bf16 v[120:123], v[52:55], a[228:231], v[120:123]
    ds_read_b64_tr_b16 v[162:163], v29 offset:1376
    s_add_u32 s29, s80, 92160
    s_add_u32 m0, s79, 0
    s_nop 0
    buffer_load_dwordx4 v25, s[40:43], s29 offen sc1 lds
    v_mfma_f32_16x16x32_bf16 v[104:107], v[56:59], a[224:227], v[104:107]
    ds_read_b64_tr_b16 v[164:165], v29 offset:128
    v_mfma_f32_16x16x32_bf16 v[124:127], v[56:59], a[228:231], v[124:127]
    ds_read_b64_tr_b16 v[166:167], v29 offset:1408
    buffer_load_dwordx4 v25, s[40:43], s29 offen offset:1024 sc1 lds
    s_waitcnt lgkmcnt(10)
    v_mfma_f32_16x16x32_bf16 v[88:91], v[128:131], a[232:235], v[88:91]
    ds_read_b64_tr_b16 v[40:41], v29 offset:5120
    v_mfma_f32_16x16x32_bf16 v[108:111], v[128:131], a[236:239], v[108:111]
    ds_read_b64_tr_b16 v[42:43], v29 offset:6400
    s_mov_b32 s17, 25600
    buffer_load_dwordx4 a[8:11], v26, s[40:43], s17 offen sc1
    v_mfma_f32_16x16x32_bf16 v[92:95], v[132:135], a[232:235], v[92:95]
    ds_read_b64_tr_b16 v[44:45], v29 offset:5152
    v_mfma_f32_16x16x32_bf16 v[112:115], v[132:135], a[236:239], v[112:115]
    ds_read_b64_tr_b16 v[46:47], v29 offset:6432
    buffer_load_dwordx4 a[12:15], v27, s[40:43], s17 offen sc1
    v_mfma_f32_16x16x32_bf16 v[96:99], v[136:139], a[232:235], v[96:99]
    ds_read_b64_tr_b16 v[48:49], v29 offset:5184
    v_mfma_f32_16x16x32_bf16 v[116:119], v[136:139], a[236:239], v[116:119]
    ds_read_b64_tr_b16 v[50:51], v29 offset:6464
    buffer_load_dwordx4 v25, s[40:43], s29 offen offset:2048 sc1 lds
    v_mfma_f32_16x16x32_bf16 v[100:103], v[140:143], a[232:235], v[100:103]
    ds_read_b64_tr_b16 v[52:53], v29 offset:5216
    v_mfma_f32_16x16x32_bf16 v[120:123], v[140:143], a[236:239], v[120:123]
    ds_read_b64_tr_b16 v[54:55], v29 offset:6496
    buffer_load_dwordx4 v25, s[40:43], s29 offen offset:3072 sc1 lds
    v_mfma_f32_16x16x32_bf16 v[104:107], v[144:147], a[232:235], v[104:107]
    ds_read_b64_tr_b16 v[56:57], v29 offset:5248
    v_mfma_f32_16x16x32_bf16 v[124:127], v[144:147], a[236:239], v[124:127]
    ds_read_b64_tr_b16 v[58:59], v29 offset:6528
    s_add_u32 s28, s29, 4096
    s_add_u32 m0, s79, 4096
    s_nop 0
    buffer_load_dwordx4 v25, s[40:43], s28 offen sc1 lds
    s_waitcnt lgkmcnt(10)
    s_barrier
    v_mfma_f32_16x16x32_bf16 v[88:91], v[148:151], a[240:243], v[88:91]
    ds_read_b64_tr_b16 v[128:129], v29 offset:20480
    v_mfma_f32_16x16x32_bf16 v[108:111], v[148:151], a[244:247], v[108:111]
    ds_read_b64_tr_b16 v[130:131], v29 offset:21760
    s_mov_b32 s17, 26624
    buffer_load_dwordx4 a[16:19], v26, s[40:43], s17 offen sc1
    v_mfma_f32_16x16x32_bf16 v[92:95], v[152:155], a[240:243], v[92:95]
    ds_read_b64_tr_b16 v[132:133], v29 offset:20512
    v_mfma_f32_16x16x32_bf16 v[112:115], v[152:155], a[244:247], v[112:115]
    ds_read_b64_tr_b16 v[134:135], v29 offset:21792
    buffer_load_dwordx4 a[20:23], v27, s[40:43], s17 offen sc1
    v_mfma_f32_16x16x32_bf16 v[96:99], v[156:159], a[240:243], v[96:99]
    ds_read_b64_tr_b16 v[136:137], v29 offset:20544
    v_mfma_f32_16x16x32_bf16 v[116:119], v[156:159], a[244:247], v[116:119]
    ds_read_b64_tr_b16 v[138:139], v29 offset:21824
    s_add_u32 s29, s80, 102400
    s_add_u32 m0, s79, 20480
    s_nop 0
    buffer_load_dwordx4 v25, s[40:43], s29 offen sc1 lds
    v_mfma_f32_16x16x32_bf16 v[100:103], v[160:163], a[240:243], v[100:103]
    ds_read_b64_tr_b16 v[140:141], v29 offset:20576
    v_mfma_f32_16x16x32_bf16 v[120:123], v[160:163], a[244:247], v[120:123]
    ds_read_b64_tr_b16 v[142:143], v29 offset:21856
    buffer_load_dwordx4 v25, s[40:43], s29 offen offset:1024 sc1 lds
    v_mfma_f32_16x16x32_bf16 v[104:107], v[164:167], a[240:243], v[104:107]
    ds_read_b64_tr_b16 v[144:145], v29 offset:20608
    v_mfma_f32_16x16x32_bf16 v[124:127], v[164:167], a[244:247], v[124:127]
    ds_read_b64_tr_b16 v[146:147], v29 offset:21888
    buffer_load_dwordx4 v25, s[40:43], s29 offen offset:2048 sc1 lds
    s_waitcnt lgkmcnt(10)
    v_mfma_f32_16x16x32_bf16 v[88:91], v[40:43], a[248:251], v[88:91]
    ds_read_b64_tr_b16 v[148:149], v29 offset:25600
    v_mfma_f32_16x16x32_bf16 v[108:111], v[40:43], a[252:255], v[108:111]
    ds_read_b64_tr_b16 v[150:151], v29 offset:26880
    s_mov_b32 s17, 27648
    buffer_load_dwordx4 a[24:27], v26, s[40:43], s17 offen sc1
    v_mfma_f32_16x16x32_bf16 v[92:95], v[44:47], a[248:251], v[92:95]
    ds_read_b64_tr_b16 v[152:153], v29 offset:25632
    v_mfma_f32_16x16x32_bf16 v[112:115], v[44:47], a[252:255], v[112:115]
    ds_read_b64_tr_b16 v[154:155], v29 offset:26912
    buffer_load_dwordx4 a[28:31], v27, s[40:43], s17 offen sc1
    v_mfma_f32_16x16x32_bf16 v[96:99], v[48:51], a[248:251], v[96:99]
    ds_read_b64_tr_b16 v[156:157], v29 offset:25664
    v_mfma_f32_16x16x32_bf16 v[116:119], v[48:51], a[252:255], v[116:119]
    ds_read_b64_tr_b16 v[158:159], v29 offset:26944
    buffer_load_dwordx4 v25, s[40:43], s29 offen offset:3072 sc1 lds
    v_mfma_f32_16x16x32_bf16 v[100:103], v[52:55], a[248:251], v[100:103]
    ds_read_b64_tr_b16 v[160:161], v29 offset:25696
    v_mfma_f32_16x16x32_bf16 v[120:123], v[52:55], a[252:255], v[120:123]
    ds_read_b64_tr_b16 v[162:163], v29 offset:26976
    s_add_u32 s28, s29, 4096
    s_add_u32 m0, s79, 24576
    s_nop 0
    buffer_load_dwordx4 v25, s[40:43], s28 offen sc1 lds
    v_mfma_f32_16x16x32_bf16 v[104:107], v[56:59], a[248:251], v[104:107]
    ds_read_b64_tr_b16 v[164:165], v29 offset:25728
    v_mfma_f32_16x16x32_bf16 v[124:127], v[56:59], a[252:255], v[124:127]
    ds_read_b64_tr_b16 v[166:167], v29 offset:27008
    s_add_u32 s29, s80, 112640
    s_add_u32 m0, s79, 40960
    s_nop 0
    buffer_load_dwordx4 v25, s[40:43], s29 offen sc1 lds
    s_waitcnt vmcnt(18) lgkmcnt(10)
    s_barrier
    v_mfma_f32_16x16x32_bf16 v[88:91], v[128:131], a[0:3], v[88:91]
    ds_read_b64_tr_b16 v[40:41], v30 offset:0
    v_mfma_f32_16x16x32_bf16 v[108:111], v[128:131], a[4:7], v[108:111]
    ds_read_b64_tr_b16 v[42:43], v30 offset:1280
    s_mov_b32 s17, 28672
    buffer_load_dwordx4 a[32:35], v26, s[40:43], s17 offen sc1
    v_mfma_f32_16x16x32_bf16 v[92:95], v[132:135], a[0:3], v[92:95]
    ds_read_b64_tr_b16 v[44:45], v30 offset:32
    v_mfma_f32_16x16x32_bf16 v[112:115], v[132:135], a[4:7], v[112:115]
    ds_read_b64_tr_b16 v[46:47], v30 offset:1312
    buffer_load_dwordx4 a[36:39], v27, s[40:43], s17 offen sc1
    v_mfma_f32_16x16x32_bf16 v[96:99], v[136:139], a[0:3], v[96:99]
    ds_read_b64_tr_b16 v[48:49], v30 offset:64
    v_mfma_f32_16x16x32_bf16 v[116:119], v[136:139], a[4:7], v[116:119]
    ds_read_b64_tr_b16 v[50:51], v30 offset:1344
    buffer_load_dwordx4 v25, s[40:43], s29 offen offset:1024 sc1 lds
    v_mfma_f32_16x16x32_bf16 v[100:103], v[140:143], a[0:3], v[100:103]
    ds_read_b64_tr_b16 v[52:53], v30 offset:96
    v_mfma_f32_16x16x32_bf16 v[120:123], v[140:143], a[4:7], v[120:123]
    ds_read_b64_tr_b16 v[54:55], v30 offset:1376
    buffer_load_dwordx4 v25, s[40:43], s29 offen offset:2048 sc1 lds
    v_mfma_f32_16x16x32_bf16 v[104:107], v[144:147], a[0:3], v[104:107]
    ds_read_b64_tr_b16 v[56:57], v30 offset:128
    v_mfma_f32_16x16x32_bf16 v[124:127], v[144:147], a[4:7], v[124:127]
    ds_read_b64_tr_b16 v[58:59], v30 offset:1408
    buffer_load_dwordx4 v25, s[40:43], s29 offen offset:3072 sc1 lds
    s_waitcnt vmcnt(18) lgkmcnt(10)
    v_mfma_f32_16x16x32_bf16 v[88:91], v[148:151], a[8:11], v[88:91]
    ds_read_b64_tr_b16 v[128:129], v30 offset:5120
    v_mfma_f32_16x16x32_bf16 v[108:111], v[148:151], a[12:15], v[108:111]
    ds_read_b64_tr_b16 v[130:131], v30 offset:6400
    s_mov_b32 s17, 29696
    buffer_load_dwordx4 a[40:43], v26, s[40:43], s17 offen sc1
    v_mfma_f32_16x16x32_bf16 v[92:95], v[152:155], a[8:11], v[92:95]
    ds_read_b64_tr_b16 v[132:133], v30 offset:5152
    v_mfma_f32_16x16x32_bf16 v[112:115], v[152:155], a[12:15], v[112:115]
    ds_read_b64_tr_b16 v[134:135], v30 offset:6432
    buffer_load_dwordx4 a[44:47], v27, s[40:43], s17 offen sc1
    v_mfma_f32_16x16x32_bf16 v[96:99], v[156:159], a[8:11], v[96:99]
    ds_read_b64_tr_b16 v[136:137], v30 offset:5184
    v_mfma_f32_16x16x32_bf16 v[116:119], v[156:159], a[12:15], v[116:119]
    ds_read_b64_tr_b16 v[138:139], v30 offset:6464
    s_add_u32 s28, s29, 4096
    s_add_u32 m0, s79, 45056
    s_nop 0
    buffer_load_dwordx4 v25, s[40:43], s28 offen sc1 lds
    v_mfma_f32_16x16x32_bf16 v[100:103], v[160:163], a[8:11], v[100:103]
    ds_read_b64_tr_b16 v[140:141], v30 offset:5216
    v_mfma_f32_16x16x32_bf16 v[120:123], v[160:163], a[12:15], v[120:123]
    ds_read_b64_tr_b16 v[142:143], v30 offset:6496
    s_mov_b32 s17, 30720
    buffer_load_dwordx4 a[48:51], v26, s[40:43], s17 offen sc1
    v_mfma_f32_16x16x32_bf16 v[104:107], v[164:167], a[8:11], v[104:107]
    ds_read_b64_tr_b16 v[144:145], v30 offset:5248
    v_mfma_f32_16x16x32_bf16 v[124:127], v[164:167], a[12:15], v[124:127]
    ds_read_b64_tr_b16 v[146:147], v30 offset:6528
    buffer_load_dwordx4 a[52:55], v27, s[40:43], s17 offen sc1
    s_waitcnt vmcnt(18) lgkmcnt(10)
    s_barrier
    v_mfma_f32_16x16x32_bf16 v[88:91], v[40:43], a[16:19], v[88:91]
    ds_read_b64_tr_b16 v[148:149], v30 offset:20480
    v_mfma_f32_16x16x32_bf16 v[108:111], v[40:43], a[20:23], v[108:111]
    ds_read_b64_tr_b16 v[150:151], v30 offset:21760
    s_mov_b32 s17, 31744
    buffer_load_dwordx4 a[56:59], v26, s[40:43], s17 offen sc1
    v_mfma_f32_16x16x32_bf16 v[92:95], v[44:47], a[16:19], v[92:95]
    ds_read_b64_tr_b16 v[152:153], v30 offset:20512
    v_mfma_f32_16x16x32_bf16 v[112:115], v[44:47], a[20:23], v[112:115]
    ds_read_b64_tr_b16 v[154:155], v30 offset:21792
    buffer_load_dwordx4 a[60:63], v27, s[40:43], s17 offen sc1
    v_mfma_f32_16x16x32_bf16 v[96:99], v[48:51], a[16:19], v[96:99]
    ds_read_b64_tr_b16 v[156:157], v30 offset:20544
    v_mfma_f32_16x16x32_bf16 v[116:119], v[48:51], a[20:23], v[116:119]
    ds_read_b64_tr_b16 v[158:159], v30 offset:21824
    s_mov_b32 s17, 32768
    buffer_load_dwordx4 a[64:67], v26, s[40:43], s17 offen sc1
    v_mfma_f32_16x16x32_bf16 v[100:103], v[52:55], a[16:19], v[100:103]
    ds_read_b64_tr_b16 v[160:161], v30 offset:20576
    v_mfma_f32_16x16x32_bf16 v[120:123], v[52:55], a[20:23], v[120:123]
    ds_read_b64_tr_b16 v[162:163], v30 offset:21856
    buffer_load_dwordx4 a[68:71], v27, s[40:43], s17 offen sc1
    v_mfma_f32_16x16x32_bf16 v[104:107], v[56:59], a[16:19], v[104:107]
    ds_read_b64_tr_b16 v[164:165], v30 offset:20608
    v_mfma_f32_16x16x32_bf16 v[124:127], v[56:59], a[20:23], v[124:127]
    ds_read_b64_tr_b16 v[166:167], v30 offset:21888
    s_mov_b32 s17, 33792
    buffer_load_dwordx4 a[72:75], v26, s[40:43], s17 offen sc1
    s_waitcnt vmcnt(18) lgkmcnt(10)
    v_mfma_f32_16x16x32_bf16 v[88:91], v[128:131], a[24:27], v[88:91]
    ds_read_b64_tr_b16 v[40:41], v30 offset:25600
    v_mfma_f32_16x16x32_bf16 v[108:111], v[128:131], a[28:31], v[108:111]
    ds_read_b64_tr_b16 v[42:43], v30 offset:26880
    buffer_load_dwordx4 a[76:79], v27, s[40:43], s17 offen sc1
    v_mfma_f32_16x16x32_bf16 v[92:95], v[132:135], a[24:27], v[92:95]
    ds_read_b64_tr_b16 v[44:45], v30 offset:25632
    v_mfma_f32_16x16x32_bf16 v[112:115], v[132:135], a[28:31], v[112:115]
    ds_read_b64_tr_b16 v[46:47], v30 offset:26912
    s_mov_b32 s17, 34816
    buffer_load_dwordx4 a[80:83], v26, s[40:43], s17 offen sc1
    v_mfma_f32_16x16x32_bf16 v[96:99], v[136:139], a[24:27], v[96:99]
    ds_read_b64_tr_b16 v[48:49], v30 offset:25664
    v_mfma_f32_16x16x32_bf16 v[116:119], v[136:139], a[28:31], v[116:119]
    ds_read_b64_tr_b16 v[50:51], v30 offset:26944
    buffer_load_dwordx4 a[84:87], v27, s[40:43], s17 offen sc1
    v_mfma_f32_16x16x32_bf16 v[100:103], v[140:143], a[24:27], v[100:103]
    ds_read_b64_tr_b16 v[52:53], v30 offset:25696
    v_mfma_f32_16x16x32_bf16 v[120:123], v[140:143], a[28:31], v[120:123]
    ds_read_b64_tr_b16 v[54:55], v30 offset:26976
    s_mov_b32 s17, 35840
    buffer_load_dwordx4 a[88:91], v26, s[40:43], s17 offen sc1
    v_mfma_f32_16x16x32_bf16 v[104:107], v[144:147], a[24:27], v[104:107]
    ds_read_b64_tr_b16 v[56:57], v30 offset:25728
    v_mfma_f32_16x16x32_bf16 v[124:127], v[144:147], a[28:31], v[124:127]
    ds_read_b64_tr_b16 v[58:59], v30 offset:27008
    buffer_load_dwordx4 a[92:95], v27, s[40:43], s17 offen sc1
    s_waitcnt vmcnt(18) lgkmcnt(10)
    s_barrier
    v_mfma_f32_16x16x32_bf16 v[88:91], v[148:151], a[32:35], v[88:91]
    ds_read_b64_tr_b16 v[128:129], v28 offset:0
    v_mfma_f32_16x16x32_bf16 v[108:111], v[148:151], a[36:39], v[108:111]
    ds_read_b64_tr_b16 v[130:131], v28 offset:1280
    v_mfma_f32_16x16x32_bf16 v[92:95], v[152:155], a[32:35], v[92:95]
    ds_read_b64_tr_b16 v[132:133], v28 offset:32
    v_mfma_f32_16x16x32_bf16 v[112:115], v[152:155], a[36:39], v[112:115]
    ds_read_b64_tr_b16 v[134:135], v28 offset:1312
    v_mfma_f32_16x16x32_bf16 v[96:99], v[156:159], a[32:35], v[96:99]
    ds_read_b64_tr_b16 v[136:137], v28 offset:64
    v_mfma_f32_16x16x32_bf16 v[116:119], v[156:159], a[36:39], v[116:119]
    ds_read_b64_tr_b16 v[138:139], v28 offset:1344
    v_mfma_f32_16x16x32_bf16 v[100:103], v[160:163], a[32:35], v[100:103]
    ds_read_b64_tr_b16 v[140:141], v28 offset:96
    v_mfma_f32_16x16x32_bf16 v[120:123], v[160:163], a[36:39], v[120:123]
    ds_read_b64_tr_b16 v[142:143], v28 offset:1376
    v_mfma_f32_16x16x32_bf16 v[104:107], v[164:167], a[32:35], v[104:107]
    ds_read_b64_tr_b16 v[144:145], v28 offset:128
    v_mfma_f32_16x16x32_bf16 v[124:127], v[164:167], a[36:39], v[124:127]
    ds_read_b64_tr_b16 v[146:147], v28 offset:1408
    s_waitcnt vmcnt(13) lgkmcnt(10)
    v_mfma_f32_16x16x32_bf16 v[88:91], v[40:43], a[40:43], v[88:91]
    ds_read_b64_tr_b16 v[148:149], v28 offset:5120
    v_mfma_f32_16x16x32_bf16 v[108:111], v[40:43], a[44:47], v[108:111]
    ds_read_b64_tr_b16 v[150:151], v28 offset:6400
    v_mfma_f32_16x16x32_bf16 v[92:95], v[44:47], a[40:43], v[92:95]
    ds_read_b64_tr_b16 v[152:153], v28 offset:5152
    v_mfma_f32_16x16x32_bf16 v[112:115], v[44:47], a[44:47], v[112:115]
    ds_read_b64_tr_b16 v[154:155], v28 offset:6432
    v_mfma_f32_16x16x32_bf16 v[96:99], v[48:51], a[40:43], v[96:99]
    ds_read_b64_tr_b16 v[156:157], v28 offset:5184
    v_mfma_f32_16x16x32_bf16 v[116:119], v[48:51], a[44:47], v[116:119]
    ds_read_b64_tr_b16 v[158:159], v28 offset:6464
    v_mfma_f32_16x16x32_bf16 v[100:103], v[52:55], a[40:43], v[100:103]
    ds_read_b64_tr_b16 v[160:161], v28 offset:5216
    v_mfma_f32_16x16x32_bf16 v[120:123], v[52:55], a[44:47], v[120:123]
    ds_read_b64_tr_b16 v[162:163], v28 offset:6496
    v_mfma_f32_16x16x32_bf16 v[104:107], v[56:59], a[40:43], v[104:107]
    ds_read_b64_tr_b16 v[164:165], v28 offset:5248
    v_mfma_f32_16x16x32_bf16 v[124:127], v[56:59], a[44:47], v[124:127]
    ds_read_b64_tr_b16 v[166:167], v28 offset:6528
    s_waitcnt vmcnt(10) lgkmcnt(10)
    s_barrier
    v_mfma_f32_16x16x32_bf16 v[88:91], v[128:131], a[48:51], v[88:91]
    ds_read_b64_tr_b16 v[40:41], v28 offset:20480
    v_mfma_f32_16x16x32_bf16 v[108:111], v[128:131], a[52:55], v[108:111]
    ds_read_b64_tr_b16 v[42:43], v28 offset:21760
    v_mfma_f32_16x16x32_bf16 v[92:95], v[132:135], a[48:51], v[92:95]
    ds_read_b64_tr_b16 v[44:45], v28 offset:20512
    v_mfma_f32_16x16x32_bf16 v[112:115], v[132:135], a[52:55], v[112:115]
    ds_read_b64_tr_b16 v[46:47], v28 offset:21792
    v_mfma_f32_16x16x32_bf16 v[96:99], v[136:139], a[48:51], v[96:99]
    ds_read_b64_tr_b16 v[48:49], v28 offset:20544
    v_mfma_f32_16x16x32_bf16 v[116:119], v[136:139], a[52:55], v[116:119]
    ds_read_b64_tr_b16 v[50:51], v28 offset:21824
    v_mfma_f32_16x16x32_bf16 v[100:103], v[140:143], a[48:51], v[100:103]
    ds_read_b64_tr_b16 v[52:53], v28 offset:20576
    v_mfma_f32_16x16x32_bf16 v[120:123], v[140:143], a[52:55], v[120:123]
    ds_read_b64_tr_b16 v[54:55], v28 offset:21856
    v_mfma_f32_16x16x32_bf16 v[104:107], v[144:147], a[48:51], v[104:107]
    ds_read_b64_tr_b16 v[56:57], v28 offset:20608
    v_mfma_f32_16x16x32_bf16 v[124:127], v[144:147], a[52:55], v[124:127]
    ds_read_b64_tr_b16 v[58:59], v28 offset:21888
    s_waitcnt vmcnt(8) lgkmcnt(10)
    v_mfma_f32_16x16x32_bf16 v[88:91], v[148:151], a[56:59], v[88:91]
    ds_read_b64_tr_b16 v[128:129], v28 offset:25600
    v_mfma_f32_16x16x32_bf16 v[108:111], v[148:151], a[60:63], v[108:111]
    ds_read_b64_tr_b16 v[130:131], v28 offset:26880
    v_mfma_f32_16x16x32_bf16 v[92:95], v[152:155], a[56:59], v[92:95]
    ds_read_b64_tr_b16 v[132:133], v28 offset:25632
    v_mfma_f32_16x16x32_bf16 v[112:115], v[152:155], a[60:63], v[112:115]
    ds_read_b64_tr_b16 v[134:135], v28 offset:26912
    v_mfma_f32_16x16x32_bf16 v[96:99], v[156:159], a[56:59], v[96:99]
    ds_read_b64_tr_b16 v[136:137], v28 offset:25664
    v_mfma_f32_16x16x32_bf16 v[116:119], v[156:159], a[60:63], v[116:119]
    ds_read_b64_tr_b16 v[138:139], v28 offset:26944
    v_mfma_f32_16x16x32_bf16 v[100:103], v[160:163], a[56:59], v[100:103]
    ds_read_b64_tr_b16 v[140:141], v28 offset:25696
    v_mfma_f32_16x16x32_bf16 v[120:123], v[160:163], a[60:63], v[120:123]
    ds_read_b64_tr_b16 v[142:143], v28 offset:26976
    v_mfma_f32_16x16x32_bf16 v[104:107], v[164:167], a[56:59], v[104:107]
    ds_read_b64_tr_b16 v[144:145], v28 offset:25728
    v_mfma_f32_16x16x32_bf16 v[124:127], v[164:167], a[60:63], v[124:127]
    ds_read_b64_tr_b16 v[146:147], v28 offset:27008
    s_waitcnt vmcnt(6) lgkmcnt(10)
    s_barrier
    v_mfma_f32_16x16x32_bf16 v[88:91], v[40:43], a[64:67], v[88:91]
    ds_read_b64_tr_b16 v[148:149], v28 offset:40960
    v_mfma_f32_16x16x32_bf16 v[108:111], v[40:43], a[68:71], v[108:111]
    ds_read_b64_tr_b16 v[150:151], v28 offset:42240
    v_mfma_f32_16x16x32_bf16 v[92:95], v[44:47], a[64:67], v[92:95]
    ds_read_b64_tr_b16 v[152:153], v28 offset:40992
    v_mfma_f32_16x16x32_bf16 v[112:115], v[44:47], a[68:71], v[112:115]
    ds_read_b64_tr_b16 v[154:155], v28 offset:42272
    v_mfma_f32_16x16x32_bf16 v[96:99], v[48:51], a[64:67], v[96:99]
    ds_read_b64_tr_b16 v[156:157], v28 offset:41024
    v_mfma_f32_16x16x32_bf16 v[116:119], v[48:51], a[68:71], v[116:119]
    ds_read_b64_tr_b16 v[158:159], v28 offset:42304
    v_mfma_f32_16x16x32_bf16 v[100:103], v[52:55], a[64:67], v[100:103]
    ds_read_b64_tr_b16 v[160:161], v28 offset:41056
    v_mfma_f32_16x16x32_bf16 v[120:123], v[52:55], a[68:71], v[120:123]
    ds_read_b64_tr_b16 v[162:163], v28 offset:42336
    v_mfma_f32_16x16x32_bf16 v[104:107], v[56:59], a[64:67], v[104:107]
    ds_read_b64_tr_b16 v[164:165], v28 offset:41088
    v_mfma_f32_16x16x32_bf16 v[124:127], v[56:59], a[68:71], v[124:127]
    ds_read_b64_tr_b16 v[166:167], v28 offset:42368
    s_waitcnt vmcnt(4) lgkmcnt(10)
    v_mfma_f32_16x16x32_bf16 v[88:91], v[128:131], a[72:75], v[88:91]
    ds_read_b64_tr_b16 v[40:41], v28 offset:46080
    v_mfma_f32_16x16x32_bf16 v[108:111], v[128:131], a[76:79], v[108:111]
    ds_read_b64_tr_b16 v[42:43], v28 offset:47360
    v_mfma_f32_16x16x32_bf16 v[92:95], v[132:135], a[72:75], v[92:95]
    ds_read_b64_tr_b16 v[44:45], v28 offset:46112
    v_mfma_f32_16x16x32_bf16 v[112:115], v[132:135], a[76:79], v[112:115]
    ds_read_b64_tr_b16 v[46:47], v28 offset:47392
    v_mfma_f32_16x16x32_bf16 v[96:99], v[136:139], a[72:75], v[96:99]
    ds_read_b64_tr_b16 v[48:49], v28 offset:46144
    v_mfma_f32_16x16x32_bf16 v[116:119], v[136:139], a[76:79], v[116:119]
    ds_read_b64_tr_b16 v[50:51], v28 offset:47424
    v_mfma_f32_16x16x32_bf16 v[100:103], v[140:143], a[72:75], v[100:103]
    ds_read_b64_tr_b16 v[52:53], v28 offset:46176
    v_mfma_f32_16x16x32_bf16 v[120:123], v[140:143], a[76:79], v[120:123]
    ds_read_b64_tr_b16 v[54:55], v28 offset:47456
    v_mfma_f32_16x16x32_bf16 v[104:107], v[144:147], a[72:75], v[104:107]
    ds_read_b64_tr_b16 v[56:57], v28 offset:46208
    v_mfma_f32_16x16x32_bf16 v[124:127], v[144:147], a[76:79], v[124:127]
    ds_read_b64_tr_b16 v[58:59], v28 offset:47488
    s_waitcnt vmcnt(2) lgkmcnt(10)
    v_mfma_f32_16x16x32_bf16 v[88:91], v[148:151], a[80:83], v[88:91]
    v_mfma_f32_16x16x32_bf16 v[108:111], v[148:151], a[84:87], v[108:111]
    v_mfma_f32_16x16x32_bf16 v[92:95], v[152:155], a[80:83], v[92:95]
    v_mfma_f32_16x16x32_bf16 v[112:115], v[152:155], a[84:87], v[112:115]
    v_mfma_f32_16x16x32_bf16 v[96:99], v[156:159], a[80:83], v[96:99]
    v_mfma_f32_16x16x32_bf16 v[116:119], v[156:159], a[84:87], v[116:119]
    v_mfma_f32_16x16x32_bf16 v[100:103], v[160:163], a[80:83], v[100:103]
    v_mfma_f32_16x16x32_bf16 v[120:123], v[160:163], a[84:87], v[120:123]
    v_mfma_f32_16x16x32_bf16 v[104:107], v[164:167], a[80:83], v[104:107]
    v_mfma_f32_16x16x32_bf16 v[124:127], v[164:167], a[84:87], v[124:127]
    s_waitcnt vmcnt(0) lgkmcnt(0)
    v_mfma_f32_16x16x32_bf16 v[88:91], v[40:43], a[88:91], v[88:91]
    v_mfma_f32_16x16x32_bf16 v[108:111], v[40:43], a[92:95], v[108:111]
    v_mfma_f32_16x16x32_bf16 v[92:95], v[44:47], a[88:91], v[92:95]
    v_mfma_f32_16x16x32_bf16 v[112:115], v[44:47], a[92:95], v[112:115]
    v_mfma_f32_16x16x32_bf16 v[96:99], v[48:51], a[88:91], v[96:99]
    v_mfma_f32_16x16x32_bf16 v[116:119], v[48:51], a[92:95], v[116:119]
    v_mfma_f32_16x16x32_bf16 v[100:103], v[52:55], a[88:91], v[100:103]
    v_mfma_f32_16x16x32_bf16 v[120:123], v[52:55], a[92:95], v[120:123]
    v_mfma_f32_16x16x32_bf16 v[104:107], v[56:59], a[88:91], v[104:107]
    v_mfma_f32_16x16x32_bf16 v[124:127], v[56:59], a[92:95], v[124:127]
    s_barrier
    s_mul_i32 s4, s14, 5120
    v_add_u32 v4, s4, v12
    s_xor_b32 s5, s14, 1
    s_mul_i32 s5, s5, 5120
    v_add_u32 v5, s5, v12
    s_cmp_eq_u32 s77, 0
    s_cbranch_scc0 L_x1_52
    ds_write_b128 v4, v[108:111] offset:0
    ds_write_b128 v4, v[112:115] offset:1024
    ds_write_b128 v4, v[116:119] offset:2048
    ds_write_b128 v4, v[120:123] offset:3072
    ds_write_b128 v4, v[124:127] offset:4096
    v_mov_b32 v128, v88
    v_mov_b32 v129, v89
    v_mov_b32 v130, v90
    v_mov_b32 v131, v91
    v_mov_b32 v132, v92
    v_mov_b32 v133, v93
    v_mov_b32 v134, v94
    v_mov_b32 v135, v95
    v_mov_b32 v136, v96
    v_mov_b32 v137, v97
    v_mov_b32 v138, v98
    v_mov_b32 v139, v99
    v_mov_b32 v140, v100
    v_mov_b32 v141, v101
    v_mov_b32 v142, v102
    v_mov_b32 v143, v103
    v_mov_b32 v144, v104
    v_mov_b32 v145, v105
    v_mov_b32 v146, v106
    v_mov_b32 v147, v107
    s_branch L_xe_53
L_x1_52:
    ds_write_b128 v4, v[88:91] offset:0
    ds_write_b128 v4, v[92:95] offset:1024
    ds_write_b128 v4, v[96:99] offset:2048
    ds_write_b128 v4, v[100:103] offset:3072
    ds_write_b128 v4, v[104:107] offset:4096
    v_mov_b32 v128, v108
    v_mov_b32 v129, v109
    v_mov_b32 v130, v110
    v_mov_b32 v131, v111
    v_mov_b32 v132, v112
    v_mov_b32 v133, v113
    v_mov_b32 v134, v114
    v_mov_b32 v135, v115
    v_mov_b32 v136, v116
    v_mov_b32 v137, v117
    v_mov_b32 v138, v118
    v_mov_b32 v139, v119
    v_mov_b32 v140, v120
    v_mov_b32 v141, v121
    v_mov_b32 v142, v122
    v_mov_b32 v143, v123
    v_mov_b32 v144, v124
    v_mov_b32 v145, v125
    v_mov_b32 v146, v126
    v_mov_b32 v147, v127
L_xe_53:
    s_waitcnt lgkmcnt(0)
    s_barrier
    ds_read_b128 v[148:151], v5 offset:0
    ds_read_b128 v[152:155], v5 offset:1024
    ds_read_b128 v[156:159], v5 offset:2048
    ds_read_b128 v[160:163], v5 offset:3072
    ds_read_b128 v[164:167], v5 offset:4096
    v_lshlrev_b32 v88, 16, v14
    v_and_b32 v89, 0xffff0000, v14
    v_lshlrev_b32_e64 v90, 16, v15
    v_and_b32 v91, 0xffff0000, v15
    v_lshlrev_b32_e64 v92, 16, v16
    v_and_b32 v93, 0xffff0000, v16
    v_lshlrev_b32_e64 v94, 16, v17
    v_and_b32 v95, 0xffff0000, v17
    v_lshlrev_b32_e64 v96, 16, v18
    v_and_b32 v97, 0xffff0000, v18
    v_lshlrev_b32_e64 v98, 16, v19
    v_and_b32 v99, 0xffff0000, v19
    v_lshlrev_b32_e64 v100, 16, v20
    v_and_b32 v101, 0xffff0000, v20
    v_lshlrev_b32_e64 v102, 16, v21
    v_and_b32 v103, 0xffff0000, v21
    v_lshlrev_b32_e64 v104, 16, v22
    v_and_b32 v105, 0xffff0000, v22
    v_lshlrev_b32_e64 v106, 16, v23
    v_and_b32 v107, 0xffff0000, v23
    v_pk_add_f32 v[128:129], v[128:129], v[88:89]
    v_pk_add_f32 v[130:131], v[130:131], v[90:91]
    v_pk_add_f32 v[132:133], v[132:133], v[92:93]
    v_pk_add_f32 v[134:135], v[134:135], v[94:95]
    v_pk_add_f32 v[136:137], v[136:137], v[96:97]
    v_pk_add_f32 v[138:139], v[138:139], v[98:99]
    v_pk_add_f32 v[140:141], v[140:141], v[100:101]
    v_pk_add_f32 v[142:143], v[142:143], v[102:103]
    v_pk_add_f32 v[144:145], v[144:145], v[104:105]
    v_pk_add_f32 v[146:147], v[146:147], v[106:107]
    s_waitcnt lgkmcnt(0)
    s_nop 0
    v_pk_add_f32 v[128:129], v[128:129], v[148:149]
    v_pk_add_f32 v[130:131], v[130:131], v[150:151]
    v_pk_add_f32 v[132:133], v[132:133], v[152:153]
    v_pk_add_f32 v[134:135], v[134:135], v[154:155]
    v_pk_add_f32 v[136:137], v[136:137], v[156:157]
    v_pk_add_f32 v[138:139], v[138:139], v[158:159]
    v_pk_add_f32 v[140:141], v[140:141], v[160:161]
    v_pk_add_f32 v[142:143], v[142:143], v[162:163]
    v_pk_add_f32 v[144:145], v[144:145], v[164:165]
    v_pk_add_f32 v[146:147], v[146:147], v[166:167]
    v_cvt_pk_bf16_f32 v108, v128, v129
    v_cvt_pk_bf16_f32 v109, v130, v131
    v_cvt_pk_bf16_f32 v110, v132, v133
    v_cvt_pk_bf16_f32 v111, v134, v135
    v_cvt_pk_bf16_f32 v112, v136, v137
    v_cvt_pk_bf16_f32 v113, v138, v139
    v_cvt_pk_bf16_f32 v114, v140, v141
    v_cvt_pk_bf16_f32 v115, v142, v143
    v_cvt_pk_bf16_f32 v116, v144, v145
    v_cvt_pk_bf16_f32 v117, v146, v147
    s_lshl_b32 s4, s15, 2
    s_add_u32 s4, s4, s14
    s_lshl_b32 s4, s4, 4
    v_and_b32 v4, 15, v1
    v_add_u32_e64 v4, s4, v4
    v_mul_u32_u24 v4, 1280, v4
    v_bfe_u32 v5, v1, 4, 1
    v_lshl_add_u32 v4, v5, 5, v4
    v_lshrrev_b32_e64 v6, 5, v1
    v_lshl_add_u32 v4, v6, 4, v4
    s_mul_i32 s5, s16, 160
    v_add_u32 v148, s5, v4
    v_add_u32 v149, 64, v148
    v_add_u32 v150, 128, v148
    v_cmp_eq_u32 vcc, 0, v5
    v_mov_b32 v7, 0x7ffffff0
    s_nop 0
    v_cndmask_b32 v150, v7, v150, vcc
    v_mov_b32 v88, v108
    v_mov_b32 v89, v109
    v_mov_b32 v90, v110
    v_mov_b32 v91, v111
    v_mov_b32 v92, v112
    v_mov_b32 v93, v113
    v_mov_b32 v94, v114
    v_mov_b32 v95, v115
    v_mov_b32 v96, v116
    v_mov_b32 v97, v117
    v_mov_b32 v98, v116
    v_mov_b32 v99, v117
    v_permlane16_swap_b32 v88, v90
    v_permlane16_swap_b32 v89, v91
    v_permlane16_swap_b32 v92, v94
    v_permlane16_swap_b32 v93, v95
    v_permlane16_swap_b32 v96, v98
    v_permlane16_swap_b32 v97, v99
    buffer_store_dwordx4 v[88:91], v148, s[72:75], 0 offen
    buffer_store_dwordx4 v[92:95], v149, s[72:75], 0 offen
    buffer_store_dwordx4 v[96:99], v150, s[72:75], 0 offen
    s_waitcnt vmcnt(0)
L_end:
    s_endpgm
.section .rodata,"a"
.p2align 6
.amdhsa_kernel sequential_preLN__linear_kernel_hedgehog__glu_gated_reglu__prompt_kernel
  .amdhsa_next_free_vgpr 512
  .amdhsa_next_free_sgpr 102
  .amdhsa_accum_offset 256
  .amdhsa_group_segment_fixed_size 0
  .amdhsa_kernarg_size 88
  .amdhsa_user_sgpr_count 2
  .amdhsa_user_sgpr_kernarg_segment_ptr 1
  .amdhsa_system_sgpr_workgroup_id_x 1
.end_amdhsa_kernel
.text
```
